```python
import torch

def _softmax(x, axis=-1):
    return torch.softmax(x, dim=axis)

def _gelu(x):
    return torch.nn.functional.gelu(x, approximate='tanh')

def _silu(x):
    return torch.nn.functional.silu(x)

def _sigmoid(x):
    return torch.sigmoid(x)

def _layernorm(x, axis=-1, eps=1e-05):
    m = x.mean(dim=axis, keepdim=True)
    v = x.var(dim=axis, keepdim=True, unbiased=False)
    return (x - m) / torch.sqrt(v + eps)

def _scatter_add(tgt, idx, src, axis=0):
    return tgt.clone().index_add_(axis, idx, src)

def _segment_sum(src, seg, n):
    out = torch.zeros((n,) + src.shape[1:], dtype=src.dtype)
    return out.index_add_(0, seg, src)

def _pad(x, pw):
    flat = tuple((v for pair in reversed(pw) for v in pair))
    return torch.nn.functional.pad(x, flat)
kernel_name = 'adaLN_cond__sliding_local_dilated__glu_gated_swiglu__prompt'

def setup_inputs():

    _w = lambda a: (lambda t: t.to(torch.bfloat16) if t.is_floating_point() else t)(torch.as_tensor(a))

    def _A_setup():
        B, S, D = (1, 2048, 576)
        return {'x': _w((lambda *s: torch.randn(*s, dtype=torch.bfloat16) * 0.05)(B, S, D)), 'wqkv': _w((lambda *s: torch.randn(*s, dtype=torch.bfloat16) * 0.05)(D, 3 * D)), 'wo': _w((lambda *s: torch.randn(*s, dtype=torch.bfloat16) * 0.05)(D, D))}
    _A_in = _A_setup()

    def _B_setup():
        B, S, D, F = (1, 2048, 576, 4608)
        return {'x': _w((lambda *s: torch.randn(*s, dtype=torch.bfloat16) * 0.05)(B, S, D)), 'w1': _w((lambda *s: torch.randn(*s, dtype=torch.bfloat16) * 0.8)(D, F) * (2.0 / D) ** 0.5), 'w3': _w((lambda *s: torch.randn(*s, dtype=torch.bfloat16) * 0.8)(D, F) * (2.0 / D) ** 0.5), 'w2': _w((lambda *s: torch.randn(*s, dtype=torch.bfloat16) * 0.8)(F, D) * (2.0 / F) ** 0.5)}
    _B_in = _B_setup()
    return {'A_x': _A_in['x'], 'A_wqkv': _A_in['wqkv'], 'A_wo': _A_in['wo'], 'B_x': _B_in['x'], 'B_w1': _B_in['w1'], 'B_w3': _B_in['w3'], 'B_w2': _B_in['w2'], 'c': _w((lambda *s: torch.randn(*s, dtype=torch.bfloat16) * 0.1)(1, 576) * 8.0), 'w_mod': _w((lambda *s: torch.randn(*s, dtype=torch.bfloat16) * 0.1)(576, 6 * 576) * 576 ** (-0.5) * 8.0)}

def reference(A_x, A_wqkv, A_wo, B_x, B_w1, B_w3, B_w2, c, w_mod):

    def _A_ref(x, wqkv, wo):
        B, S, D = x.shape
        H = 32
        Dh = D // H
        W, dil = (8, 2)
        qkv = (lambda x, *d: x.permute(*d))((x @ wqkv).reshape(B, S, 3, H, Dh), 2, 0, 3, 1, 4)
        q, k, v = (qkv[0], qkv[1], qkv[2])
        scale = Dh ** (-0.5)
        pos = torch.arange(S)
        off = torch.arange(W) * dil
        idx = pos[:, None] - off[None, :]
        mask = idx >= 0
        idx_c = torch.where(mask, idx, 0).reshape(-1)
        kg = k[:, :, idx_c, :].reshape(B, H, S, W, Dh)
        vg = v[:, :, idx_c, :].reshape(B, H, S, W, Dh)
        logits = torch.einsum('bhsd,bhswd->bhsw', q, kg) * scale
        logits = torch.where(mask[None, None, :, :], logits, -1000000000.0)
        attn = _softmax(logits, axis=-1)
        o = torch.einsum('bhsw,bhswd->bhsd', attn, vg)
        return (lambda x, *d: x.permute(*d))(o, 0, 2, 1, 3).reshape(B, S, D) @ wo

    def _B_ref(x, w1, w3, w2):
        gate = torch.einsum('bsd,df->bsf', x, w1)
        up = torch.einsum('bsd,df->bsf', x, w3)
        h = _silu(gate) * up
        out = torch.einsum('bsf,fd->bsd', h, w2)
        return out
    x = A_x
    mod = (_silu(c) @ w_mod).reshape(c.shape[0], 6, 1, -1)
    sa, ca, ga, sb, cb, gb = (mod[:, 0].clone(), mod[:, 1].clone(), mod[:, 2].clone(), mod[:, 3].clone(), mod[:, 4].clone(), mod[:, 5].clone())
    h = _layernorm(x, axis=-1) * (1 + ca) + sa
    x = x + ga * _A_ref(h, A_wqkv, A_wo)
    h = _layernorm(x, axis=-1) * (1 + cb) + sb
    x = x + gb * _B_ref(h, B_w1, B_w3, B_w2)
    return x
```

```asm
; @launch kernel=prep_kernel grid=(370,1,1) block=(256,1,1) lds=9472
; @launch kernel=qkv_attn_kernel grid=(256,1,1) block=(512,1,1) lds=163840
.amdgcn_target "amdgcn-amd-amdhsa--gfx950"
.text
.globl prep_kernel
.p2align 8
.type prep_kernel,@function
prep_kernel:
    s_cmp_ge_u32 s2, 370
    s_cbranch_scc1 k0_done
    s_load_dwordx2 s[4:5], s[0:1], 0
    s_load_dwordx4 s[16:19], s[0:1], 8
    s_load_dwordx4 s[20:23], s[0:1], 56
    s_load_dwordx2 s[6:7], s[0:1], 88
    v_and_b32 v1, 63, v0
    v_lshrrev_b32 v2, 6, v0
    s_waitcnt lgkmcnt(0)
    s_mov_b32 s12, s6
    s_and_b32 s13, s7, 0xffff
    s_mov_b32 s14, 268435456
    s_mov_b32 s15, 0x00020000
    v_readfirstlane_b32 s3, v2
    s_cmp_ge_u32 s2, 108
    s_cbranch_scc1 k0_not_mod
    v_and_b32 v3, 3, v0
    v_lshrrev_b32 v4, 2, v0
    v_mul_u32_u24 v5, 6912, v4
    v_lshl_add_u32 v5, v3, 4, v5
    s_lshl_b32 s10, s2, 6
    v_add_u32 v5, s10, v5
    v_lshlrev_b32 v6, 1, v4
    global_load_ushort v60, v6, s[20:21] offset:0
    global_load_ushort v61, v6, s[20:21] offset:128
    global_load_ushort v62, v6, s[20:21] offset:256
    global_load_ushort v63, v6, s[20:21] offset:384
    global_load_ushort v64, v6, s[20:21] offset:512
    global_load_ushort v65, v6, s[20:21] offset:640
    global_load_ushort v66, v6, s[20:21] offset:768
    global_load_ushort v67, v6, s[20:21] offset:896
    global_load_ushort v68, v6, s[20:21] offset:1024
    global_load_dwordx4 v[16:19], v5, s[22:23]
    v_add_u32 v5, 442368, v5
    global_load_dwordx4 v[20:23], v5, s[22:23]
    v_add_u32 v5, 442368, v5
    global_load_dwordx4 v[24:27], v5, s[22:23]
    v_add_u32 v5, 442368, v5
    global_load_dwordx4 v[28:31], v5, s[22:23]
    v_add_u32 v5, 442368, v5
    global_load_dwordx4 v[32:35], v5, s[22:23]
    v_add_u32 v5, 442368, v5
    global_load_dwordx4 v[36:39], v5, s[22:23]
    v_add_u32 v5, 442368, v5
    global_load_dwordx4 v[40:43], v5, s[22:23]
    v_add_u32 v5, 442368, v5
    global_load_dwordx4 v[44:47], v5, s[22:23]
    v_add_u32 v5, 442368, v5
    global_load_dwordx4 v[48:51], v5, s[22:23]
    v_mov_b32 v80, 0
    v_mov_b32 v81, 0
    v_mov_b32 v82, 0
    v_mov_b32 v83, 0
    v_mov_b32 v84, 0
    v_mov_b32 v85, 0
    v_mov_b32 v86, 0
    v_mov_b32 v87, 0
    s_waitcnt vmcnt(9)
    v_lshlrev_b32 v60, 16, v60
    v_mul_f32 v70, 0xbfb8aa3b, v60
    v_exp_f32 v70, v70
    s_nop 0
    v_add_f32 v70, 1.0, v70
    v_rcp_f32 v70, v70
    s_nop 0
    v_mul_f32 v60, v60, v70
    v_cvt_pk_bf16_f32 v60, v60, v60
    v_lshlrev_b32 v60, 16, v60
    v_lshlrev_b32 v61, 16, v61
    v_mul_f32 v70, 0xbfb8aa3b, v61
    v_exp_f32 v70, v70
    s_nop 0
    v_add_f32 v70, 1.0, v70
    v_rcp_f32 v70, v70
    s_nop 0
    v_mul_f32 v61, v61, v70
    v_cvt_pk_bf16_f32 v61, v61, v61
    v_lshlrev_b32 v61, 16, v61
    v_lshlrev_b32 v62, 16, v62
    v_mul_f32 v70, 0xbfb8aa3b, v62
    v_exp_f32 v70, v70
    s_nop 0
    v_add_f32 v70, 1.0, v70
    v_rcp_f32 v70, v70
    s_nop 0
    v_mul_f32 v62, v62, v70
    v_cvt_pk_bf16_f32 v62, v62, v62
    v_lshlrev_b32 v62, 16, v62
    v_lshlrev_b32 v63, 16, v63
    v_mul_f32 v70, 0xbfb8aa3b, v63
    v_exp_f32 v70, v70
    s_nop 0
    v_add_f32 v70, 1.0, v70
    v_rcp_f32 v70, v70
    s_nop 0
    v_mul_f32 v63, v63, v70
    v_cvt_pk_bf16_f32 v63, v63, v63
    v_lshlrev_b32 v63, 16, v63
    v_lshlrev_b32 v64, 16, v64
    v_mul_f32 v70, 0xbfb8aa3b, v64
    v_exp_f32 v70, v70
    s_nop 0
    v_add_f32 v70, 1.0, v70
    v_rcp_f32 v70, v70
    s_nop 0
    v_mul_f32 v64, v64, v70
    v_cvt_pk_bf16_f32 v64, v64, v64
    v_lshlrev_b32 v64, 16, v64
    v_lshlrev_b32 v65, 16, v65
    v_mul_f32 v70, 0xbfb8aa3b, v65
    v_exp_f32 v70, v70
    s_nop 0
    v_add_f32 v70, 1.0, v70
    v_rcp_f32 v70, v70
    s_nop 0
    v_mul_f32 v65, v65, v70
    v_cvt_pk_bf16_f32 v65, v65, v65
    v_lshlrev_b32 v65, 16, v65
    v_lshlrev_b32 v66, 16, v66
    v_mul_f32 v70, 0xbfb8aa3b, v66
    v_exp_f32 v70, v70
    s_nop 0
    v_add_f32 v70, 1.0, v70
    v_rcp_f32 v70, v70
    s_nop 0
    v_mul_f32 v66, v66, v70
    v_cvt_pk_bf16_f32 v66, v66, v66
    v_lshlrev_b32 v66, 16, v66
    v_lshlrev_b32 v67, 16, v67
    v_mul_f32 v70, 0xbfb8aa3b, v67
    v_exp_f32 v70, v70
    s_nop 0
    v_add_f32 v70, 1.0, v70
    v_rcp_f32 v70, v70
    s_nop 0
    v_mul_f32 v67, v67, v70
    v_cvt_pk_bf16_f32 v67, v67, v67
    v_lshlrev_b32 v67, 16, v67
    v_lshlrev_b32 v68, 16, v68
    v_mul_f32 v70, 0xbfb8aa3b, v68
    v_exp_f32 v70, v70
    s_nop 0
    v_add_f32 v70, 1.0, v70
    v_rcp_f32 v70, v70
    s_nop 0
    v_mul_f32 v68, v68, v70
    v_cvt_pk_bf16_f32 v68, v68, v68
    v_lshlrev_b32 v68, 16, v68
    s_waitcnt vmcnt(8)
    v_lshlrev_b32 v71, 16, v16
    v_and_b32 v72, 0xffff0000, v16
    v_fmac_f32 v80, v60, v71
    v_fmac_f32 v81, v60, v72
    v_lshlrev_b32 v71, 16, v17
    v_and_b32 v72, 0xffff0000, v17
    v_fmac_f32 v82, v60, v71
    v_fmac_f32 v83, v60, v72
    v_lshlrev_b32 v71, 16, v18
    v_and_b32 v72, 0xffff0000, v18
    v_fmac_f32 v84, v60, v71
    v_fmac_f32 v85, v60, v72
    v_lshlrev_b32 v71, 16, v19
    v_and_b32 v72, 0xffff0000, v19
    v_fmac_f32 v86, v60, v71
    v_fmac_f32 v87, v60, v72
    s_waitcnt vmcnt(7)
    v_lshlrev_b32 v71, 16, v20
    v_and_b32 v72, 0xffff0000, v20
    v_fmac_f32 v80, v61, v71
    v_fmac_f32 v81, v61, v72
    v_lshlrev_b32 v71, 16, v21
    v_and_b32 v72, 0xffff0000, v21
    v_fmac_f32 v82, v61, v71
    v_fmac_f32 v83, v61, v72
    v_lshlrev_b32 v71, 16, v22
    v_and_b32 v72, 0xffff0000, v22
    v_fmac_f32 v84, v61, v71
    v_fmac_f32 v85, v61, v72
    v_lshlrev_b32 v71, 16, v23
    v_and_b32 v72, 0xffff0000, v23
    v_fmac_f32 v86, v61, v71
    v_fmac_f32 v87, v61, v72
    s_waitcnt vmcnt(6)
    v_lshlrev_b32 v71, 16, v24
    v_and_b32 v72, 0xffff0000, v24
    v_fmac_f32 v80, v62, v71
    v_fmac_f32 v81, v62, v72
    v_lshlrev_b32 v71, 16, v25
    v_and_b32 v72, 0xffff0000, v25
    v_fmac_f32 v82, v62, v71
    v_fmac_f32 v83, v62, v72
    v_lshlrev_b32 v71, 16, v26
    v_and_b32 v72, 0xffff0000, v26
    v_fmac_f32 v84, v62, v71
    v_fmac_f32 v85, v62, v72
    v_lshlrev_b32 v71, 16, v27
    v_and_b32 v72, 0xffff0000, v27
    v_fmac_f32 v86, v62, v71
    v_fmac_f32 v87, v62, v72
    s_waitcnt vmcnt(5)
    v_lshlrev_b32 v71, 16, v28
    v_and_b32 v72, 0xffff0000, v28
    v_fmac_f32 v80, v63, v71
    v_fmac_f32 v81, v63, v72
    v_lshlrev_b32 v71, 16, v29
    v_and_b32 v72, 0xffff0000, v29
    v_fmac_f32 v82, v63, v71
    v_fmac_f32 v83, v63, v72
    v_lshlrev_b32 v71, 16, v30
    v_and_b32 v72, 0xffff0000, v30
    v_fmac_f32 v84, v63, v71
    v_fmac_f32 v85, v63, v72
    v_lshlrev_b32 v71, 16, v31
    v_and_b32 v72, 0xffff0000, v31
    v_fmac_f32 v86, v63, v71
    v_fmac_f32 v87, v63, v72
    s_waitcnt vmcnt(4)
    v_lshlrev_b32 v71, 16, v32
    v_and_b32 v72, 0xffff0000, v32
    v_fmac_f32 v80, v64, v71
    v_fmac_f32 v81, v64, v72
    v_lshlrev_b32 v71, 16, v33
    v_and_b32 v72, 0xffff0000, v33
    v_fmac_f32 v82, v64, v71
    v_fmac_f32 v83, v64, v72
    v_lshlrev_b32 v71, 16, v34
    v_and_b32 v72, 0xffff0000, v34
    v_fmac_f32 v84, v64, v71
    v_fmac_f32 v85, v64, v72
    v_lshlrev_b32 v71, 16, v35
    v_and_b32 v72, 0xffff0000, v35
    v_fmac_f32 v86, v64, v71
    v_fmac_f32 v87, v64, v72
    s_waitcnt vmcnt(3)
    v_lshlrev_b32 v71, 16, v36
    v_and_b32 v72, 0xffff0000, v36
    v_fmac_f32 v80, v65, v71
    v_fmac_f32 v81, v65, v72
    v_lshlrev_b32 v71, 16, v37
    v_and_b32 v72, 0xffff0000, v37
    v_fmac_f32 v82, v65, v71
    v_fmac_f32 v83, v65, v72
    v_lshlrev_b32 v71, 16, v38
    v_and_b32 v72, 0xffff0000, v38
    v_fmac_f32 v84, v65, v71
    v_fmac_f32 v85, v65, v72
    v_lshlrev_b32 v71, 16, v39
    v_and_b32 v72, 0xffff0000, v39
    v_fmac_f32 v86, v65, v71
    v_fmac_f32 v87, v65, v72
    s_waitcnt vmcnt(2)
    v_lshlrev_b32 v71, 16, v40
    v_and_b32 v72, 0xffff0000, v40
    v_fmac_f32 v80, v66, v71
    v_fmac_f32 v81, v66, v72
    v_lshlrev_b32 v71, 16, v41
    v_and_b32 v72, 0xffff0000, v41
    v_fmac_f32 v82, v66, v71
    v_fmac_f32 v83, v66, v72
    v_lshlrev_b32 v71, 16, v42
    v_and_b32 v72, 0xffff0000, v42
    v_fmac_f32 v84, v66, v71
    v_fmac_f32 v85, v66, v72
    v_lshlrev_b32 v71, 16, v43
    v_and_b32 v72, 0xffff0000, v43
    v_fmac_f32 v86, v66, v71
    v_fmac_f32 v87, v66, v72
    s_waitcnt vmcnt(1)
    v_lshlrev_b32 v71, 16, v44
    v_and_b32 v72, 0xffff0000, v44
    v_fmac_f32 v80, v67, v71
    v_fmac_f32 v81, v67, v72
    v_lshlrev_b32 v71, 16, v45
    v_and_b32 v72, 0xffff0000, v45
    v_fmac_f32 v82, v67, v71
    v_fmac_f32 v83, v67, v72
    v_lshlrev_b32 v71, 16, v46
    v_and_b32 v72, 0xffff0000, v46
    v_fmac_f32 v84, v67, v71
    v_fmac_f32 v85, v67, v72
    v_lshlrev_b32 v71, 16, v47
    v_and_b32 v72, 0xffff0000, v47
    v_fmac_f32 v86, v67, v71
    v_fmac_f32 v87, v67, v72
    s_waitcnt vmcnt(0)
    v_lshlrev_b32 v71, 16, v48
    v_and_b32 v72, 0xffff0000, v48
    v_fmac_f32 v80, v68, v71
    v_fmac_f32 v81, v68, v72
    v_lshlrev_b32 v71, 16, v49
    v_and_b32 v72, 0xffff0000, v49
    v_fmac_f32 v82, v68, v71
    v_fmac_f32 v83, v68, v72
    v_lshlrev_b32 v71, 16, v50
    v_and_b32 v72, 0xffff0000, v50
    v_fmac_f32 v84, v68, v71
    v_fmac_f32 v85, v68, v72
    v_lshlrev_b32 v71, 16, v51
    v_and_b32 v72, 0xffff0000, v51
    v_fmac_f32 v86, v68, v71
    v_fmac_f32 v87, v68, v72
    v_lshlrev_b32 v7, 5, v0
    ds_write_b128 v7, v[80:83]
    ds_write_b128 v7, v[84:87] offset:16
    s_waitcnt lgkmcnt(0)
    s_barrier
    v_and_b32 v8, 31, v0
    v_lshrrev_b32 v9, 5, v0
    v_lshlrev_b32 v10, 10, v9
    v_lshl_add_u32 v10, v8, 2, v10
    ds_read_b32 v16, v10 offset:0
    ds_read_b32 v17, v10 offset:128
    ds_read_b32 v18, v10 offset:256
    ds_read_b32 v19, v10 offset:384
    ds_read_b32 v20, v10 offset:512
    ds_read_b32 v21, v10 offset:640
    ds_read_b32 v22, v10 offset:768
    ds_read_b32 v23, v10 offset:896
    s_waitcnt lgkmcnt(0)
    v_add_f32 v16, v16, v17
    v_add_f32 v18, v18, v19
    v_add_f32 v20, v20, v21
    v_add_f32 v22, v22, v23
    v_add_f32 v16, v16, v18
    v_add_f32 v20, v20, v22
    v_add_f32 v16, v16, v20
    v_lshlrev_b32 v11, 2, v0
    ds_write_b32 v11, v16 offset:8192
    s_waitcnt lgkmcnt(0)
    s_barrier
    v_cmp_gt_u32 vcc, 32, v0
    s_nop 3
    s_and_saveexec_b64 s[36:37], vcc
    s_cbranch_execz k0_done
    ds_read_b32 v16, v11 offset:8192
    ds_read_b32 v17, v11 offset:8320
    ds_read_b32 v18, v11 offset:8448
    ds_read_b32 v19, v11 offset:8576
    ds_read_b32 v20, v11 offset:8704
    ds_read_b32 v21, v11 offset:8832
    ds_read_b32 v22, v11 offset:8960
    ds_read_b32 v23, v11 offset:9088
    s_waitcnt lgkmcnt(0)
    v_add_f32 v16, v16, v17
    v_add_f32 v18, v18, v19
    v_add_f32 v20, v20, v21
    v_add_f32 v22, v22, v23
    v_add_f32 v16, v16, v18
    v_add_f32 v20, v20, v22
    v_add_f32 v16, v16, v20
    v_cvt_pk_bf16_f32 v16, v16, v16
    v_lshlrev_b32 v16, 16, v16
    s_mov_b32 s11, 0
    s_cmp_ge_u32 s2, 18
    s_cselect_b32 s24, 1, 0
    s_cmp_lt_u32 s2, 36
    s_cselect_b32 s25, 1, 0
    s_and_b32 s24, s24, s25
    s_cmp_ge_u32 s2, 72
    s_cselect_b32 s25, 1, 0
    s_cmp_lt_u32 s2, 90
    s_cselect_b32 s26, 1, 0
    s_and_b32 s25, s25, s26
    s_or_b32 s24, s24, s25
    s_cmp_eq_u32 s24, 0
    s_cbranch_scc1 k0_mod_store
    v_add_f32 v16, 1.0, v16
    v_cvt_pk_bf16_f32 v16, v16, v16
    v_lshlrev_b32 v16, 16, v16
k0_mod_store:
    s_lshl_b32 s10, s2, 8
    s_add_u32 s10, s10, 131072
    v_mov_b32 v17, 0
    buffer_store_dword v17, v11, s[12:15], s10 offen
    s_lshl_b32 s10, s2, 7
    v_add_u32 v11, s10, v11
    buffer_store_dword v16, v11, s[12:15], 0 offen offset:0
    s_cmp_lt_u32 s2, 54
    s_cbranch_scc1 k0_done
    s_cmp_ge_u32 s2, 90
    s_cbranch_scc1 k0_done
    s_sub_u32 s24, s2, 54
    s_sub_u32 s25, s2, 72
    s_cmp_ge_u32 s2, 72
    s_cselect_b32 s24, s25, s24
    s_cselect_b32 s25, 0, 16
    s_lshl_b32 s26, s24, 1
    v_lshrrev_b32 v12, 4, v0
    v_add_u32 v12, s26, v12
    v_mul_u32_u24 v13, 57, v12
    v_lshrrev_b32 v13, 9, v13
    v_mul_u32_u24 v14, 9, v13
    v_sub_u32 v14, v12, v14
    v_lshrrev_b32 v15, 1, v13
    v_mul_u32_u24 v15, 9, v15
    v_and_b32 v17, 1, v13
    v_lshrrev_b32 v18, 1, v14
    v_lshl_add_u32 v18, v17, 2, v18
    v_and_b32 v19, 1, v14
    v_cmp_eq_u32 vcc, 8, v14
    s_nop 1
    v_cndmask_b32 v18, v18, 8, vcc
    v_cndmask_b32 v19, v19, v17, vcc
    v_add_u32 v15, v15, v18
    v_lshlrev_b32 v12, 7, v15
    v_bfe_u32 v13, v0, 2, 2
    v_lshl_add_u32 v12, v13, 5, v12
    v_lshl_add_u32 v12, v19, 3, v12
    v_and_b32 v13, 3, v0
    v_lshl_add_u32 v12, v13, 1, v12
    s_add_u32 s25, s25, 65536
    v_lshrrev_b32 v16, 16, v16
    buffer_store_short v16, v12, s[12:15], s25 offen
    s_branch k0_done
k0_not_mod:
    s_sub_u32 s2, s2, 108
    s_cmp_ge_u32 s2, 64
    s_cbranch_scc1 k0_not_xn
    s_lshl_b32 s10, s2, 2
    s_add_u32 s10, s10, s3
    s_lshl_b32 s10, s10, 3
    v_lshrrev_b32 v3, 3, v1
    v_add_u32 v3, s10, v3
    v_and_b32 v4, 7, v1
    v_mul_u32_u24 v5, 1152, v3
    v_lshl_add_u32 v5, v4, 4, v5
    global_load_dwordx4 v[16:19], v5, s[4:5] offset:0
    global_load_dwordx4 v[20:23], v5, s[4:5] offset:128
    global_load_dwordx4 v[24:27], v5, s[4:5] offset:256
    global_load_dwordx4 v[28:31], v5, s[4:5] offset:384
    global_load_dwordx4 v[32:35], v5, s[4:5] offset:512
    global_load_dwordx4 v[36:39], v5, s[4:5] offset:640
    global_load_dwordx4 v[40:43], v5, s[4:5] offset:768
    global_load_dwordx4 v[44:47], v5, s[4:5] offset:896
    global_load_dwordx4 v[48:51], v5, s[4:5] offset:1024
    v_lshrrev_b32 v6, 4, v3
    v_mul_u32_u24 v6, 18432, v6
    v_and_b32 v7, 15, v3
    v_lshl_add_u32 v6, v7, 4, v6
    v_lshrrev_b32 v7, 2, v4
    v_lshl_add_u32 v6, v7, 10, v6
    v_and_b32 v7, 3, v4
    v_lshl_add_u32 v6, v7, 8, v6
    v_add_u32 v6, 1048576, v6
    v_mov_b32 v8, 0
    v_mov_b32 v9, 0
    s_waitcnt vmcnt(8)
    v_lshlrev_b32 v64, 16, v16
    v_and_b32 v65, 0xffff0000, v16
    v_lshlrev_b32 v66, 16, v17
    v_and_b32 v67, 0xffff0000, v17
    v_lshlrev_b32 v68, 16, v18
    v_and_b32 v69, 0xffff0000, v18
    v_lshlrev_b32 v70, 16, v19
    v_and_b32 v71, 0xffff0000, v19
    v_add_f32 v8, v8, v64
    v_add_f32 v9, v9, v65
    v_add_f32 v8, v8, v66
    v_add_f32 v9, v9, v67
    v_add_f32 v8, v8, v68
    v_add_f32 v9, v9, v69
    v_add_f32 v8, v8, v70
    v_add_f32 v9, v9, v71
    s_waitcnt vmcnt(7)
    v_lshlrev_b32 v72, 16, v20
    v_and_b32 v73, 0xffff0000, v20
    v_lshlrev_b32 v74, 16, v21
    v_and_b32 v75, 0xffff0000, v21
    v_lshlrev_b32 v76, 16, v22
    v_and_b32 v77, 0xffff0000, v22
    v_lshlrev_b32 v78, 16, v23
    v_and_b32 v79, 0xffff0000, v23
    v_add_f32 v8, v8, v72
    v_add_f32 v9, v9, v73
    v_add_f32 v8, v8, v74
    v_add_f32 v9, v9, v75
    v_add_f32 v8, v8, v76
    v_add_f32 v9, v9, v77
    v_add_f32 v8, v8, v78
    v_add_f32 v9, v9, v79
    s_waitcnt vmcnt(6)
    v_lshlrev_b32 v80, 16, v24
    v_and_b32 v81, 0xffff0000, v24
    v_lshlrev_b32 v82, 16, v25
    v_and_b32 v83, 0xffff0000, v25
    v_lshlrev_b32 v84, 16, v26
    v_and_b32 v85, 0xffff0000, v26
    v_lshlrev_b32 v86, 16, v27
    v_and_b32 v87, 0xffff0000, v27
    v_add_f32 v8, v8, v80
    v_add_f32 v9, v9, v81
    v_add_f32 v8, v8, v82
    v_add_f32 v9, v9, v83
    v_add_f32 v8, v8, v84
    v_add_f32 v9, v9, v85
    v_add_f32 v8, v8, v86
    v_add_f32 v9, v9, v87
    s_waitcnt vmcnt(5)
    v_lshlrev_b32 v88, 16, v28
    v_and_b32 v89, 0xffff0000, v28
    v_lshlrev_b32 v90, 16, v29
    v_and_b32 v91, 0xffff0000, v29
    v_lshlrev_b32 v92, 16, v30
    v_and_b32 v93, 0xffff0000, v30
    v_lshlrev_b32 v94, 16, v31
    v_and_b32 v95, 0xffff0000, v31
    v_add_f32 v8, v8, v88
    v_add_f32 v9, v9, v89
    v_add_f32 v8, v8, v90
    v_add_f32 v9, v9, v91
    v_add_f32 v8, v8, v92
    v_add_f32 v9, v9, v93
    v_add_f32 v8, v8, v94
    v_add_f32 v9, v9, v95
    s_waitcnt vmcnt(4)
    v_lshlrev_b32 v96, 16, v32
    v_and_b32 v97, 0xffff0000, v32
    v_lshlrev_b32 v98, 16, v33
    v_and_b32 v99, 0xffff0000, v33
    v_lshlrev_b32 v100, 16, v34
    v_and_b32 v101, 0xffff0000, v34
    v_lshlrev_b32 v102, 16, v35
    v_and_b32 v103, 0xffff0000, v35
    v_add_f32 v8, v8, v96
    v_add_f32 v9, v9, v97
    v_add_f32 v8, v8, v98
    v_add_f32 v9, v9, v99
    v_add_f32 v8, v8, v100
    v_add_f32 v9, v9, v101
    v_add_f32 v8, v8, v102
    v_add_f32 v9, v9, v103
    s_waitcnt vmcnt(3)
    v_lshlrev_b32 v104, 16, v36
    v_and_b32 v105, 0xffff0000, v36
    v_lshlrev_b32 v106, 16, v37
    v_and_b32 v107, 0xffff0000, v37
    v_lshlrev_b32 v108, 16, v38
    v_and_b32 v109, 0xffff0000, v38
    v_lshlrev_b32 v110, 16, v39
    v_and_b32 v111, 0xffff0000, v39
    v_add_f32 v8, v8, v104
    v_add_f32 v9, v9, v105
    v_add_f32 v8, v8, v106
    v_add_f32 v9, v9, v107
    v_add_f32 v8, v8, v108
    v_add_f32 v9, v9, v109
    v_add_f32 v8, v8, v110
    v_add_f32 v9, v9, v111
    s_waitcnt vmcnt(2)
    v_lshlrev_b32 v112, 16, v40
    v_and_b32 v113, 0xffff0000, v40
    v_lshlrev_b32 v114, 16, v41
    v_and_b32 v115, 0xffff0000, v41
    v_lshlrev_b32 v116, 16, v42
    v_and_b32 v117, 0xffff0000, v42
    v_lshlrev_b32 v118, 16, v43
    v_and_b32 v119, 0xffff0000, v43
    v_add_f32 v8, v8, v112
    v_add_f32 v9, v9, v113
    v_add_f32 v8, v8, v114
    v_add_f32 v9, v9, v115
    v_add_f32 v8, v8, v116
    v_add_f32 v9, v9, v117
    v_add_f32 v8, v8, v118
    v_add_f32 v9, v9, v119
    s_waitcnt vmcnt(1)
    v_lshlrev_b32 v120, 16, v44
    v_and_b32 v121, 0xffff0000, v44
    v_lshlrev_b32 v122, 16, v45
    v_and_b32 v123, 0xffff0000, v45
    v_lshlrev_b32 v124, 16, v46
    v_and_b32 v125, 0xffff0000, v46
    v_lshlrev_b32 v126, 16, v47
    v_and_b32 v127, 0xffff0000, v47
    v_add_f32 v8, v8, v120
    v_add_f32 v9, v9, v121
    v_add_f32 v8, v8, v122
    v_add_f32 v9, v9, v123
    v_add_f32 v8, v8, v124
    v_add_f32 v9, v9, v125
    v_add_f32 v8, v8, v126
    v_add_f32 v9, v9, v127
    s_waitcnt vmcnt(0)
    v_lshlrev_b32 v128, 16, v48
    v_and_b32 v129, 0xffff0000, v48
    v_lshlrev_b32 v130, 16, v49
    v_and_b32 v131, 0xffff0000, v49
    v_lshlrev_b32 v132, 16, v50
    v_and_b32 v133, 0xffff0000, v50
    v_lshlrev_b32 v134, 16, v51
    v_and_b32 v135, 0xffff0000, v51
    v_add_f32 v8, v8, v128
    v_add_f32 v9, v9, v129
    v_add_f32 v8, v8, v130
    v_add_f32 v9, v9, v131
    v_add_f32 v8, v8, v132
    v_add_f32 v9, v9, v133
    v_add_f32 v8, v8, v134
    v_add_f32 v9, v9, v135
    v_add_f32 v8, v8, v9
    s_nop 1
    v_add_f32_dpp v8, v8, v8 quad_perm:[1,0,3,2] row_mask:0xf bank_mask:0xf
    s_nop 1
    v_add_f32_dpp v8, v8, v8 quad_perm:[2,3,0,1] row_mask:0xf bank_mask:0xf
    s_nop 1
    v_add_f32_dpp v8, v8, v8 row_half_mirror row_mask:0xf bank_mask:0xf
    v_mul_f32 v10, 0x3ae38e39, v8
    v_mov_b32 v11, v10
    v_mov_b32 v8, 0
    v_mov_b32 v9, 0
    v_sub_f32 v12, v64, v10
    v_sub_f32 v13, v65, v11
    v_fma_f32 v8, v12, v12, v8
    v_fma_f32 v9, v13, v13, v9
    v_sub_f32 v12, v66, v10
    v_sub_f32 v13, v67, v11
    v_fma_f32 v8, v12, v12, v8
    v_fma_f32 v9, v13, v13, v9
    v_sub_f32 v12, v68, v10
    v_sub_f32 v13, v69, v11
    v_fma_f32 v8, v12, v12, v8
    v_fma_f32 v9, v13, v13, v9
    v_sub_f32 v12, v70, v10
    v_sub_f32 v13, v71, v11
    v_fma_f32 v8, v12, v12, v8
    v_fma_f32 v9, v13, v13, v9
    v_sub_f32 v12, v72, v10
    v_sub_f32 v13, v73, v11
    v_fma_f32 v8, v12, v12, v8
    v_fma_f32 v9, v13, v13, v9
    v_sub_f32 v12, v74, v10
    v_sub_f32 v13, v75, v11
    v_fma_f32 v8, v12, v12, v8
    v_fma_f32 v9, v13, v13, v9
    v_sub_f32 v12, v76, v10
    v_sub_f32 v13, v77, v11
    v_fma_f32 v8, v12, v12, v8
    v_fma_f32 v9, v13, v13, v9
    v_sub_f32 v12, v78, v10
    v_sub_f32 v13, v79, v11
    v_fma_f32 v8, v12, v12, v8
    v_fma_f32 v9, v13, v13, v9
    v_sub_f32 v12, v80, v10
    v_sub_f32 v13, v81, v11
    v_fma_f32 v8, v12, v12, v8
    v_fma_f32 v9, v13, v13, v9
    v_sub_f32 v12, v82, v10
    v_sub_f32 v13, v83, v11
    v_fma_f32 v8, v12, v12, v8
    v_fma_f32 v9, v13, v13, v9
    v_sub_f32 v12, v84, v10
    v_sub_f32 v13, v85, v11
    v_fma_f32 v8, v12, v12, v8
    v_fma_f32 v9, v13, v13, v9
    v_sub_f32 v12, v86, v10
    v_sub_f32 v13, v87, v11
    v_fma_f32 v8, v12, v12, v8
    v_fma_f32 v9, v13, v13, v9
    v_sub_f32 v12, v88, v10
    v_sub_f32 v13, v89, v11
    v_fma_f32 v8, v12, v12, v8
    v_fma_f32 v9, v13, v13, v9
    v_sub_f32 v12, v90, v10
    v_sub_f32 v13, v91, v11
    v_fma_f32 v8, v12, v12, v8
    v_fma_f32 v9, v13, v13, v9
    v_sub_f32 v12, v92, v10
    v_sub_f32 v13, v93, v11
    v_fma_f32 v8, v12, v12, v8
    v_fma_f32 v9, v13, v13, v9
    v_sub_f32 v12, v94, v10
    v_sub_f32 v13, v95, v11
    v_fma_f32 v8, v12, v12, v8
    v_fma_f32 v9, v13, v13, v9
    v_sub_f32 v12, v96, v10
    v_sub_f32 v13, v97, v11
    v_fma_f32 v8, v12, v12, v8
    v_fma_f32 v9, v13, v13, v9
    v_sub_f32 v12, v98, v10
    v_sub_f32 v13, v99, v11
    v_fma_f32 v8, v12, v12, v8
    v_fma_f32 v9, v13, v13, v9
    v_sub_f32 v12, v100, v10
    v_sub_f32 v13, v101, v11
    v_fma_f32 v8, v12, v12, v8
    v_fma_f32 v9, v13, v13, v9
    v_sub_f32 v12, v102, v10
    v_sub_f32 v13, v103, v11
    v_fma_f32 v8, v12, v12, v8
    v_fma_f32 v9, v13, v13, v9
    v_sub_f32 v12, v104, v10
    v_sub_f32 v13, v105, v11
    v_fma_f32 v8, v12, v12, v8
    v_fma_f32 v9, v13, v13, v9
    v_sub_f32 v12, v106, v10
    v_sub_f32 v13, v107, v11
    v_fma_f32 v8, v12, v12, v8
    v_fma_f32 v9, v13, v13, v9
    v_sub_f32 v12, v108, v10
    v_sub_f32 v13, v109, v11
    v_fma_f32 v8, v12, v12, v8
    v_fma_f32 v9, v13, v13, v9
    v_sub_f32 v12, v110, v10
    v_sub_f32 v13, v111, v11
    v_fma_f32 v8, v12, v12, v8
    v_fma_f32 v9, v13, v13, v9
    v_sub_f32 v12, v112, v10
    v_sub_f32 v13, v113, v11
    v_fma_f32 v8, v12, v12, v8
    v_fma_f32 v9, v13, v13, v9
    v_sub_f32 v12, v114, v10
    v_sub_f32 v13, v115, v11
    v_fma_f32 v8, v12, v12, v8
    v_fma_f32 v9, v13, v13, v9
    v_sub_f32 v12, v116, v10
    v_sub_f32 v13, v117, v11
    v_fma_f32 v8, v12, v12, v8
    v_fma_f32 v9, v13, v13, v9
    v_sub_f32 v12, v118, v10
    v_sub_f32 v13, v119, v11
    v_fma_f32 v8, v12, v12, v8
    v_fma_f32 v9, v13, v13, v9
    v_sub_f32 v12, v120, v10
    v_sub_f32 v13, v121, v11
    v_fma_f32 v8, v12, v12, v8
    v_fma_f32 v9, v13, v13, v9
    v_sub_f32 v12, v122, v10
    v_sub_f32 v13, v123, v11
    v_fma_f32 v8, v12, v12, v8
    v_fma_f32 v9, v13, v13, v9
    v_sub_f32 v12, v124, v10
    v_sub_f32 v13, v125, v11
    v_fma_f32 v8, v12, v12, v8
    v_fma_f32 v9, v13, v13, v9
    v_sub_f32 v12, v126, v10
    v_sub_f32 v13, v127, v11
    v_fma_f32 v8, v12, v12, v8
    v_fma_f32 v9, v13, v13, v9
    v_sub_f32 v12, v128, v10
    v_sub_f32 v13, v129, v11
    v_fma_f32 v8, v12, v12, v8
    v_fma_f32 v9, v13, v13, v9
    v_sub_f32 v12, v130, v10
    v_sub_f32 v13, v131, v11
    v_fma_f32 v8, v12, v12, v8
    v_fma_f32 v9, v13, v13, v9
    v_sub_f32 v12, v132, v10
    v_sub_f32 v13, v133, v11
    v_fma_f32 v8, v12, v12, v8
    v_fma_f32 v9, v13, v13, v9
    v_sub_f32 v12, v134, v10
    v_sub_f32 v13, v135, v11
    v_fma_f32 v8, v12, v12, v8
    v_fma_f32 v9, v13, v13, v9
    v_add_f32 v8, v8, v9
    s_nop 1
    v_add_f32_dpp v8, v8, v8 quad_perm:[1,0,3,2] row_mask:0xf bank_mask:0xf
    s_nop 1
    v_add_f32_dpp v8, v8, v8 quad_perm:[2,3,0,1] row_mask:0xf bank_mask:0xf
    s_nop 1
    v_add_f32_dpp v8, v8, v8 row_half_mirror row_mask:0xf bank_mask:0xf
    v_mul_f32 v8, 0x3ae38e39, v8
    v_cvt_pk_bf16_f32 v8, v8, v8
    v_lshlrev_b32 v8, 16, v8
    v_add_f32 v8, 0x3727c5ac, v8
    v_cvt_pk_bf16_f32 v8, v8, v8
    v_lshlrev_b32 v8, 16, v8
    v_sqrt_f32 v8, v8
    s_nop 0
    v_cvt_pk_bf16_f32 v8, v8, v8
    v_lshlrev_b32 v8, 16, v8
    v_rcp_f32 v8, v8
    v_cvt_pk_bf16_f32 v10, v10, v10
    v_lshlrev_b32 v10, 16, v10
    v_mov_b32 v11, v10
    v_mov_b32 v9, v8
    v_sub_f32 v12, v64, v10
    v_sub_f32 v13, v65, v11
    v_cvt_pk_bf16_f32 v14, v12, v13
    v_lshlrev_b32 v12, 16, v14
    v_and_b32 v13, 0xffff0000, v14
    v_mul_f32 v12, v12, v8
    v_mul_f32 v13, v13, v9
    v_cvt_pk_bf16_f32 v16, v12, v13
    v_sub_f32 v12, v66, v10
    v_sub_f32 v13, v67, v11
    v_cvt_pk_bf16_f32 v14, v12, v13
    v_lshlrev_b32 v12, 16, v14
    v_and_b32 v13, 0xffff0000, v14
    v_mul_f32 v12, v12, v8
    v_mul_f32 v13, v13, v9
    v_cvt_pk_bf16_f32 v17, v12, v13
    v_sub_f32 v12, v68, v10
    v_sub_f32 v13, v69, v11
    v_cvt_pk_bf16_f32 v14, v12, v13
    v_lshlrev_b32 v12, 16, v14
    v_and_b32 v13, 0xffff0000, v14
    v_mul_f32 v12, v12, v8
    v_mul_f32 v13, v13, v9
    v_cvt_pk_bf16_f32 v18, v12, v13
    v_sub_f32 v12, v70, v10
    v_sub_f32 v13, v71, v11
    v_cvt_pk_bf16_f32 v14, v12, v13
    v_lshlrev_b32 v12, 16, v14
    v_and_b32 v13, 0xffff0000, v14
    v_mul_f32 v12, v12, v8
    v_mul_f32 v13, v13, v9
    v_cvt_pk_bf16_f32 v19, v12, v13
    buffer_store_dwordx4 v[16:19], v6, s[12:15], 0 offen offset:0
    v_sub_f32 v12, v72, v10
    v_sub_f32 v13, v73, v11
    v_cvt_pk_bf16_f32 v14, v12, v13
    v_lshlrev_b32 v12, 16, v14
    v_and_b32 v13, 0xffff0000, v14
    v_mul_f32 v12, v12, v8
    v_mul_f32 v13, v13, v9
    v_cvt_pk_bf16_f32 v20, v12, v13
    v_sub_f32 v12, v74, v10
    v_sub_f32 v13, v75, v11
    v_cvt_pk_bf16_f32 v14, v12, v13
    v_lshlrev_b32 v12, 16, v14
    v_and_b32 v13, 0xffff0000, v14
    v_mul_f32 v12, v12, v8
    v_mul_f32 v13, v13, v9
    v_cvt_pk_bf16_f32 v21, v12, v13
    v_sub_f32 v12, v76, v10
    v_sub_f32 v13, v77, v11
    v_cvt_pk_bf16_f32 v14, v12, v13
    v_lshlrev_b32 v12, 16, v14
    v_and_b32 v13, 0xffff0000, v14
    v_mul_f32 v12, v12, v8
    v_mul_f32 v13, v13, v9
    v_cvt_pk_bf16_f32 v22, v12, v13
    v_sub_f32 v12, v78, v10
    v_sub_f32 v13, v79, v11
    v_cvt_pk_bf16_f32 v14, v12, v13
    v_lshlrev_b32 v12, 16, v14
    v_and_b32 v13, 0xffff0000, v14
    v_mul_f32 v12, v12, v8
    v_mul_f32 v13, v13, v9
    v_cvt_pk_bf16_f32 v23, v12, v13
    buffer_store_dwordx4 v[20:23], v6, s[12:15], 0 offen offset:2048
    v_add_u32 v6, 4096, v6
    v_sub_f32 v12, v80, v10
    v_sub_f32 v13, v81, v11
    v_cvt_pk_bf16_f32 v14, v12, v13
    v_lshlrev_b32 v12, 16, v14
    v_and_b32 v13, 0xffff0000, v14
    v_mul_f32 v12, v12, v8
    v_mul_f32 v13, v13, v9
    v_cvt_pk_bf16_f32 v24, v12, v13
    v_sub_f32 v12, v82, v10
    v_sub_f32 v13, v83, v11
    v_cvt_pk_bf16_f32 v14, v12, v13
    v_lshlrev_b32 v12, 16, v14
    v_and_b32 v13, 0xffff0000, v14
    v_mul_f32 v12, v12, v8
    v_mul_f32 v13, v13, v9
    v_cvt_pk_bf16_f32 v25, v12, v13
    v_sub_f32 v12, v84, v10
    v_sub_f32 v13, v85, v11
    v_cvt_pk_bf16_f32 v14, v12, v13
    v_lshlrev_b32 v12, 16, v14
    v_and_b32 v13, 0xffff0000, v14
    v_mul_f32 v12, v12, v8
    v_mul_f32 v13, v13, v9
    v_cvt_pk_bf16_f32 v26, v12, v13
    v_sub_f32 v12, v86, v10
    v_sub_f32 v13, v87, v11
    v_cvt_pk_bf16_f32 v14, v12, v13
    v_lshlrev_b32 v12, 16, v14
    v_and_b32 v13, 0xffff0000, v14
    v_mul_f32 v12, v12, v8
    v_mul_f32 v13, v13, v9
    v_cvt_pk_bf16_f32 v27, v12, v13
    buffer_store_dwordx4 v[24:27], v6, s[12:15], 0 offen offset:0
    v_sub_f32 v12, v88, v10
    v_sub_f32 v13, v89, v11
    v_cvt_pk_bf16_f32 v14, v12, v13
    v_lshlrev_b32 v12, 16, v14
    v_and_b32 v13, 0xffff0000, v14
    v_mul_f32 v12, v12, v8
    v_mul_f32 v13, v13, v9
    v_cvt_pk_bf16_f32 v28, v12, v13
    v_sub_f32 v12, v90, v10
    v_sub_f32 v13, v91, v11
    v_cvt_pk_bf16_f32 v14, v12, v13
    v_lshlrev_b32 v12, 16, v14
    v_and_b32 v13, 0xffff0000, v14
    v_mul_f32 v12, v12, v8
    v_mul_f32 v13, v13, v9
    v_cvt_pk_bf16_f32 v29, v12, v13
    v_sub_f32 v12, v92, v10
    v_sub_f32 v13, v93, v11
    v_cvt_pk_bf16_f32 v14, v12, v13
    v_lshlrev_b32 v12, 16, v14
    v_and_b32 v13, 0xffff0000, v14
    v_mul_f32 v12, v12, v8
    v_mul_f32 v13, v13, v9
    v_cvt_pk_bf16_f32 v30, v12, v13
    v_sub_f32 v12, v94, v10
    v_sub_f32 v13, v95, v11
    v_cvt_pk_bf16_f32 v14, v12, v13
    v_lshlrev_b32 v12, 16, v14
    v_and_b32 v13, 0xffff0000, v14
    v_mul_f32 v12, v12, v8
    v_mul_f32 v13, v13, v9
    v_cvt_pk_bf16_f32 v31, v12, v13
    buffer_store_dwordx4 v[28:31], v6, s[12:15], 0 offen offset:2048
    v_add_u32 v6, 4096, v6
    v_sub_f32 v12, v96, v10
    v_sub_f32 v13, v97, v11
    v_cvt_pk_bf16_f32 v14, v12, v13
    v_lshlrev_b32 v12, 16, v14
    v_and_b32 v13, 0xffff0000, v14
    v_mul_f32 v12, v12, v8
    v_mul_f32 v13, v13, v9
    v_cvt_pk_bf16_f32 v32, v12, v13
    v_sub_f32 v12, v98, v10
    v_sub_f32 v13, v99, v11
    v_cvt_pk_bf16_f32 v14, v12, v13
    v_lshlrev_b32 v12, 16, v14
    v_and_b32 v13, 0xffff0000, v14
    v_mul_f32 v12, v12, v8
    v_mul_f32 v13, v13, v9
    v_cvt_pk_bf16_f32 v33, v12, v13
    v_sub_f32 v12, v100, v10
    v_sub_f32 v13, v101, v11
    v_cvt_pk_bf16_f32 v14, v12, v13
    v_lshlrev_b32 v12, 16, v14
    v_and_b32 v13, 0xffff0000, v14
    v_mul_f32 v12, v12, v8
    v_mul_f32 v13, v13, v9
    v_cvt_pk_bf16_f32 v34, v12, v13
    v_sub_f32 v12, v102, v10
    v_sub_f32 v13, v103, v11
    v_cvt_pk_bf16_f32 v14, v12, v13
    v_lshlrev_b32 v12, 16, v14
    v_and_b32 v13, 0xffff0000, v14
    v_mul_f32 v12, v12, v8
    v_mul_f32 v13, v13, v9
    v_cvt_pk_bf16_f32 v35, v12, v13
    buffer_store_dwordx4 v[32:35], v6, s[12:15], 0 offen offset:0
    v_sub_f32 v12, v104, v10
    v_sub_f32 v13, v105, v11
    v_cvt_pk_bf16_f32 v14, v12, v13
    v_lshlrev_b32 v12, 16, v14
    v_and_b32 v13, 0xffff0000, v14
    v_mul_f32 v12, v12, v8
    v_mul_f32 v13, v13, v9
    v_cvt_pk_bf16_f32 v36, v12, v13
    v_sub_f32 v12, v106, v10
    v_sub_f32 v13, v107, v11
    v_cvt_pk_bf16_f32 v14, v12, v13
    v_lshlrev_b32 v12, 16, v14
    v_and_b32 v13, 0xffff0000, v14
    v_mul_f32 v12, v12, v8
    v_mul_f32 v13, v13, v9
    v_cvt_pk_bf16_f32 v37, v12, v13
    v_sub_f32 v12, v108, v10
    v_sub_f32 v13, v109, v11
    v_cvt_pk_bf16_f32 v14, v12, v13
    v_lshlrev_b32 v12, 16, v14
    v_and_b32 v13, 0xffff0000, v14
    v_mul_f32 v12, v12, v8
    v_mul_f32 v13, v13, v9
    v_cvt_pk_bf16_f32 v38, v12, v13
    v_sub_f32 v12, v110, v10
    v_sub_f32 v13, v111, v11
    v_cvt_pk_bf16_f32 v14, v12, v13
    v_lshlrev_b32 v12, 16, v14
    v_and_b32 v13, 0xffff0000, v14
    v_mul_f32 v12, v12, v8
    v_mul_f32 v13, v13, v9
    v_cvt_pk_bf16_f32 v39, v12, v13
    buffer_store_dwordx4 v[36:39], v6, s[12:15], 0 offen offset:2048
    v_add_u32 v6, 4096, v6
    v_sub_f32 v12, v112, v10
    v_sub_f32 v13, v113, v11
    v_cvt_pk_bf16_f32 v14, v12, v13
    v_lshlrev_b32 v12, 16, v14
    v_and_b32 v13, 0xffff0000, v14
    v_mul_f32 v12, v12, v8
    v_mul_f32 v13, v13, v9
    v_cvt_pk_bf16_f32 v40, v12, v13
    v_sub_f32 v12, v114, v10
    v_sub_f32 v13, v115, v11
    v_cvt_pk_bf16_f32 v14, v12, v13
    v_lshlrev_b32 v12, 16, v14
    v_and_b32 v13, 0xffff0000, v14
    v_mul_f32 v12, v12, v8
    v_mul_f32 v13, v13, v9
    v_cvt_pk_bf16_f32 v41, v12, v13
    v_sub_f32 v12, v116, v10
    v_sub_f32 v13, v117, v11
    v_cvt_pk_bf16_f32 v14, v12, v13
    v_lshlrev_b32 v12, 16, v14
    v_and_b32 v13, 0xffff0000, v14
    v_mul_f32 v12, v12, v8
    v_mul_f32 v13, v13, v9
    v_cvt_pk_bf16_f32 v42, v12, v13
    v_sub_f32 v12, v118, v10
    v_sub_f32 v13, v119, v11
    v_cvt_pk_bf16_f32 v14, v12, v13
    v_lshlrev_b32 v12, 16, v14
    v_and_b32 v13, 0xffff0000, v14
    v_mul_f32 v12, v12, v8
    v_mul_f32 v13, v13, v9
    v_cvt_pk_bf16_f32 v43, v12, v13
    buffer_store_dwordx4 v[40:43], v6, s[12:15], 0 offen offset:0
    v_sub_f32 v12, v120, v10
    v_sub_f32 v13, v121, v11
    v_cvt_pk_bf16_f32 v14, v12, v13
    v_lshlrev_b32 v12, 16, v14
    v_and_b32 v13, 0xffff0000, v14
    v_mul_f32 v12, v12, v8
    v_mul_f32 v13, v13, v9
    v_cvt_pk_bf16_f32 v44, v12, v13
    v_sub_f32 v12, v122, v10
    v_sub_f32 v13, v123, v11
    v_cvt_pk_bf16_f32 v14, v12, v13
    v_lshlrev_b32 v12, 16, v14
    v_and_b32 v13, 0xffff0000, v14
    v_mul_f32 v12, v12, v8
    v_mul_f32 v13, v13, v9
    v_cvt_pk_bf16_f32 v45, v12, v13
    v_sub_f32 v12, v124, v10
    v_sub_f32 v13, v125, v11
    v_cvt_pk_bf16_f32 v14, v12, v13
    v_lshlrev_b32 v12, 16, v14
    v_and_b32 v13, 0xffff0000, v14
    v_mul_f32 v12, v12, v8
    v_mul_f32 v13, v13, v9
    v_cvt_pk_bf16_f32 v46, v12, v13
    v_sub_f32 v12, v126, v10
    v_sub_f32 v13, v127, v11
    v_cvt_pk_bf16_f32 v14, v12, v13
    v_lshlrev_b32 v12, 16, v14
    v_and_b32 v13, 0xffff0000, v14
    v_mul_f32 v12, v12, v8
    v_mul_f32 v13, v13, v9
    v_cvt_pk_bf16_f32 v47, v12, v13
    buffer_store_dwordx4 v[44:47], v6, s[12:15], 0 offen offset:2048
    v_add_u32 v6, 4096, v6
    v_sub_f32 v12, v128, v10
    v_sub_f32 v13, v129, v11
    v_cvt_pk_bf16_f32 v14, v12, v13
    v_lshlrev_b32 v12, 16, v14
    v_and_b32 v13, 0xffff0000, v14
    v_mul_f32 v12, v12, v8
    v_mul_f32 v13, v13, v9
    v_cvt_pk_bf16_f32 v48, v12, v13
    v_sub_f32 v12, v130, v10
    v_sub_f32 v13, v131, v11
    v_cvt_pk_bf16_f32 v14, v12, v13
    v_lshlrev_b32 v12, 16, v14
    v_and_b32 v13, 0xffff0000, v14
    v_mul_f32 v12, v12, v8
    v_mul_f32 v13, v13, v9
    v_cvt_pk_bf16_f32 v49, v12, v13
    v_sub_f32 v12, v132, v10
    v_sub_f32 v13, v133, v11
    v_cvt_pk_bf16_f32 v14, v12, v13
    v_lshlrev_b32 v12, 16, v14
    v_and_b32 v13, 0xffff0000, v14
    v_mul_f32 v12, v12, v8
    v_mul_f32 v13, v13, v9
    v_cvt_pk_bf16_f32 v50, v12, v13
    v_sub_f32 v12, v134, v10
    v_sub_f32 v13, v135, v11
    v_cvt_pk_bf16_f32 v14, v12, v13
    v_lshlrev_b32 v12, 16, v14
    v_and_b32 v13, 0xffff0000, v14
    v_mul_f32 v12, v12, v8
    v_mul_f32 v13, v13, v9
    v_cvt_pk_bf16_f32 v51, v12, v13
    buffer_store_dwordx4 v[48:51], v6, s[12:15], 0 offen offset:0
    s_branch k0_done
k0_not_xn:
    s_sub_u32 s2, s2, 64
    s_cmp_ge_u32 s2, 144
    s_cbranch_scc1 k0_not_wq
    s_mov_b32 s8, s16
    s_and_b32 s9, s17, 0xffff
    s_mov_b32 s10, 1990656
    s_mov_b32 s11, 0x00020000
    s_lshl_b32 s10, s2, 2
    s_add_u32 s34, s10, s3
    s_mov_b32 s10, 1990656
    s_and_b32 s35, s34, 7
    s_lshr_b32 s38, s34, 3
    v_cmp_gt_u32 vcc, 60, v1
    s_nop 3
    s_and_saveexec_b64 s[36:37], vcc
    v_mul_u32_u24 v3, 13, v1
    v_lshrrev_b32 v3, 8, v3
    v_mul_u32_u24 v4, 20, v3
    v_sub_u32 v4, v1, v4
    v_mul_u32_u24 v5, 13, v4
    v_lshrrev_b32 v5, 6, v5
    v_mul_u32_u24 v6, 5, v5
    v_sub_u32 v6, v4, v6
    v_cmp_eq_u32 s[40:41], 4, v6
    v_mul_u32_u24 v10, 1152, v3
    v_mul_u32_u24 v7, 36, v5
    v_add_u32 v10, v10, v7
    v_lshl_add_u32 v10, v6, 3, v10
    s_mul_i32 s39, s35, 144
    s_mul_i32 s42, s38, 27648
    s_add_u32 s39, s39, s42
    v_add_u32 v10, s39, v10
    v_lshrrev_b32 v7, 2, v1
    v_mul_u32_u24 v11, 18432, v7
    v_and_b32 v7, 3, v1
    v_lshl_add_u32 v11, v7, 6, v11
    s_mul_i32 s39, s35, 294912
    s_lshr_b32 s42, s38, 2
    s_lshl_b32 s42, s42, 10
    s_add_u32 s39, s39, s42
    s_and_b32 s42, s38, 3
    s_lshl_b32 s42, s42, 8
    s_add_u32 s39, s39, s42
    s_add_u32 s39, s39, 4194304
    v_add_u32 v11, s39, v11
    s_mov_b32 s24, 0
    s_mov_b32 s25, 3456
    s_mov_b32 s26, 6912
    s_mov_b32 s27, 10368
    s_mov_b32 s28, 13824
    s_mov_b32 s29, 17280
    s_mov_b32 s30, 20736
    s_mov_b32 s31, 24192
    buffer_load_dwordx2 v[16:17], v10, s[8:11], s24 offen
    buffer_load_dwordx2 v[18:19], v10, s[8:11], s25 offen
    buffer_load_dwordx2 v[20:21], v10, s[8:11], s26 offen
    buffer_load_dwordx2 v[22:23], v10, s[8:11], s27 offen
    buffer_load_dwordx2 v[24:25], v10, s[8:11], s28 offen
    buffer_load_dwordx2 v[26:27], v10, s[8:11], s29 offen
    buffer_load_dwordx2 v[28:29], v10, s[8:11], s30 offen
    buffer_load_dwordx2 v[30:31], v10, s[8:11], s31 offen
    s_mov_b32 s32, 0x05040100
    s_mov_b32 s33, 0x07060302
    s_waitcnt vmcnt(0)
    v_cndmask_b32 v17, v17, 0, s[40:41]
    v_cndmask_b32 v19, v19, 0, s[40:41]
    v_cndmask_b32 v21, v21, 0, s[40:41]
    v_cndmask_b32 v23, v23, 0, s[40:41]
    v_cndmask_b32 v25, v25, 0, s[40:41]
    v_cndmask_b32 v27, v27, 0, s[40:41]
    v_cndmask_b32 v29, v29, 0, s[40:41]
    v_cndmask_b32 v31, v31, 0, s[40:41]
    v_perm_b32 v32, v18, v16, s32
    v_perm_b32 v33, v22, v20, s32
    v_perm_b32 v34, v26, v24, s32
    v_perm_b32 v35, v30, v28, s32
    v_perm_b32 v36, v18, v16, s33
    v_perm_b32 v37, v22, v20, s33
    v_perm_b32 v38, v26, v24, s33
    v_perm_b32 v39, v30, v28, s33
    v_perm_b32 v40, v19, v17, s32
    v_perm_b32 v41, v23, v21, s32
    v_perm_b32 v42, v27, v25, s32
    v_perm_b32 v43, v31, v29, s32
    v_perm_b32 v44, v19, v17, s33
    v_perm_b32 v45, v23, v21, s33
    v_perm_b32 v46, v27, v25, s33
    v_perm_b32 v47, v31, v29, s33
    buffer_store_dwordx4 v[32:35], v11, s[12:15], 0 offen offset:0
    buffer_store_dwordx4 v[36:39], v11, s[12:15], 0 offen offset:16
    buffer_store_dwordx4 v[40:43], v11, s[12:15], 0 offen offset:32
    buffer_store_dwordx4 v[44:47], v11, s[12:15], 0 offen offset:48
    s_branch k0_done
k0_not_wq:
    s_sub_u32 s2, s2, 144
    s_mov_b32 s8, s18
    s_and_b32 s9, s19, 0xffff
    s_mov_b32 s10, 663552
    s_mov_b32 s11, 0x00020000
    s_lshl_b32 s34, s2, 2
    s_add_u32 s34, s34, s3
    s_mul_hi_u32 s38, s34, 0x55555556
    s_mul_i32 s35, s38, 3
    s_sub_u32 s35, s34, s35
    v_cmp_gt_u32 vcc, 48, v1
    s_nop 3
    s_and_saveexec_b64 s[36:37], vcc
    s_mul_i32 s39, s35, 48
    v_add_u32 v3, s39, v1
    v_lshlrev_b32 v10, 3, v3
    s_mul_i32 s42, s38, 9216
    v_add_u32 v10, s42, v10
    v_lshrrev_b32 v7, 2, v3
    v_mul_u32_u24 v11, 18432, v7
    v_and_b32 v7, 3, v3
    v_lshl_add_u32 v11, v7, 6, v11
    s_lshr_b32 s42, s38, 2
    s_lshl_b32 s39, s42, 10
    s_and_b32 s42, s38, 3
    s_lshl_b32 s42, s42, 8
    s_add_u32 s39, s39, s42
    s_add_u32 s39, s39, 7340032
    v_add_u32 v11, s39, v11
    s_mov_b32 s24, 0
    s_mov_b32 s25, 1152
    s_mov_b32 s26, 2304
    s_mov_b32 s27, 3456
    s_mov_b32 s28, 4608
    s_mov_b32 s29, 5760
    s_mov_b32 s30, 6912
    s_mov_b32 s31, 8064
    buffer_load_dwordx2 v[16:17], v10, s[8:11], s24 offen
    buffer_load_dwordx2 v[18:19], v10, s[8:11], s25 offen
    buffer_load_dwordx2 v[20:21], v10, s[8:11], s26 offen
    buffer_load_dwordx2 v[22:23], v10, s[8:11], s27 offen
    buffer_load_dwordx2 v[24:25], v10, s[8:11], s28 offen
    buffer_load_dwordx2 v[26:27], v10, s[8:11], s29 offen
    buffer_load_dwordx2 v[28:29], v10, s[8:11], s30 offen
    buffer_load_dwordx2 v[30:31], v10, s[8:11], s31 offen
    s_mov_b32 s32, 0x05040100
    s_mov_b32 s33, 0x07060302
    s_waitcnt vmcnt(0)
    v_perm_b32 v32, v18, v16, s32
    v_perm_b32 v33, v22, v20, s32
    v_perm_b32 v34, v26, v24, s32
    v_perm_b32 v35, v30, v28, s32
    v_perm_b32 v36, v18, v16, s33
    v_perm_b32 v37, v22, v20, s33
    v_perm_b32 v38, v26, v24, s33
    v_perm_b32 v39, v30, v28, s33
    v_perm_b32 v40, v19, v17, s32
    v_perm_b32 v41, v23, v21, s32
    v_perm_b32 v42, v27, v25, s32
    v_perm_b32 v43, v31, v29, s32
    v_perm_b32 v44, v19, v17, s33
    v_perm_b32 v45, v23, v21, s33
    v_perm_b32 v46, v27, v25, s33
    v_perm_b32 v47, v31, v29, s33
    buffer_store_dwordx4 v[32:35], v11, s[12:15], 0 offen offset:0
    buffer_store_dwordx4 v[36:39], v11, s[12:15], 0 offen offset:16
    buffer_store_dwordx4 v[40:43], v11, s[12:15], 0 offen offset:32
    buffer_store_dwordx4 v[44:47], v11, s[12:15], 0 offen offset:48
k0_done:
    s_endpgm
prep_kernel_end:

.globl qkv_attn_kernel
.p2align 8
.type qkv_attn_kernel,@function
qkv_attn_kernel:
    s_cmp_ge_u32 s2, 256
    s_cbranch_scc1 k4_done
    s_load_dwordx4 s[84:87], s[0:1], 80
    s_load_dwordx4 s[16:19], s[0:1], 32
    s_load_dwordx2 s[8:9], s[0:1], 0
    v_and_b32 v1, 63, v0
    v_lshrrev_b32 v2, 6, v0
    v_lshlrev_b32 v3, 4, v1
    v_lshrrev_b32 v4, 4, v1
    v_readfirstlane_b32 s3, v2
    s_and_b32 s4, s2, 1
    s_lshl_b32 s4, s4, 2
    s_bfe_u32 s31, s2, 0x20003
    s_add_u32 s4, s4, s31
    s_bfe_u32 s5, s2, 0x20001
    s_lshl_b32 s5, s5, 3
    s_lshr_b32 s31, s2, 5
    s_add_u32 s5, s5, s31
    v_lshlrev_b32 v5, 5, v4
    s_waitcnt lgkmcnt(0)
    s_mov_b32 s12, s86
    s_and_b32 s13, s87, 0xffff
    s_mov_b32 s14, 268435456
    s_mov_b32 s15, 0x00020000
    s_mul_i32 s31, s3, 576
    s_add_u32 s32, s31, 131200
    s_mov_b32 m0, s32
    s_mov_b32 exec_hi, 0xf
    buffer_load_dwordx4 v3, s[12:15], s31 offen lds
    s_mov_b64 exec, -1
    s_lshl_b32 s23, s5, 2
    s_sub_u32 s24, s23, 1
    s_max_i32 s24, s24, 0
    s_mul_i32 s25, s24, 18432
    s_add_u32 s25, s25, 1048576
    s_add_u32 s30, s23, 0
    s_mul_i32 s26, s30, 18432
    s_add_u32 s26, s26, 1048576
    s_add_u32 s30, s23, 1
    s_mul_i32 s27, s30, 18432
    s_add_u32 s27, s27, 1048576
    s_add_u32 s30, s23, 2
    s_mul_i32 s28, s30, 18432
    s_add_u32 s28, s28, 1048576
    s_add_u32 s30, s23, 3
    s_mul_i32 s29, s30, 18432
    s_add_u32 s29, s29, 1048576
    s_lshl_b32 s20, s3, 10
    s_add_u32 s21, s20, 8192
    s_add_u32 s34, s25, s20
    buffer_load_dwordx4 v[48:51], v3, s[12:15], s34 offen
    s_add_u32 s34, s26, s20
    buffer_load_dwordx4 v[52:55], v3, s[12:15], s34 offen
    s_add_u32 s34, s27, s20
    buffer_load_dwordx4 v[56:59], v3, s[12:15], s34 offen
    s_add_u32 s34, s28, s20
    buffer_load_dwordx4 v[60:63], v3, s[12:15], s34 offen
    s_add_u32 s34, s29, s20
    buffer_load_dwordx4 v[64:67], v3, s[12:15], s34 offen
    s_add_u32 s34, s25, s21
    buffer_load_dwordx4 v[68:71], v3, s[12:15], s34 offen
    s_add_u32 s34, s26, s21
    buffer_load_dwordx4 v[72:75], v3, s[12:15], s34 offen
    s_add_u32 s34, s27, s21
    buffer_load_dwordx4 v[76:79], v3, s[12:15], s34 offen
    s_add_u32 s34, s28, s21
    buffer_load_dwordx4 v[80:83], v3, s[12:15], s34 offen
    s_add_u32 s34, s29, s21
    buffer_load_dwordx4 v[84:87], v3, s[12:15], s34 offen
    s_add_u32 s36, s3, 8
    s_cmp_lt_u32 s3, 2
    s_cselect_b32 s36, s36, s3
    s_mov_b32 s35, s3
    s_cmp_ge_u32 s35, 5
    s_cselect_b32 s44, 17, 16
    s_cselect_b32 s37, 5, 0
    s_sub_u32 s46, s35, s37
    s_add_u32 s37, s23, s46
    s_sub_u32 s37, s37, 1
    s_max_i32 s37, s37, 0
    s_mul_i32 s37, s37, 18
    s_add_u32 s37, s37, s44
    s_lshl_b32 s37, s37, 10
    s_add_u32 s37, s37, 1048576
    buffer_load_dwordx4 v[88:91], v3, s[12:15], s37 offen
    s_cmp_ge_u32 s36, 5
    s_cselect_b32 s45, 17, 16
    s_cselect_b32 s37, 5, 0
    s_sub_u32 s47, s36, s37
    s_add_u32 s37, s23, s47
    s_sub_u32 s37, s37, 1
    s_max_i32 s37, s37, 0
    s_mul_i32 s37, s37, 18
    s_add_u32 s37, s37, s45
    s_lshl_b32 s37, s37, 10
    s_add_u32 s37, s37, 1048576
    buffer_load_dwordx4 v[92:95], v3, s[12:15], s37 offen
    s_waitcnt vmcnt(12)
    s_barrier
    s_lshl_b32 s40, s4, 4
    s_lshl_b32 s41, s3, 1
    s_add_u32 s42, s41, 1
    s_min_u32 s42, s42, 14
    s_add_u32 s41, s41, s40
    s_add_u32 s42, s42, s40
    s_mul_i32 s41, s41, 18432
    s_mul_i32 s42, s42, 18432
    s_add_u32 s41, s41, 4194304
    s_add_u32 s42, s42, 4194304
    s_lshl_b32 s31, s3, 7
    v_add_u32 v8, s31, v5
    s_lshl_b32 s31, s44, 7
    v_add_u32 v9, s31, v5
    s_lshl_b32 s31, s45, 7
    v_add_u32 v11, s31, v5
    v_add_u32 v8, 131200, v8
    v_add_u32 v9, 131200, v9
    v_add_u32 v11, 131200, v11
    v_add_u32 v12, s20, v3
    v_add_u32 v13, 18432, v12
    v_add_u32 v14, s21, v3
    v_add_u32 v15, 18432, v14
    s_mul_i32 s37, s46, 18
    s_add_u32 s37, s37, s44
    s_lshl_b32 s37, s37, 10
    v_add_u32 v228, s37, v3
    s_mul_i32 s37, s47, 18
    s_add_u32 s37, s37, s45
    s_lshl_b32 s37, s37, 10
    v_add_u32 v229, s37, v3
    ds_read_b128 v[16:19], v8 offset:2304
    ds_read_b128 v[20:23], v8 offset:2320
    ds_read_b128 v[24:27], v8 offset:0
    ds_read_b128 v[28:31], v8 offset:16
    ds_read_b128 v[32:35], v8 offset:3328
    ds_read_b128 v[36:39], v8 offset:3344
    ds_read_b128 v[40:43], v8 offset:1024
    ds_read_b128 v[44:47], v8 offset:1040
    s_waitcnt lgkmcnt(4)
    s_waitcnt vmcnt(11)
    v_lshlrev_b32 v96, 16, v48
    v_and_b32 v97, 0xffff0000, v48
    v_lshlrev_b32 v98, 16, v49
    v_and_b32 v99, 0xffff0000, v49
    v_lshlrev_b32 v100, 16, v50
    v_and_b32 v101, 0xffff0000, v50
    v_lshlrev_b32 v102, 16, v51
    v_and_b32 v103, 0xffff0000, v51
    v_mul_f32 v96, v96, v16
    v_mul_f32 v97, v97, v17
    v_mul_f32 v98, v98, v18
    v_mul_f32 v99, v99, v19
    v_mul_f32 v100, v100, v20
    v_mul_f32 v101, v101, v21
    v_mul_f32 v102, v102, v22
    v_mul_f32 v103, v103, v23
    v_cvt_pk_bf16_f32 v48, v96, v97
    v_cvt_pk_bf16_f32 v49, v98, v99
    v_cvt_pk_bf16_f32 v50, v100, v101
    v_cvt_pk_bf16_f32 v51, v102, v103
    v_lshlrev_b32 v96, 16, v48
    v_and_b32 v97, 0xffff0000, v48
    v_lshlrev_b32 v98, 16, v49
    v_and_b32 v99, 0xffff0000, v49
    v_lshlrev_b32 v100, 16, v50
    v_and_b32 v101, 0xffff0000, v50
    v_lshlrev_b32 v102, 16, v51
    v_and_b32 v103, 0xffff0000, v51
    v_add_f32 v96, v96, v24
    v_add_f32 v97, v97, v25
    v_add_f32 v98, v98, v26
    v_add_f32 v99, v99, v27
    v_add_f32 v100, v100, v28
    v_add_f32 v101, v101, v29
    v_add_f32 v102, v102, v30
    v_add_f32 v103, v103, v31
    v_cvt_pk_bf16_f32 v48, v96, v97
    v_cvt_pk_bf16_f32 v49, v98, v99
    v_cvt_pk_bf16_f32 v50, v100, v101
    v_cvt_pk_bf16_f32 v51, v102, v103
    ds_write_b128 v12, v[48:51] offset:0
    s_waitcnt vmcnt(10)
    v_lshlrev_b32 v96, 16, v52
    v_and_b32 v97, 0xffff0000, v52
    v_lshlrev_b32 v98, 16, v53
    v_and_b32 v99, 0xffff0000, v53
    v_lshlrev_b32 v100, 16, v54
    v_and_b32 v101, 0xffff0000, v54
    v_lshlrev_b32 v102, 16, v55
    v_and_b32 v103, 0xffff0000, v55
    v_mul_f32 v96, v96, v16
    v_mul_f32 v97, v97, v17
    v_mul_f32 v98, v98, v18
    v_mul_f32 v99, v99, v19
    v_mul_f32 v100, v100, v20
    v_mul_f32 v101, v101, v21
    v_mul_f32 v102, v102, v22
    v_mul_f32 v103, v103, v23
    v_cvt_pk_bf16_f32 v52, v96, v97
    v_cvt_pk_bf16_f32 v53, v98, v99
    v_cvt_pk_bf16_f32 v54, v100, v101
    v_cvt_pk_bf16_f32 v55, v102, v103
    v_lshlrev_b32 v96, 16, v52
    v_and_b32 v97, 0xffff0000, v52
    v_lshlrev_b32 v98, 16, v53
    v_and_b32 v99, 0xffff0000, v53
    v_lshlrev_b32 v100, 16, v54
    v_and_b32 v101, 0xffff0000, v54
    v_lshlrev_b32 v102, 16, v55
    v_and_b32 v103, 0xffff0000, v55
    v_add_f32 v96, v96, v24
    v_add_f32 v97, v97, v25
    v_add_f32 v98, v98, v26
    v_add_f32 v99, v99, v27
    v_add_f32 v100, v100, v28
    v_add_f32 v101, v101, v29
    v_add_f32 v102, v102, v30
    v_add_f32 v103, v103, v31
    v_cvt_pk_bf16_f32 v52, v96, v97
    v_cvt_pk_bf16_f32 v53, v98, v99
    v_cvt_pk_bf16_f32 v54, v100, v101
    v_cvt_pk_bf16_f32 v55, v102, v103
    ds_write_b128 v12, v[52:55] offset:18432
    buffer_load_dwordx4 v[124:127], v3, s[12:15], s41 offen offset:0
    buffer_load_dwordx4 v[128:131], v3, s[12:15], s42 offen offset:0
    s_waitcnt vmcnt(11)
    v_lshlrev_b32 v96, 16, v56
    v_and_b32 v97, 0xffff0000, v56
    v_lshlrev_b32 v98, 16, v57
    v_and_b32 v99, 0xffff0000, v57
    v_lshlrev_b32 v100, 16, v58
    v_and_b32 v101, 0xffff0000, v58
    v_lshlrev_b32 v102, 16, v59
    v_and_b32 v103, 0xffff0000, v59
    v_mul_f32 v96, v96, v16
    v_mul_f32 v97, v97, v17
    v_mul_f32 v98, v98, v18
    v_mul_f32 v99, v99, v19
    v_mul_f32 v100, v100, v20
    v_mul_f32 v101, v101, v21
    v_mul_f32 v102, v102, v22
    v_mul_f32 v103, v103, v23
    v_cvt_pk_bf16_f32 v56, v96, v97
    v_cvt_pk_bf16_f32 v57, v98, v99
    v_cvt_pk_bf16_f32 v58, v100, v101
    v_cvt_pk_bf16_f32 v59, v102, v103
    v_lshlrev_b32 v96, 16, v56
    v_and_b32 v97, 0xffff0000, v56
    v_lshlrev_b32 v98, 16, v57
    v_and_b32 v99, 0xffff0000, v57
    v_lshlrev_b32 v100, 16, v58
    v_and_b32 v101, 0xffff0000, v58
    v_lshlrev_b32 v102, 16, v59
    v_and_b32 v103, 0xffff0000, v59
    v_add_f32 v96, v96, v24
    v_add_f32 v97, v97, v25
    v_add_f32 v98, v98, v26
    v_add_f32 v99, v99, v27
    v_add_f32 v100, v100, v28
    v_add_f32 v101, v101, v29
    v_add_f32 v102, v102, v30
    v_add_f32 v103, v103, v31
    v_cvt_pk_bf16_f32 v56, v96, v97
    v_cvt_pk_bf16_f32 v57, v98, v99
    v_cvt_pk_bf16_f32 v58, v100, v101
    v_cvt_pk_bf16_f32 v59, v102, v103
    ds_write_b128 v12, v[56:59] offset:36864
    buffer_load_dwordx4 v[132:135], v3, s[12:15], s41 offen offset:1024
    buffer_load_dwordx4 v[136:139], v3, s[12:15], s42 offen offset:1024
    s_waitcnt vmcnt(12)
    v_lshlrev_b32 v96, 16, v60
    v_and_b32 v97, 0xffff0000, v60
    v_lshlrev_b32 v98, 16, v61
    v_and_b32 v99, 0xffff0000, v61
    v_lshlrev_b32 v100, 16, v62
    v_and_b32 v101, 0xffff0000, v62
    v_lshlrev_b32 v102, 16, v63
    v_and_b32 v103, 0xffff0000, v63
    v_mul_f32 v96, v96, v16
    v_mul_f32 v97, v97, v17
    v_mul_f32 v98, v98, v18
    v_mul_f32 v99, v99, v19
    v_mul_f32 v100, v100, v20
    v_mul_f32 v101, v101, v21
    v_mul_f32 v102, v102, v22
    v_mul_f32 v103, v103, v23
    v_cvt_pk_bf16_f32 v60, v96, v97
    v_cvt_pk_bf16_f32 v61, v98, v99
    v_cvt_pk_bf16_f32 v62, v100, v101
    v_cvt_pk_bf16_f32 v63, v102, v103
    v_lshlrev_b32 v96, 16, v60
    v_and_b32 v97, 0xffff0000, v60
    v_lshlrev_b32 v98, 16, v61
    v_and_b32 v99, 0xffff0000, v61
    v_lshlrev_b32 v100, 16, v62
    v_and_b32 v101, 0xffff0000, v62
    v_lshlrev_b32 v102, 16, v63
    v_and_b32 v103, 0xffff0000, v63
    v_add_f32 v96, v96, v24
    v_add_f32 v97, v97, v25
    v_add_f32 v98, v98, v26
    v_add_f32 v99, v99, v27
    v_add_f32 v100, v100, v28
    v_add_f32 v101, v101, v29
    v_add_f32 v102, v102, v30
    v_add_f32 v103, v103, v31
    v_cvt_pk_bf16_f32 v60, v96, v97
    v_cvt_pk_bf16_f32 v61, v98, v99
    v_cvt_pk_bf16_f32 v62, v100, v101
    v_cvt_pk_bf16_f32 v63, v102, v103
    ds_write_b128 v12, v[60:63] offset:55296
    buffer_load_dwordx4 v[140:143], v3, s[12:15], s41 offen offset:2048
    buffer_load_dwordx4 v[144:147], v3, s[12:15], s42 offen offset:2048
    s_waitcnt vmcnt(13)
    v_lshlrev_b32 v96, 16, v64
    v_and_b32 v97, 0xffff0000, v64
    v_lshlrev_b32 v98, 16, v65
    v_and_b32 v99, 0xffff0000, v65
    v_lshlrev_b32 v100, 16, v66
    v_and_b32 v101, 0xffff0000, v66
    v_lshlrev_b32 v102, 16, v67
    v_and_b32 v103, 0xffff0000, v67
    v_mul_f32 v96, v96, v16
    v_mul_f32 v97, v97, v17
    v_mul_f32 v98, v98, v18
    v_mul_f32 v99, v99, v19
    v_mul_f32 v100, v100, v20
    v_mul_f32 v101, v101, v21
    v_mul_f32 v102, v102, v22
    v_mul_f32 v103, v103, v23
    v_cvt_pk_bf16_f32 v64, v96, v97
    v_cvt_pk_bf16_f32 v65, v98, v99
    v_cvt_pk_bf16_f32 v66, v100, v101
    v_cvt_pk_bf16_f32 v67, v102, v103
    v_lshlrev_b32 v96, 16, v64
    v_and_b32 v97, 0xffff0000, v64
    v_lshlrev_b32 v98, 16, v65
    v_and_b32 v99, 0xffff0000, v65
    v_lshlrev_b32 v100, 16, v66
    v_and_b32 v101, 0xffff0000, v66
    v_lshlrev_b32 v102, 16, v67
    v_and_b32 v103, 0xffff0000, v67
    v_add_f32 v96, v96, v24
    v_add_f32 v97, v97, v25
    v_add_f32 v98, v98, v26
    v_add_f32 v99, v99, v27
    v_add_f32 v100, v100, v28
    v_add_f32 v101, v101, v29
    v_add_f32 v102, v102, v30
    v_add_f32 v103, v103, v31
    v_cvt_pk_bf16_f32 v64, v96, v97
    v_cvt_pk_bf16_f32 v65, v98, v99
    v_cvt_pk_bf16_f32 v66, v100, v101
    v_cvt_pk_bf16_f32 v67, v102, v103
    ds_write_b128 v13, v[64:67] offset:55296
    buffer_load_dwordx4 v[148:151], v3, s[12:15], s41 offen offset:3072
    buffer_load_dwordx4 v[152:155], v3, s[12:15], s42 offen offset:3072
    s_waitcnt lgkmcnt(0)
    s_barrier
    v_add_u32 v6, 55296, v3
    ds_read_b128 v[48:51], v3 offset:0
    ds_read_b128 v[52:55], v3 offset:18432
    ds_read_b128 v[56:59], v3 offset:36864
    ds_read_b128 v[60:63], v6 offset:0
    ds_read_b128 v[64:67], v6 offset:18432
    ds_read_b128 v[104:107], v3 offset:1024
    ds_read_b128 v[108:111], v3 offset:19456
    ds_read_b128 v[112:115], v3 offset:37888
    ds_read_b128 v[116:119], v6 offset:1024
    ds_read_b128 v[120:123], v6 offset:19456
    s_add_u32 s41, s41, 4096
    s_add_u32 s42, s42, 4096
    buffer_load_dwordx4 v[156:159], v3, s[12:15], s41 offen offset:0
    buffer_load_dwordx4 v[160:163], v3, s[12:15], s42 offen offset:0
    buffer_load_dwordx4 v[164:167], v3, s[12:15], s41 offen offset:1024
    buffer_load_dwordx4 v[168:171], v3, s[12:15], s42 offen offset:1024
    buffer_load_dwordx4 v[172:175], v3, s[12:15], s41 offen offset:2048
    buffer_load_dwordx4 v[176:179], v3, s[12:15], s42 offen offset:2048
    buffer_load_dwordx4 v[180:183], v3, s[12:15], s41 offen offset:3072
    buffer_load_dwordx4 v[184:187], v3, s[12:15], s42 offen offset:3072
    s_waitcnt vmcnt(14)
    s_waitcnt lgkmcnt(5)
    v_mfma_f32_16x16x32_bf16 v[188:191], v[124:127], v[48:51], 0
    v_lshlrev_b32 v96, 16, v68
    v_and_b32 v97, 0xffff0000, v68
    v_lshlrev_b32 v98, 16, v69
    v_and_b32 v99, 0xffff0000, v69
    v_lshlrev_b32 v100, 16, v70
    v_mfma_f32_16x16x32_bf16 v[208:211], v[128:131], v[48:51], 0
    v_and_b32 v101, 0xffff0000, v70
    v_lshlrev_b32 v102, 16, v71
    v_and_b32 v103, 0xffff0000, v71
    v_mul_f32 v96, v96, v32
    v_mfma_f32_16x16x32_bf16 v[192:195], v[124:127], v[52:55], 0
    v_mul_f32 v97, v97, v33
    v_mul_f32 v98, v98, v34
    v_mul_f32 v99, v99, v35
    v_mul_f32 v100, v100, v36
    v_mfma_f32_16x16x32_bf16 v[212:215], v[128:131], v[52:55], 0
    v_mul_f32 v101, v101, v37
    v_mul_f32 v102, v102, v38
    v_mul_f32 v103, v103, v39
    v_cvt_pk_bf16_f32 v68, v96, v97
    v_mfma_f32_16x16x32_bf16 v[196:199], v[124:127], v[56:59], 0
    v_cvt_pk_bf16_f32 v69, v98, v99
    v_cvt_pk_bf16_f32 v70, v100, v101
    v_cvt_pk_bf16_f32 v71, v102, v103
    v_lshlrev_b32 v96, 16, v68
    v_mfma_f32_16x16x32_bf16 v[216:219], v[128:131], v[56:59], 0
    v_and_b32 v97, 0xffff0000, v68
    v_lshlrev_b32 v98, 16, v69
    v_and_b32 v99, 0xffff0000, v69
    v_lshlrev_b32 v100, 16, v70
    v_mfma_f32_16x16x32_bf16 v[200:203], v[124:127], v[60:63], 0
    v_and_b32 v101, 0xffff0000, v70
    v_lshlrev_b32 v102, 16, v71
    v_and_b32 v103, 0xffff0000, v71
    v_add_f32 v96, v96, v40
    v_mfma_f32_16x16x32_bf16 v[220:223], v[128:131], v[60:63], 0
    v_add_f32 v97, v97, v41
    v_add_f32 v98, v98, v42
    v_add_f32 v99, v99, v43
    v_add_f32 v100, v100, v44
    v_mfma_f32_16x16x32_bf16 v[204:207], v[124:127], v[64:67], 0
    v_add_f32 v101, v101, v45
    v_add_f32 v102, v102, v46
    v_add_f32 v103, v103, v47
    v_cvt_pk_bf16_f32 v68, v96, v97
    v_mfma_f32_16x16x32_bf16 v[224:227], v[128:131], v[64:67], 0
    v_cvt_pk_bf16_f32 v69, v98, v99
    v_cvt_pk_bf16_f32 v70, v100, v101
    v_cvt_pk_bf16_f32 v71, v102, v103
    ds_write_b128 v14, v[68:71] offset:0
    ds_read_b128 v[48:51], v3 offset:2048
    ds_read_b128 v[52:55], v3 offset:20480
    ds_read_b128 v[56:59], v3 offset:38912
    ds_read_b128 v[60:63], v6 offset:2048
    ds_read_b128 v[64:67], v6 offset:20480
    s_add_u32 s41, s41, 4096
    s_add_u32 s42, s42, 4096
    buffer_load_dwordx4 v[124:127], v3, s[12:15], s41 offen offset:0
    buffer_load_dwordx4 v[128:131], v3, s[12:15], s42 offen offset:0
    s_waitcnt vmcnt(14)
    s_waitcnt lgkmcnt(5)
    v_mfma_f32_16x16x32_bf16 v[188:191], v[132:135], v[104:107], v[188:191]
    v_lshlrev_b32 v96, 16, v72
    v_and_b32 v97, 0xffff0000, v72
    v_lshlrev_b32 v98, 16, v73
    v_and_b32 v99, 0xffff0000, v73
    v_lshlrev_b32 v100, 16, v74
    v_mfma_f32_16x16x32_bf16 v[208:211], v[136:139], v[104:107], v[208:211]
    v_and_b32 v101, 0xffff0000, v74
    v_lshlrev_b32 v102, 16, v75
    v_and_b32 v103, 0xffff0000, v75
    v_mul_f32 v96, v96, v32
    v_mfma_f32_16x16x32_bf16 v[192:195], v[132:135], v[108:111], v[192:195]
    v_mul_f32 v97, v97, v33
    v_mul_f32 v98, v98, v34
    v_mul_f32 v99, v99, v35
    v_mul_f32 v100, v100, v36
    v_mfma_f32_16x16x32_bf16 v[212:215], v[136:139], v[108:111], v[212:215]
    v_mul_f32 v101, v101, v37
    v_mul_f32 v102, v102, v38
    v_mul_f32 v103, v103, v39
    v_cvt_pk_bf16_f32 v72, v96, v97
    v_mfma_f32_16x16x32_bf16 v[196:199], v[132:135], v[112:115], v[196:199]
    v_cvt_pk_bf16_f32 v73, v98, v99
    v_cvt_pk_bf16_f32 v74, v100, v101
    v_cvt_pk_bf16_f32 v75, v102, v103
    v_lshlrev_b32 v96, 16, v72
    v_mfma_f32_16x16x32_bf16 v[216:219], v[136:139], v[112:115], v[216:219]
    v_and_b32 v97, 0xffff0000, v72
    v_lshlrev_b32 v98, 16, v73
    v_and_b32 v99, 0xffff0000, v73
    v_lshlrev_b32 v100, 16, v74
    v_mfma_f32_16x16x32_bf16 v[200:203], v[132:135], v[116:119], v[200:203]
    v_and_b32 v101, 0xffff0000, v74
    v_lshlrev_b32 v102, 16, v75
    v_and_b32 v103, 0xffff0000, v75
    v_add_f32 v96, v96, v40
    v_mfma_f32_16x16x32_bf16 v[220:223], v[136:139], v[116:119], v[220:223]
    v_add_f32 v97, v97, v41
    v_add_f32 v98, v98, v42
    v_add_f32 v99, v99, v43
    v_add_f32 v100, v100, v44
    v_mfma_f32_16x16x32_bf16 v[204:207], v[132:135], v[120:123], v[204:207]
    v_add_f32 v101, v101, v45
    v_add_f32 v102, v102, v46
    v_add_f32 v103, v103, v47
    v_cvt_pk_bf16_f32 v72, v96, v97
    v_mfma_f32_16x16x32_bf16 v[224:227], v[136:139], v[120:123], v[224:227]
    v_cvt_pk_bf16_f32 v73, v98, v99
    v_cvt_pk_bf16_f32 v74, v100, v101
    v_cvt_pk_bf16_f32 v75, v102, v103
    ds_write_b128 v14, v[72:75] offset:18432
    ds_read_b128 v[104:107], v3 offset:3072
    ds_read_b128 v[108:111], v3 offset:21504
    ds_read_b128 v[112:115], v3 offset:39936
    ds_read_b128 v[116:119], v6 offset:3072
    ds_read_b128 v[120:123], v6 offset:21504
    buffer_load_dwordx4 v[132:135], v3, s[12:15], s41 offen offset:1024
    buffer_load_dwordx4 v[136:139], v3, s[12:15], s42 offen offset:1024
    s_waitcnt vmcnt(14)
    s_waitcnt lgkmcnt(5)
    v_mfma_f32_16x16x32_bf16 v[188:191], v[140:143], v[48:51], v[188:191]
    v_lshlrev_b32 v96, 16, v76
    v_and_b32 v97, 0xffff0000, v76
    v_lshlrev_b32 v98, 16, v77
    v_and_b32 v99, 0xffff0000, v77
    v_lshlrev_b32 v100, 16, v78
    v_mfma_f32_16x16x32_bf16 v[208:211], v[144:147], v[48:51], v[208:211]
    v_and_b32 v101, 0xffff0000, v78
    v_lshlrev_b32 v102, 16, v79
    v_and_b32 v103, 0xffff0000, v79
    v_mul_f32 v96, v96, v32
    v_mfma_f32_16x16x32_bf16 v[192:195], v[140:143], v[52:55], v[192:195]
    v_mul_f32 v97, v97, v33
    v_mul_f32 v98, v98, v34
    v_mul_f32 v99, v99, v35
    v_mul_f32 v100, v100, v36
    v_mfma_f32_16x16x32_bf16 v[212:215], v[144:147], v[52:55], v[212:215]
    v_mul_f32 v101, v101, v37
    v_mul_f32 v102, v102, v38
    v_mul_f32 v103, v103, v39
    v_cvt_pk_bf16_f32 v76, v96, v97
    v_mfma_f32_16x16x32_bf16 v[196:199], v[140:143], v[56:59], v[196:199]
    v_cvt_pk_bf16_f32 v77, v98, v99
    v_cvt_pk_bf16_f32 v78, v100, v101
    v_cvt_pk_bf16_f32 v79, v102, v103
    v_lshlrev_b32 v96, 16, v76
    v_mfma_f32_16x16x32_bf16 v[216:219], v[144:147], v[56:59], v[216:219]
    v_and_b32 v97, 0xffff0000, v76
    v_lshlrev_b32 v98, 16, v77
    v_and_b32 v99, 0xffff0000, v77
    v_lshlrev_b32 v100, 16, v78
    v_mfma_f32_16x16x32_bf16 v[200:203], v[140:143], v[60:63], v[200:203]
    v_and_b32 v101, 0xffff0000, v78
    v_lshlrev_b32 v102, 16, v79
    v_and_b32 v103, 0xffff0000, v79
    v_add_f32 v96, v96, v40
    v_mfma_f32_16x16x32_bf16 v[220:223], v[144:147], v[60:63], v[220:223]
    v_add_f32 v97, v97, v41
    v_add_f32 v98, v98, v42
    v_add_f32 v99, v99, v43
    v_add_f32 v100, v100, v44
    v_mfma_f32_16x16x32_bf16 v[204:207], v[140:143], v[64:67], v[204:207]
    v_add_f32 v101, v101, v45
    v_add_f32 v102, v102, v46
    v_add_f32 v103, v103, v47
    v_cvt_pk_bf16_f32 v76, v96, v97
    v_mfma_f32_16x16x32_bf16 v[224:227], v[144:147], v[64:67], v[224:227]
    v_cvt_pk_bf16_f32 v77, v98, v99
    v_cvt_pk_bf16_f32 v78, v100, v101
    v_cvt_pk_bf16_f32 v79, v102, v103
    ds_write_b128 v14, v[76:79] offset:36864
    ds_read_b128 v[48:51], v3 offset:4096
    ds_read_b128 v[52:55], v3 offset:22528
    ds_read_b128 v[56:59], v3 offset:40960
    ds_read_b128 v[60:63], v6 offset:4096
    ds_read_b128 v[64:67], v6 offset:22528
    buffer_load_dwordx4 v[140:143], v3, s[12:15], s41 offen offset:2048
    buffer_load_dwordx4 v[144:147], v3, s[12:15], s42 offen offset:2048
    s_waitcnt vmcnt(14)
    s_waitcnt lgkmcnt(5)
    v_mfma_f32_16x16x32_bf16 v[188:191], v[148:151], v[104:107], v[188:191]
    v_lshlrev_b32 v96, 16, v80
    v_and_b32 v97, 0xffff0000, v80
    v_lshlrev_b32 v98, 16, v81
    v_and_b32 v99, 0xffff0000, v81
    v_lshlrev_b32 v100, 16, v82
    v_mfma_f32_16x16x32_bf16 v[208:211], v[152:155], v[104:107], v[208:211]
    v_and_b32 v101, 0xffff0000, v82
    v_lshlrev_b32 v102, 16, v83
    v_and_b32 v103, 0xffff0000, v83
    v_mul_f32 v96, v96, v32
    v_mfma_f32_16x16x32_bf16 v[192:195], v[148:151], v[108:111], v[192:195]
    v_mul_f32 v97, v97, v33
    v_mul_f32 v98, v98, v34
    v_mul_f32 v99, v99, v35
    v_mul_f32 v100, v100, v36
    v_mfma_f32_16x16x32_bf16 v[212:215], v[152:155], v[108:111], v[212:215]
    v_mul_f32 v101, v101, v37
    v_mul_f32 v102, v102, v38
    v_mul_f32 v103, v103, v39
    v_cvt_pk_bf16_f32 v80, v96, v97
    v_mfma_f32_16x16x32_bf16 v[196:199], v[148:151], v[112:115], v[196:199]
    v_cvt_pk_bf16_f32 v81, v98, v99
    v_cvt_pk_bf16_f32 v82, v100, v101
    v_cvt_pk_bf16_f32 v83, v102, v103
    v_lshlrev_b32 v96, 16, v80
    v_mfma_f32_16x16x32_bf16 v[216:219], v[152:155], v[112:115], v[216:219]
    v_and_b32 v97, 0xffff0000, v80
    v_lshlrev_b32 v98, 16, v81
    v_and_b32 v99, 0xffff0000, v81
    v_lshlrev_b32 v100, 16, v82
    v_mfma_f32_16x16x32_bf16 v[200:203], v[148:151], v[116:119], v[200:203]
    v_and_b32 v101, 0xffff0000, v82
    v_lshlrev_b32 v102, 16, v83
    v_and_b32 v103, 0xffff0000, v83
    v_add_f32 v96, v96, v40
    v_mfma_f32_16x16x32_bf16 v[220:223], v[152:155], v[116:119], v[220:223]
    v_add_f32 v97, v97, v41
    v_add_f32 v98, v98, v42
    v_add_f32 v99, v99, v43
    v_add_f32 v100, v100, v44
    v_mfma_f32_16x16x32_bf16 v[204:207], v[148:151], v[120:123], v[204:207]
    v_add_f32 v101, v101, v45
    v_add_f32 v102, v102, v46
    v_add_f32 v103, v103, v47
    v_cvt_pk_bf16_f32 v80, v96, v97
    v_mfma_f32_16x16x32_bf16 v[224:227], v[152:155], v[120:123], v[224:227]
    v_cvt_pk_bf16_f32 v81, v98, v99
    v_cvt_pk_bf16_f32 v82, v100, v101
    v_cvt_pk_bf16_f32 v83, v102, v103
    ds_write_b128 v14, v[80:83] offset:55296
    ds_read_b128 v[104:107], v3 offset:5120
    ds_read_b128 v[108:111], v3 offset:23552
    ds_read_b128 v[112:115], v3 offset:41984
    ds_read_b128 v[116:119], v6 offset:5120
    ds_read_b128 v[120:123], v6 offset:23552
    buffer_load_dwordx4 v[148:151], v3, s[12:15], s41 offen offset:3072
    buffer_load_dwordx4 v[152:155], v3, s[12:15], s42 offen offset:3072
    s_waitcnt vmcnt(14)
    s_waitcnt lgkmcnt(5)
    v_mfma_f32_16x16x32_bf16 v[188:191], v[156:159], v[48:51], v[188:191]
    ds_read_b128 v[16:19], v9 offset:2304
    ds_read_b128 v[20:23], v9 offset:2320
    ds_read_b128 v[24:27], v9 offset:0
    ds_read_b128 v[28:31], v9 offset:16
    v_lshlrev_b32 v96, 16, v84
    v_mfma_f32_16x16x32_bf16 v[208:211], v[160:163], v[48:51], v[208:211]
    v_and_b32 v97, 0xffff0000, v84
    v_lshlrev_b32 v98, 16, v85
    v_and_b32 v99, 0xffff0000, v85
    v_lshlrev_b32 v100, 16, v86
    v_and_b32 v101, 0xffff0000, v86
    v_mfma_f32_16x16x32_bf16 v[192:195], v[156:159], v[52:55], v[192:195]
    v_lshlrev_b32 v102, 16, v87
    v_and_b32 v103, 0xffff0000, v87
    v_mul_f32 v96, v96, v32
    v_mul_f32 v97, v97, v33
    v_mul_f32 v98, v98, v34
    v_mfma_f32_16x16x32_bf16 v[212:215], v[160:163], v[52:55], v[212:215]
    v_mul_f32 v99, v99, v35
    v_mul_f32 v100, v100, v36
    v_mul_f32 v101, v101, v37
    v_mul_f32 v102, v102, v38
    v_mul_f32 v103, v103, v39
    v_mfma_f32_16x16x32_bf16 v[196:199], v[156:159], v[56:59], v[196:199]
    v_cvt_pk_bf16_f32 v84, v96, v97
    v_cvt_pk_bf16_f32 v85, v98, v99
    v_cvt_pk_bf16_f32 v86, v100, v101
    v_cvt_pk_bf16_f32 v87, v102, v103
    v_lshlrev_b32 v96, 16, v84
    v_mfma_f32_16x16x32_bf16 v[216:219], v[160:163], v[56:59], v[216:219]
    v_and_b32 v97, 0xffff0000, v84
    v_lshlrev_b32 v98, 16, v85
    v_and_b32 v99, 0xffff0000, v85
    v_lshlrev_b32 v100, 16, v86
    v_mfma_f32_16x16x32_bf16 v[200:203], v[156:159], v[60:63], v[200:203]
    v_and_b32 v101, 0xffff0000, v86
    v_lshlrev_b32 v102, 16, v87
    v_and_b32 v103, 0xffff0000, v87
    v_add_f32 v96, v96, v40
    v_mfma_f32_16x16x32_bf16 v[220:223], v[160:163], v[60:63], v[220:223]
    v_add_f32 v97, v97, v41
    v_add_f32 v98, v98, v42
    v_add_f32 v99, v99, v43
    v_add_f32 v100, v100, v44
    v_mfma_f32_16x16x32_bf16 v[204:207], v[156:159], v[64:67], v[204:207]
    v_add_f32 v101, v101, v45
    v_add_f32 v102, v102, v46
    v_add_f32 v103, v103, v47
    v_cvt_pk_bf16_f32 v84, v96, v97
    v_mfma_f32_16x16x32_bf16 v[224:227], v[160:163], v[64:67], v[224:227]
    v_cvt_pk_bf16_f32 v85, v98, v99
    v_cvt_pk_bf16_f32 v86, v100, v101
    v_cvt_pk_bf16_f32 v87, v102, v103
    ds_write_b128 v15, v[84:87] offset:55296
    ds_read_b128 v[48:51], v3 offset:6144
    ds_read_b128 v[52:55], v3 offset:24576
    ds_read_b128 v[56:59], v3 offset:43008
    ds_read_b128 v[60:63], v6 offset:6144
    ds_read_b128 v[64:67], v6 offset:24576
    s_add_u32 s41, s41, 4096
    s_add_u32 s42, s42, 4096
    buffer_load_dwordx4 v[156:159], v3, s[12:15], s41 offen offset:0
    buffer_load_dwordx4 v[160:163], v3, s[12:15], s42 offen offset:0
    s_waitcnt vmcnt(14)
    s_waitcnt lgkmcnt(5)
    v_mfma_f32_16x16x32_bf16 v[188:191], v[164:167], v[104:107], v[188:191]
    ds_read_b128 v[32:35], v11 offset:2304
    ds_read_b128 v[36:39], v11 offset:2320
    ds_read_b128 v[40:43], v11 offset:0
    ds_read_b128 v[44:47], v11 offset:16
    v_lshlrev_b32 v96, 16, v88
    v_mfma_f32_16x16x32_bf16 v[208:211], v[168:171], v[104:107], v[208:211]
    v_and_b32 v97, 0xffff0000, v88
    v_lshlrev_b32 v98, 16, v89
    v_and_b32 v99, 0xffff0000, v89
    v_lshlrev_b32 v100, 16, v90
    v_and_b32 v101, 0xffff0000, v90
    v_mfma_f32_16x16x32_bf16 v[192:195], v[164:167], v[108:111], v[192:195]
    v_lshlrev_b32 v102, 16, v91
    v_and_b32 v103, 0xffff0000, v91
    v_mul_f32 v96, v96, v16
    v_mul_f32 v97, v97, v17
    v_mul_f32 v98, v98, v18
    v_mfma_f32_16x16x32_bf16 v[212:215], v[168:171], v[108:111], v[212:215]
    v_mul_f32 v99, v99, v19
    v_mul_f32 v100, v100, v20
    v_mul_f32 v101, v101, v21
    v_mul_f32 v102, v102, v22
    v_mul_f32 v103, v103, v23
    v_mfma_f32_16x16x32_bf16 v[196:199], v[164:167], v[112:115], v[196:199]
    v_cvt_pk_bf16_f32 v88, v96, v97
    v_cvt_pk_bf16_f32 v89, v98, v99
    v_cvt_pk_bf16_f32 v90, v100, v101
    v_cvt_pk_bf16_f32 v91, v102, v103
    v_lshlrev_b32 v96, 16, v88
    v_mfma_f32_16x16x32_bf16 v[216:219], v[168:171], v[112:115], v[216:219]
    v_and_b32 v97, 0xffff0000, v88
    v_lshlrev_b32 v98, 16, v89
    v_and_b32 v99, 0xffff0000, v89
    v_lshlrev_b32 v100, 16, v90
    v_mfma_f32_16x16x32_bf16 v[200:203], v[164:167], v[116:119], v[200:203]
    v_and_b32 v101, 0xffff0000, v90
    v_lshlrev_b32 v102, 16, v91
    v_and_b32 v103, 0xffff0000, v91
    v_add_f32 v96, v96, v24
    v_mfma_f32_16x16x32_bf16 v[220:223], v[168:171], v[116:119], v[220:223]
    v_add_f32 v97, v97, v25
    v_add_f32 v98, v98, v26
    v_add_f32 v99, v99, v27
    v_add_f32 v100, v100, v28
    v_mfma_f32_16x16x32_bf16 v[204:207], v[164:167], v[120:123], v[204:207]
    v_add_f32 v101, v101, v29
    v_add_f32 v102, v102, v30
    v_add_f32 v103, v103, v31
    v_cvt_pk_bf16_f32 v88, v96, v97
    v_mfma_f32_16x16x32_bf16 v[224:227], v[168:171], v[120:123], v[224:227]
    v_cvt_pk_bf16_f32 v89, v98, v99
    v_cvt_pk_bf16_f32 v90, v100, v101
    v_cvt_pk_bf16_f32 v91, v102, v103
    ds_write_b128 v228, v[88:91]
    ds_read_b128 v[104:107], v3 offset:7168
    ds_read_b128 v[108:111], v3 offset:25600
    ds_read_b128 v[112:115], v3 offset:44032
    ds_read_b128 v[116:119], v6 offset:7168
    ds_read_b128 v[120:123], v6 offset:25600
    buffer_load_dwordx4 v[164:167], v3, s[12:15], s41 offen offset:1024
    buffer_load_dwordx4 v[168:171], v3, s[12:15], s42 offen offset:1024
    s_waitcnt vmcnt(14)
    s_waitcnt lgkmcnt(5)
    v_mfma_f32_16x16x32_bf16 v[188:191], v[172:175], v[48:51], v[188:191]
    v_lshlrev_b32 v96, 16, v92
    v_and_b32 v97, 0xffff0000, v92
    v_lshlrev_b32 v98, 16, v93
    v_and_b32 v99, 0xffff0000, v93
    v_lshlrev_b32 v100, 16, v94
    v_mfma_f32_16x16x32_bf16 v[208:211], v[176:179], v[48:51], v[208:211]
    v_and_b32 v101, 0xffff0000, v94
    v_lshlrev_b32 v102, 16, v95
    v_and_b32 v103, 0xffff0000, v95
    v_mul_f32 v96, v96, v32
    v_mfma_f32_16x16x32_bf16 v[192:195], v[172:175], v[52:55], v[192:195]
    v_mul_f32 v97, v97, v33
    v_mul_f32 v98, v98, v34
    v_mul_f32 v99, v99, v35
    v_mul_f32 v100, v100, v36
    v_mfma_f32_16x16x32_bf16 v[212:215], v[176:179], v[52:55], v[212:215]
    v_mul_f32 v101, v101, v37
    v_mul_f32 v102, v102, v38
    v_mul_f32 v103, v103, v39
    v_cvt_pk_bf16_f32 v92, v96, v97
    v_mfma_f32_16x16x32_bf16 v[196:199], v[172:175], v[56:59], v[196:199]
    v_cvt_pk_bf16_f32 v93, v98, v99
    v_cvt_pk_bf16_f32 v94, v100, v101
    v_cvt_pk_bf16_f32 v95, v102, v103
    v_lshlrev_b32 v96, 16, v92
    v_mfma_f32_16x16x32_bf16 v[216:219], v[176:179], v[56:59], v[216:219]
    v_and_b32 v97, 0xffff0000, v92
    v_lshlrev_b32 v98, 16, v93
    v_and_b32 v99, 0xffff0000, v93
    v_lshlrev_b32 v100, 16, v94
    v_mfma_f32_16x16x32_bf16 v[200:203], v[172:175], v[60:63], v[200:203]
    v_and_b32 v101, 0xffff0000, v94
    v_lshlrev_b32 v102, 16, v95
    v_and_b32 v103, 0xffff0000, v95
    v_add_f32 v96, v96, v40
    v_mfma_f32_16x16x32_bf16 v[220:223], v[176:179], v[60:63], v[220:223]
    v_add_f32 v97, v97, v41
    v_add_f32 v98, v98, v42
    v_add_f32 v99, v99, v43
    v_add_f32 v100, v100, v44
    v_mfma_f32_16x16x32_bf16 v[204:207], v[172:175], v[64:67], v[204:207]
    v_add_f32 v101, v101, v45
    v_add_f32 v102, v102, v46
    v_add_f32 v103, v103, v47
    v_cvt_pk_bf16_f32 v92, v96, v97
    v_mfma_f32_16x16x32_bf16 v[224:227], v[176:179], v[64:67], v[224:227]
    v_cvt_pk_bf16_f32 v93, v98, v99
    v_cvt_pk_bf16_f32 v94, v100, v101
    v_cvt_pk_bf16_f32 v95, v102, v103
    ds_write_b128 v229, v[92:95]
    s_waitcnt lgkmcnt(0)
    s_barrier
    ds_read_b128 v[48:51], v3 offset:8192
    ds_read_b128 v[52:55], v3 offset:26624
    ds_read_b128 v[56:59], v3 offset:45056
    ds_read_b128 v[60:63], v6 offset:8192
    ds_read_b128 v[64:67], v6 offset:26624
    buffer_load_dwordx4 v[172:175], v3, s[12:15], s41 offen offset:2048
    buffer_load_dwordx4 v[176:179], v3, s[12:15], s42 offen offset:2048
    s_waitcnt vmcnt(14)
    s_waitcnt lgkmcnt(5)
    v_mfma_f32_16x16x32_bf16 v[188:191], v[180:183], v[104:107], v[188:191]
    v_mfma_f32_16x16x32_bf16 v[208:211], v[184:187], v[104:107], v[208:211]
    v_mfma_f32_16x16x32_bf16 v[192:195], v[180:183], v[108:111], v[192:195]
    v_mfma_f32_16x16x32_bf16 v[212:215], v[184:187], v[108:111], v[212:215]
    v_mfma_f32_16x16x32_bf16 v[196:199], v[180:183], v[112:115], v[196:199]
    v_mfma_f32_16x16x32_bf16 v[216:219], v[184:187], v[112:115], v[216:219]
    v_mfma_f32_16x16x32_bf16 v[200:203], v[180:183], v[116:119], v[200:203]
    v_mfma_f32_16x16x32_bf16 v[220:223], v[184:187], v[116:119], v[220:223]
    v_mfma_f32_16x16x32_bf16 v[204:207], v[180:183], v[120:123], v[204:207]
    v_mfma_f32_16x16x32_bf16 v[224:227], v[184:187], v[120:123], v[224:227]
    ds_read_b128 v[104:107], v3 offset:9216
    ds_read_b128 v[108:111], v3 offset:27648
    ds_read_b128 v[112:115], v3 offset:46080
    ds_read_b128 v[116:119], v6 offset:9216
    ds_read_b128 v[120:123], v6 offset:27648
    buffer_load_dwordx4 v[180:183], v3, s[12:15], s41 offen offset:3072
    buffer_load_dwordx4 v[184:187], v3, s[12:15], s42 offen offset:3072
    s_waitcnt vmcnt(14)
    s_waitcnt lgkmcnt(5)
    v_mfma_f32_16x16x32_bf16 v[188:191], v[124:127], v[48:51], v[188:191]
    v_mfma_f32_16x16x32_bf16 v[208:211], v[128:131], v[48:51], v[208:211]
    v_mfma_f32_16x16x32_bf16 v[192:195], v[124:127], v[52:55], v[192:195]
    v_mfma_f32_16x16x32_bf16 v[212:215], v[128:131], v[52:55], v[212:215]
    v_mfma_f32_16x16x32_bf16 v[196:199], v[124:127], v[56:59], v[196:199]
    v_mfma_f32_16x16x32_bf16 v[216:219], v[128:131], v[56:59], v[216:219]
    v_mfma_f32_16x16x32_bf16 v[200:203], v[124:127], v[60:63], v[200:203]
    v_mfma_f32_16x16x32_bf16 v[220:223], v[128:131], v[60:63], v[220:223]
    v_mfma_f32_16x16x32_bf16 v[204:207], v[124:127], v[64:67], v[204:207]
    v_mfma_f32_16x16x32_bf16 v[224:227], v[128:131], v[64:67], v[224:227]
    ds_read_b128 v[48:51], v3 offset:10240
    ds_read_b128 v[52:55], v3 offset:28672
    ds_read_b128 v[56:59], v3 offset:47104
    ds_read_b128 v[60:63], v6 offset:10240
    ds_read_b128 v[64:67], v6 offset:28672
    s_add_u32 s41, s41, 4096
    s_add_u32 s42, s42, 4096
    buffer_load_dwordx4 v[124:127], v3, s[12:15], s41 offen offset:0
    buffer_load_dwordx4 v[128:131], v3, s[12:15], s42 offen offset:0
    s_waitcnt vmcnt(14)
    s_waitcnt lgkmcnt(5)
    v_mfma_f32_16x16x32_bf16 v[188:191], v[132:135], v[104:107], v[188:191]
    v_mfma_f32_16x16x32_bf16 v[208:211], v[136:139], v[104:107], v[208:211]
    v_mfma_f32_16x16x32_bf16 v[192:195], v[132:135], v[108:111], v[192:195]
    v_mfma_f32_16x16x32_bf16 v[212:215], v[136:139], v[108:111], v[212:215]
    v_mfma_f32_16x16x32_bf16 v[196:199], v[132:135], v[112:115], v[196:199]
    v_mfma_f32_16x16x32_bf16 v[216:219], v[136:139], v[112:115], v[216:219]
    v_mfma_f32_16x16x32_bf16 v[200:203], v[132:135], v[116:119], v[200:203]
    v_mfma_f32_16x16x32_bf16 v[220:223], v[136:139], v[116:119], v[220:223]
    v_mfma_f32_16x16x32_bf16 v[204:207], v[132:135], v[120:123], v[204:207]
    v_mfma_f32_16x16x32_bf16 v[224:227], v[136:139], v[120:123], v[224:227]
    ds_read_b128 v[104:107], v3 offset:11264
    ds_read_b128 v[108:111], v3 offset:29696
    ds_read_b128 v[112:115], v3 offset:48128
    ds_read_b128 v[116:119], v6 offset:11264
    ds_read_b128 v[120:123], v6 offset:29696
    buffer_load_dwordx4 v[132:135], v3, s[12:15], s41 offen offset:1024
    buffer_load_dwordx4 v[136:139], v3, s[12:15], s42 offen offset:1024
    s_waitcnt vmcnt(14)
    s_waitcnt lgkmcnt(5)
    v_mfma_f32_16x16x32_bf16 v[188:191], v[140:143], v[48:51], v[188:191]
    v_mfma_f32_16x16x32_bf16 v[208:211], v[144:147], v[48:51], v[208:211]
    v_mfma_f32_16x16x32_bf16 v[192:195], v[140:143], v[52:55], v[192:195]
    v_mfma_f32_16x16x32_bf16 v[212:215], v[144:147], v[52:55], v[212:215]
    v_mfma_f32_16x16x32_bf16 v[196:199], v[140:143], v[56:59], v[196:199]
    v_mfma_f32_16x16x32_bf16 v[216:219], v[144:147], v[56:59], v[216:219]
    v_mfma_f32_16x16x32_bf16 v[200:203], v[140:143], v[60:63], v[200:203]
    v_mfma_f32_16x16x32_bf16 v[220:223], v[144:147], v[60:63], v[220:223]
    v_mfma_f32_16x16x32_bf16 v[204:207], v[140:143], v[64:67], v[204:207]
    v_mfma_f32_16x16x32_bf16 v[224:227], v[144:147], v[64:67], v[224:227]
    ds_read_b128 v[48:51], v3 offset:12288
    ds_read_b128 v[52:55], v3 offset:30720
    ds_read_b128 v[56:59], v3 offset:49152
    ds_read_b128 v[60:63], v6 offset:12288
    ds_read_b128 v[64:67], v6 offset:30720
    s_waitcnt vmcnt(12)
    s_waitcnt lgkmcnt(5)
    v_mfma_f32_16x16x32_bf16 v[188:191], v[148:151], v[104:107], v[188:191]
    v_mfma_f32_16x16x32_bf16 v[208:211], v[152:155], v[104:107], v[208:211]
    v_mfma_f32_16x16x32_bf16 v[192:195], v[148:151], v[108:111], v[192:195]
    v_mfma_f32_16x16x32_bf16 v[212:215], v[152:155], v[108:111], v[212:215]
    v_mfma_f32_16x16x32_bf16 v[196:199], v[148:151], v[112:115], v[196:199]
    v_mfma_f32_16x16x32_bf16 v[216:219], v[152:155], v[112:115], v[216:219]
    v_mfma_f32_16x16x32_bf16 v[200:203], v[148:151], v[116:119], v[200:203]
    v_mfma_f32_16x16x32_bf16 v[220:223], v[152:155], v[116:119], v[220:223]
    v_mfma_f32_16x16x32_bf16 v[204:207], v[148:151], v[120:123], v[204:207]
    v_mfma_f32_16x16x32_bf16 v[224:227], v[152:155], v[120:123], v[224:227]
    ds_read_b128 v[104:107], v3 offset:13312
    ds_read_b128 v[108:111], v3 offset:31744
    ds_read_b128 v[112:115], v3 offset:50176
    ds_read_b128 v[116:119], v6 offset:13312
    ds_read_b128 v[120:123], v6 offset:31744
    s_waitcnt vmcnt(10)
    s_waitcnt lgkmcnt(5)
    v_mfma_f32_16x16x32_bf16 v[188:191], v[156:159], v[48:51], v[188:191]
    v_mfma_f32_16x16x32_bf16 v[208:211], v[160:163], v[48:51], v[208:211]
    v_mfma_f32_16x16x32_bf16 v[192:195], v[156:159], v[52:55], v[192:195]
    v_mfma_f32_16x16x32_bf16 v[212:215], v[160:163], v[52:55], v[212:215]
    v_mfma_f32_16x16x32_bf16 v[196:199], v[156:159], v[56:59], v[196:199]
    v_mfma_f32_16x16x32_bf16 v[216:219], v[160:163], v[56:59], v[216:219]
    v_mfma_f32_16x16x32_bf16 v[200:203], v[156:159], v[60:63], v[200:203]
    v_mfma_f32_16x16x32_bf16 v[220:223], v[160:163], v[60:63], v[220:223]
    v_mfma_f32_16x16x32_bf16 v[204:207], v[156:159], v[64:67], v[204:207]
    v_mfma_f32_16x16x32_bf16 v[224:227], v[160:163], v[64:67], v[224:227]
    ds_read_b128 v[48:51], v3 offset:14336
    ds_read_b128 v[52:55], v3 offset:32768
    ds_read_b128 v[56:59], v3 offset:51200
    ds_read_b128 v[60:63], v6 offset:14336
    ds_read_b128 v[64:67], v6 offset:32768
    s_waitcnt vmcnt(8)
    s_waitcnt lgkmcnt(5)
    v_mfma_f32_16x16x32_bf16 v[188:191], v[164:167], v[104:107], v[188:191]
    v_mfma_f32_16x16x32_bf16 v[208:211], v[168:171], v[104:107], v[208:211]
    v_mfma_f32_16x16x32_bf16 v[192:195], v[164:167], v[108:111], v[192:195]
    v_mfma_f32_16x16x32_bf16 v[212:215], v[168:171], v[108:111], v[212:215]
    v_mfma_f32_16x16x32_bf16 v[196:199], v[164:167], v[112:115], v[196:199]
    v_mfma_f32_16x16x32_bf16 v[216:219], v[168:171], v[112:115], v[216:219]
    v_mfma_f32_16x16x32_bf16 v[200:203], v[164:167], v[116:119], v[200:203]
    v_mfma_f32_16x16x32_bf16 v[220:223], v[168:171], v[116:119], v[220:223]
    v_mfma_f32_16x16x32_bf16 v[204:207], v[164:167], v[120:123], v[204:207]
    v_mfma_f32_16x16x32_bf16 v[224:227], v[168:171], v[120:123], v[224:227]
    ds_read_b128 v[104:107], v3 offset:15360
    ds_read_b128 v[108:111], v3 offset:33792
    ds_read_b128 v[112:115], v3 offset:52224
    ds_read_b128 v[116:119], v6 offset:15360
    ds_read_b128 v[120:123], v6 offset:33792
    s_waitcnt vmcnt(6)
    s_waitcnt lgkmcnt(5)
    v_mfma_f32_16x16x32_bf16 v[188:191], v[172:175], v[48:51], v[188:191]
    v_mfma_f32_16x16x32_bf16 v[208:211], v[176:179], v[48:51], v[208:211]
    v_mfma_f32_16x16x32_bf16 v[192:195], v[172:175], v[52:55], v[192:195]
    v_mfma_f32_16x16x32_bf16 v[212:215], v[176:179], v[52:55], v[212:215]
    v_mfma_f32_16x16x32_bf16 v[196:199], v[172:175], v[56:59], v[196:199]
    v_mfma_f32_16x16x32_bf16 v[216:219], v[176:179], v[56:59], v[216:219]
    v_mfma_f32_16x16x32_bf16 v[200:203], v[172:175], v[60:63], v[200:203]
    v_mfma_f32_16x16x32_bf16 v[220:223], v[176:179], v[60:63], v[220:223]
    v_mfma_f32_16x16x32_bf16 v[204:207], v[172:175], v[64:67], v[204:207]
    v_mfma_f32_16x16x32_bf16 v[224:227], v[176:179], v[64:67], v[224:227]
    ds_read_b128 v[48:51], v3 offset:16384
    ds_read_b128 v[52:55], v3 offset:34816
    ds_read_b128 v[56:59], v3 offset:53248
    ds_read_b128 v[60:63], v6 offset:16384
    ds_read_b128 v[64:67], v6 offset:34816
    s_waitcnt vmcnt(4)
    s_waitcnt lgkmcnt(5)
    v_mfma_f32_16x16x32_bf16 v[188:191], v[180:183], v[104:107], v[188:191]
    v_mfma_f32_16x16x32_bf16 v[208:211], v[184:187], v[104:107], v[208:211]
    v_mfma_f32_16x16x32_bf16 v[192:195], v[180:183], v[108:111], v[192:195]
    v_mfma_f32_16x16x32_bf16 v[212:215], v[184:187], v[108:111], v[212:215]
    v_mfma_f32_16x16x32_bf16 v[196:199], v[180:183], v[112:115], v[196:199]
    v_mfma_f32_16x16x32_bf16 v[216:219], v[184:187], v[112:115], v[216:219]
    v_mfma_f32_16x16x32_bf16 v[200:203], v[180:183], v[116:119], v[200:203]
    v_mfma_f32_16x16x32_bf16 v[220:223], v[184:187], v[116:119], v[220:223]
    v_mfma_f32_16x16x32_bf16 v[204:207], v[180:183], v[120:123], v[204:207]
    v_mfma_f32_16x16x32_bf16 v[224:227], v[184:187], v[120:123], v[224:227]
    ds_read_b128 v[104:107], v3 offset:17408
    ds_read_b128 v[108:111], v3 offset:35840
    ds_read_b128 v[112:115], v3 offset:54272
    ds_read_b128 v[116:119], v6 offset:17408
    ds_read_b128 v[120:123], v6 offset:35840
    s_waitcnt vmcnt(2)
    s_waitcnt lgkmcnt(5)
    v_mfma_f32_16x16x32_bf16 v[188:191], v[124:127], v[48:51], v[188:191]
    v_mfma_f32_16x16x32_bf16 v[208:211], v[128:131], v[48:51], v[208:211]
    v_mfma_f32_16x16x32_bf16 v[192:195], v[124:127], v[52:55], v[192:195]
    v_mfma_f32_16x16x32_bf16 v[212:215], v[128:131], v[52:55], v[212:215]
    v_mfma_f32_16x16x32_bf16 v[196:199], v[124:127], v[56:59], v[196:199]
    v_mfma_f32_16x16x32_bf16 v[216:219], v[128:131], v[56:59], v[216:219]
    v_mfma_f32_16x16x32_bf16 v[200:203], v[124:127], v[60:63], v[200:203]
    v_mfma_f32_16x16x32_bf16 v[220:223], v[128:131], v[60:63], v[220:223]
    v_mfma_f32_16x16x32_bf16 v[204:207], v[124:127], v[64:67], v[204:207]
    v_mfma_f32_16x16x32_bf16 v[224:227], v[128:131], v[64:67], v[224:227]
    s_waitcnt vmcnt(0)
    s_waitcnt lgkmcnt(0)
    v_mfma_f32_16x16x32_bf16 v[188:191], v[132:135], v[104:107], v[188:191]
    v_mfma_f32_16x16x32_bf16 v[208:211], v[136:139], v[104:107], v[208:211]
    v_mfma_f32_16x16x32_bf16 v[192:195], v[132:135], v[108:111], v[192:195]
    v_mfma_f32_16x16x32_bf16 v[212:215], v[136:139], v[108:111], v[212:215]
    v_mfma_f32_16x16x32_bf16 v[196:199], v[132:135], v[112:115], v[196:199]
    v_mfma_f32_16x16x32_bf16 v[216:219], v[136:139], v[112:115], v[216:219]
    v_mfma_f32_16x16x32_bf16 v[200:203], v[132:135], v[116:119], v[200:203]
    v_mfma_f32_16x16x32_bf16 v[220:223], v[136:139], v[116:119], v[220:223]
    v_mfma_f32_16x16x32_bf16 v[204:207], v[132:135], v[120:123], v[204:207]
    v_mfma_f32_16x16x32_bf16 v[224:227], v[136:139], v[120:123], v[224:227]
    v_and_b32 v6, 15, v1
    v_mul_u32_u24 v6, 488, v6
    v_lshl_add_u32 v6, v4, 3, v6
    s_lshl_b32 s31, s3, 6
    s_add_u32 s31, s31, 92160
    v_add_u32 v6, s31, v6
    v_cvt_pk_bf16_f32 v60, v188, v189
    v_cvt_pk_bf16_f32 v61, v190, v191
    ds_write_b64 v6, v[60:61] offset:0
    v_cvt_pk_bf16_f32 v62, v192, v193
    v_cvt_pk_bf16_f32 v63, v194, v195
    ds_write_b64 v6, v[62:63] offset:7808
    v_cvt_pk_bf16_f32 v64, v196, v197
    v_cvt_pk_bf16_f32 v65, v198, v199
    ds_write_b64 v6, v[64:65] offset:15616
    v_cvt_pk_bf16_f32 v66, v200, v201
    v_cvt_pk_bf16_f32 v67, v202, v203
    ds_write_b64 v6, v[66:67] offset:23424
    v_cvt_pk_bf16_f32 v68, v204, v205
    v_cvt_pk_bf16_f32 v69, v206, v207
    ds_write_b64 v6, v[68:69] offset:31232
    s_cmp_eq_u32 s3, 7
    s_cbranch_scc1 k1_skip_t1
    v_cvt_pk_bf16_f32 v60, v208, v209
    v_cvt_pk_bf16_f32 v61, v210, v211
    ds_write_b64 v6, v[60:61] offset:32
    v_cvt_pk_bf16_f32 v62, v212, v213
    v_cvt_pk_bf16_f32 v63, v214, v215
    ds_write_b64 v6, v[62:63] offset:7840
    v_cvt_pk_bf16_f32 v64, v216, v217
    v_cvt_pk_bf16_f32 v65, v218, v219
    ds_write_b64 v6, v[64:65] offset:15648
    v_cvt_pk_bf16_f32 v66, v220, v221
    v_cvt_pk_bf16_f32 v67, v222, v223
    ds_write_b64 v6, v[66:67] offset:23456
    v_cvt_pk_bf16_f32 v68, v224, v225
    v_cvt_pk_bf16_f32 v69, v226, v227
    ds_write_b64 v6, v[68:69] offset:31264
k1_skip_t1:
    s_waitcnt lgkmcnt(0)
    s_barrier
    s_sub_u32 s31, s3, 2
    s_cmp_ge_u32 s31, 2
    s_cbranch_scc1 k1_nopfw
    v_subrev_u32 v236, 128, v0
    v_min_u32 v236, 71, v236
    v_cmp_le_u32 vcc, 36, v236
    v_subrev_u32 v237, 36, v236
    s_nop 0
    v_cndmask_b32 v236, v236, v237, vcc
    v_mul_u32_u24 v237, 57, v236
    v_lshrrev_b32 v237, 9, v237
    v_mul_u32_u24 v238, 9, v237
    v_sub_u32 v238, v236, v238
    v_mul_u32_u24 v237, 9216, v237
    v_lshl_add_u32 v237, v238, 7, v237
    s_lshr_b32 s31, s2, 3
    s_mul_i32 s31, s31, 36864
    s_and_b32 s32, s2, 7
    s_mul_i32 s32, s32, 1152
    s_add_u32 s31, s31, s32
    v_add_u32 v237, s31, v237
    v_mov_b32 v238, s16
    v_mov_b32 v239, s17
    v_mov_b32 v240, s18
    v_mov_b32 v241, s19
    v_cndmask_b32 v238, v238, v240, vcc
    v_cndmask_b32 v239, v239, v241, vcc
    v_add_co_u32 v238, vcc, v238, v237
    s_nop 1
    v_addc_co_u32 v239, vcc, 0, v239, vcc
    global_load_dword v242, v[238:239], off
k1_nopfw:
    s_and_b32 s50, s4, 1
    s_lshr_b32 s51, s4, 1
    s_lshl_b32 s52, s5, 2
    s_lshl_b32 s53, s50, 1
    s_add_u32 s52, s52, s53
    s_mul_i32 s53, s51, 9
    s_add_u32 s54, s53, s3
    s_mul_i32 s55, s54, 18432
    s_add_u32 s55, s55, 7340032
    v_add_u32 v216, 4096, v3
    v_add_u32 v217, 8192, v3
    v_add_u32 v218, 12288, v3
    v_add_u32 v219, 16384, v3
    v_and_b32 v220, 15, v1
    s_lshl_b32 s31, s52, 4
    v_add_u32 v220, s31, v220
    v_mul_u32_u24 v221, 1152, v220
    v_lshl_add_u32 v221, v4, 3, v221
    s_lshl_b32 s31, s54, 5
    v_add_u32 v222, s31, v221
    v_add_u32 v223, 18432, v222
    v_lshlrev_b32 v224, 4, v4
    s_lshl_b32 s31, s54, 6
    v_add_u32 v225, s31, v224
    s_mov_b32 s56, 4608
    s_mov_b32 s57, 9216
    v_and_b32 v6, 1, v1
    v_bfe_u32 v7, v1, 1, 2
    v_lshrrev_b32 v8, 3, v1
    s_lshl_b32 s31, s3, 3
    v_add_u32 v8, s31, v8
    v_mul_u32_u24 v9, 488, v8
    v_mul_u32_u24 v10, 40, v7
    v_add_u32 v9, v9, v10
    v_add_u32 v9, 99968, v9
    v_mul_u32_u24 v10, 3904, v6
    v_sub_u32 v11, v9, v10
    buffer_load_dwordx4 v[128:131], v3, s[12:15], s55 offen offset:0
    v_add_u32 v12, -2768, v11
    v_lshl_add_u32 v13, v6, 4, v11
    v_add_u32 v13, -2608, v13
    v_add_u32 v14, v9, v10
    v_lshl_add_u32 v14, v6, 4, v14
    v_add_u32 v14, -6512, v14
    ds_read_b64 v[16:17], v9 offset:0
    ds_read_b64 v[18:19], v9 offset:8
    ds_read_b64 v[20:21], v9 offset:16
    ds_read_b64 v[22:23], v9 offset:24
    ds_read_b64 v[24:25], v9 offset:32
    ds_read_b64 v[32:33], v12 offset:2928
    ds_read_b64 v[34:35], v12 offset:2936
    ds_read_b64 v[36:37], v12 offset:2944
    ds_read_b64 v[38:39], v12 offset:2952
    ds_read_b64 v[40:41], v12 offset:2960
    ds_read_b64 v[42:43], v12 offset:1952
    ds_read_b64 v[44:45], v12 offset:1960
    ds_read_b64 v[46:47], v12 offset:1968
    ds_read_b64 v[48:49], v12 offset:1976
    ds_read_b64 v[50:51], v12 offset:1984
    ds_read_b64 v[52:53], v12 offset:976
    ds_read_b64 v[54:55], v12 offset:984
    ds_read_b64 v[56:57], v12 offset:992
    ds_read_b64 v[58:59], v12 offset:1000
    ds_read_b64 v[60:61], v12 offset:1008
    ds_read_b64 v[62:63], v12 offset:0
    ds_read_b64 v[64:65], v12 offset:8
    ds_read_b64 v[66:67], v12 offset:16
    ds_read_b64 v[68:69], v12 offset:24
    ds_read_b64 v[70:71], v12 offset:32
    ds_read_b64 v[80:81], v13 offset:2928
    ds_read_b64 v[82:83], v13 offset:2936
    ds_read_b64 v[84:85], v13 offset:2944
    ds_read_b64 v[86:87], v13 offset:1952
    ds_read_b64 v[88:89], v13 offset:1960
    ds_read_b64 v[90:91], v13 offset:1968
    ds_read_b64 v[92:93], v13 offset:976
    ds_read_b64 v[94:95], v13 offset:984
    ds_read_b64 v[96:97], v13 offset:992
    ds_read_b64 v[98:99], v13 offset:0
    ds_read_b64 v[100:101], v13 offset:8
    ds_read_b64 v[102:103], v13 offset:16
    ds_read_b64 v[104:105], v14 offset:2928
    ds_read_b64 v[106:107], v14 offset:2936
    ds_read_b64 v[108:109], v14 offset:2944
    ds_read_b64 v[110:111], v14 offset:1952
    ds_read_b64 v[112:113], v14 offset:1960
    ds_read_b64 v[114:115], v14 offset:1968
    ds_read_b64 v[116:117], v14 offset:976
    ds_read_b64 v[118:119], v14 offset:984
    ds_read_b64 v[120:121], v14 offset:992
    ds_read_b64 v[122:123], v14 offset:0
    ds_read_b64 v[124:125], v14 offset:8
    ds_read_b64 v[126:127], v14 offset:16
    s_lshl_b32 s31, s5, 6
    v_add_u32 v15, s31, v8
    v_lshlrev_b32 v26, 3, v6
    v_sub_u32 v15, v15, v26
    v_mov_b32 v27, 0xce6e6b28
    buffer_load_dwordx4 v[132:135], v3, s[12:15], s55 offen offset:1024
    s_waitcnt lgkmcnt(15)
    s_waitcnt lgkmcnt(0)
    v_dot2_f32_bf16 v28, v16, v32, 0
    v_dot2_f32_bf16 v29, v16, v42, 0
    v_dot2_f32_bf16 v30, v16, v52, 0
    v_dot2_f32_bf16 v31, v16, v62, 0
    v_dot2_f32_bf16 v28, v17, v33, v28
    v_dot2_f32_bf16 v29, v17, v43, v29
    v_dot2_f32_bf16 v30, v17, v53, v30
    v_dot2_f32_bf16 v31, v17, v63, v31
    v_dot2_f32_bf16 v28, v18, v34, v28
    v_dot2_f32_bf16 v29, v18, v44, v29
    buffer_load_dwordx4 v[136:139], v3, s[12:15], s55 offen offset:2048
    v_dot2_f32_bf16 v30, v18, v54, v30
    v_dot2_f32_bf16 v31, v18, v64, v31
    v_dot2_f32_bf16 v28, v19, v35, v28
    v_dot2_f32_bf16 v29, v19, v45, v29
    v_dot2_f32_bf16 v30, v19, v55, v30
    v_dot2_f32_bf16 v31, v19, v65, v31
    v_dot2_f32_bf16 v28, v20, v36, v28
    v_dot2_f32_bf16 v29, v20, v46, v29
    v_dot2_f32_bf16 v30, v20, v56, v30
    v_dot2_f32_bf16 v31, v20, v66, v31
    buffer_load_dwordx4 v[140:143], v3, s[12:15], s55 offen offset:3072
    v_dot2_f32_bf16 v28, v21, v37, v28
    v_dot2_f32_bf16 v29, v21, v47, v29
    v_dot2_f32_bf16 v30, v21, v57, v30
    v_dot2_f32_bf16 v31, v21, v67, v31
    v_dot2_f32_bf16 v28, v22, v38, v28
    v_dot2_f32_bf16 v29, v22, v48, v29
    v_dot2_f32_bf16 v30, v22, v58, v30
    v_dot2_f32_bf16 v31, v22, v68, v31
    v_dot2_f32_bf16 v28, v23, v39, v28
    v_dot2_f32_bf16 v29, v23, v49, v29
    buffer_load_dwordx4 v[144:147], v216, s[12:15], s55 offen offset:0
    v_dot2_f32_bf16 v30, v23, v59, v30
    v_dot2_f32_bf16 v31, v23, v69, v31
    v_dot2_f32_bf16 v28, v24, v40, v28
    v_dot2_f32_bf16 v29, v24, v50, v29
    v_dot2_f32_bf16 v30, v24, v60, v30
    v_dot2_f32_bf16 v31, v24, v70, v31
    v_cvt_pk_bf16_f32 v28, v28, v28
    v_lshlrev_b32 v28, 16, v28
    v_mul_f32 v28, 0x3e715bef, v28
    v_cvt_pk_bf16_f32 v28, v28, v28
    buffer_load_dwordx4 v[148:151], v216, s[12:15], s55 offen offset:1024
    v_lshlrev_b32 v28, 16, v28
    v_cmp_gt_i32 vcc, 0, v15
    s_nop 1
    v_cndmask_b32 v28, v28, v27, vcc
    v_cvt_pk_bf16_f32 v29, v29, v29
    v_lshlrev_b32 v29, 16, v29
    v_mul_f32 v29, 0x3e715bef, v29
    v_cvt_pk_bf16_f32 v29, v29, v29
    v_lshlrev_b32 v29, 16, v29
    v_cmp_gt_i32 vcc, 2, v15
    s_nop 1
    v_cndmask_b32 v29, v29, v27, vcc
    buffer_load_dwordx4 v[152:155], v216, s[12:15], s55 offen offset:2048
    v_cvt_pk_bf16_f32 v30, v30, v30
    v_lshlrev_b32 v30, 16, v30
    v_mul_f32 v30, 0x3e715bef, v30
    v_cvt_pk_bf16_f32 v30, v30, v30
    v_lshlrev_b32 v30, 16, v30
    v_cmp_gt_i32 vcc, 4, v15
    s_nop 1
    v_cndmask_b32 v30, v30, v27, vcc
    v_cvt_pk_bf16_f32 v31, v31, v31
    v_lshlrev_b32 v31, 16, v31
    v_mul_f32 v31, 0x3e715bef, v31
    buffer_load_dwordx4 v[156:159], v216, s[12:15], s55 offen offset:3072
    v_cvt_pk_bf16_f32 v31, v31, v31
    v_lshlrev_b32 v31, 16, v31
    v_cmp_gt_i32 vcc, 6, v15
    s_nop 1
    v_cndmask_b32 v31, v31, v27, vcc
    v_mov_b32_dpp v32, v28 quad_perm:[1,0,3,2] row_mask:0xf bank_mask:0xf
    v_mov_b32_dpp v33, v29 quad_perm:[1,0,3,2] row_mask:0xf bank_mask:0xf
    v_mov_b32_dpp v34, v30 quad_perm:[1,0,3,2] row_mask:0xf bank_mask:0xf
    v_mov_b32_dpp v35, v31 quad_perm:[1,0,3,2] row_mask:0xf bank_mask:0xf
    v_max3_f32 v36, v28, v29, v30
    v_max3_f32 v36, v36, v31, v32
    buffer_load_dwordx4 v[160:163], v217, s[12:15], s55 offen offset:0
    v_max3_f32 v36, v36, v33, v34
    v_max_f32 v36, v36, v35
    v_sub_f32 v28, v28, v36
    v_mul_f32 v28, 0x3fb8aa3b, v28
    v_exp_f32 v28, v28
    v_sub_f32 v29, v29, v36
    v_mul_f32 v29, 0x3fb8aa3b, v29
    v_exp_f32 v29, v29
    v_sub_f32 v30, v30, v36
    v_mul_f32 v30, 0x3fb8aa3b, v30
    buffer_load_dwordx4 v[164:167], v217, s[12:15], s55 offen offset:1024
    v_exp_f32 v30, v30
    v_sub_f32 v31, v31, v36
    v_mul_f32 v31, 0x3fb8aa3b, v31
    v_exp_f32 v31, v31
    v_sub_f32 v32, v32, v36
    v_mul_f32 v32, 0x3fb8aa3b, v32
    v_exp_f32 v32, v32
    v_sub_f32 v33, v33, v36
    v_mul_f32 v33, 0x3fb8aa3b, v33
    v_exp_f32 v33, v33
    buffer_load_dwordx4 v[168:171], v217, s[12:15], s55 offen offset:2048
    v_sub_f32 v34, v34, v36
    v_mul_f32 v34, 0x3fb8aa3b, v34
    v_exp_f32 v34, v34
    v_sub_f32 v35, v35, v36
    v_mul_f32 v35, 0x3fb8aa3b, v35
    v_exp_f32 v35, v35
    v_add_f32 v36, v28, v29
    v_add_f32 v37, v30, v31
    v_add_f32 v38, v32, v33
    v_add_f32 v39, v34, v35
    buffer_load_dwordx4 v[172:175], v217, s[12:15], s55 offen offset:3072
    v_add_f32 v36, v36, v37
    v_add_f32 v38, v38, v39
    v_add_f32 v36, v36, v38
    v_rcp_f32 v36, v36
    s_nop 0
    v_mul_f32 v28, v28, v36
    v_cvt_pk_bf16_f32 v40, v28, 0
    v_lshlrev_b32 v48, 16, v40
    v_mul_f32 v29, v29, v36
    v_cvt_pk_bf16_f32 v41, v29, 0
    v_lshlrev_b32 v49, 16, v41
    buffer_load_dwordx4 v[176:179], v218, s[12:15], s55 offen offset:0
    v_mul_f32 v30, v30, v36
    v_cvt_pk_bf16_f32 v42, v30, 0
    v_lshlrev_b32 v50, 16, v42
    v_mul_f32 v31, v31, v36
    v_cvt_pk_bf16_f32 v43, v31, 0
    v_lshlrev_b32 v51, 16, v43
    v_mul_f32 v32, v32, v36
    v_cvt_pk_bf16_f32 v44, v32, 0
    v_lshlrev_b32 v52, 16, v44
    v_mul_f32 v33, v33, v36
    buffer_load_dwordx4 v[180:183], v218, s[12:15], s55 offen offset:1024
    v_cvt_pk_bf16_f32 v45, v33, 0
    v_lshlrev_b32 v53, 16, v45
    v_mul_f32 v34, v34, v36
    v_cvt_pk_bf16_f32 v46, v34, 0
    v_lshlrev_b32 v54, 16, v46
    v_mul_f32 v35, v35, v36
    v_cvt_pk_bf16_f32 v47, v35, 0
    v_lshlrev_b32 v55, 16, v47
    v_dot2_f32_bf16 v60, v80, v40, 0
    v_dot2_f32_bf16 v61, v80, v48, 0
    buffer_load_dwordx4 v[184:187], v218, s[12:15], s55 offen offset:2048
    v_dot2_f32_bf16 v62, v81, v40, 0
    v_dot2_f32_bf16 v63, v81, v48, 0
    v_dot2_f32_bf16 v64, v82, v40, 0
    v_dot2_f32_bf16 v65, v82, v48, 0
    v_dot2_f32_bf16 v66, v83, v40, 0
    v_dot2_f32_bf16 v67, v83, v48, 0
    v_dot2_f32_bf16 v68, v84, v40, 0
    v_dot2_f32_bf16 v69, v84, v48, 0
    v_dot2_f32_bf16 v60, v86, v41, v60
    v_dot2_f32_bf16 v61, v86, v49, v61
    buffer_load_dwordx4 v[188:191], v218, s[12:15], s55 offen offset:3072
    v_dot2_f32_bf16 v62, v87, v41, v62
    v_dot2_f32_bf16 v63, v87, v49, v63
    v_dot2_f32_bf16 v64, v88, v41, v64
    v_dot2_f32_bf16 v65, v88, v49, v65
    v_dot2_f32_bf16 v66, v89, v41, v66
    v_dot2_f32_bf16 v67, v89, v49, v67
    v_dot2_f32_bf16 v68, v90, v41, v68
    v_dot2_f32_bf16 v69, v90, v49, v69
    v_dot2_f32_bf16 v60, v92, v42, v60
    v_dot2_f32_bf16 v61, v92, v50, v61
    buffer_load_dwordx4 v[192:195], v219, s[12:15], s55 offen offset:0
    v_dot2_f32_bf16 v62, v93, v42, v62
    v_dot2_f32_bf16 v63, v93, v50, v63
    v_dot2_f32_bf16 v64, v94, v42, v64
    v_dot2_f32_bf16 v65, v94, v50, v65
    v_dot2_f32_bf16 v66, v95, v42, v66
    v_dot2_f32_bf16 v67, v95, v50, v67
    v_dot2_f32_bf16 v68, v96, v42, v68
    v_dot2_f32_bf16 v69, v96, v50, v69
    v_dot2_f32_bf16 v60, v98, v43, v60
    v_dot2_f32_bf16 v61, v98, v51, v61
    buffer_load_dwordx4 v[196:199], v219, s[12:15], s55 offen offset:1024
    v_dot2_f32_bf16 v62, v99, v43, v62
    v_dot2_f32_bf16 v63, v99, v51, v63
    v_dot2_f32_bf16 v64, v100, v43, v64
    v_dot2_f32_bf16 v65, v100, v51, v65
    v_dot2_f32_bf16 v66, v101, v43, v66
    v_dot2_f32_bf16 v67, v101, v51, v67
    v_dot2_f32_bf16 v68, v102, v43, v68
    v_dot2_f32_bf16 v69, v102, v51, v69
    v_dot2_f32_bf16 v60, v104, v44, v60
    v_dot2_f32_bf16 v61, v104, v52, v61
    global_load_dwordx2 v[200:201], v222, s[8:9]
    v_dot2_f32_bf16 v62, v105, v44, v62
    v_dot2_f32_bf16 v63, v105, v52, v63
    v_dot2_f32_bf16 v64, v106, v44, v64
    v_dot2_f32_bf16 v65, v106, v52, v65
    v_dot2_f32_bf16 v66, v107, v44, v66
    v_dot2_f32_bf16 v67, v107, v52, v67
    v_dot2_f32_bf16 v68, v108, v44, v68
    v_dot2_f32_bf16 v69, v108, v52, v69
    v_dot2_f32_bf16 v60, v110, v45, v60
    v_dot2_f32_bf16 v61, v110, v53, v61
    global_load_dwordx2 v[202:203], v223, s[8:9]
    v_dot2_f32_bf16 v62, v111, v45, v62
    v_dot2_f32_bf16 v63, v111, v53, v63
    v_dot2_f32_bf16 v64, v112, v45, v64
    v_dot2_f32_bf16 v65, v112, v53, v65
    v_dot2_f32_bf16 v66, v113, v45, v66
    v_dot2_f32_bf16 v67, v113, v53, v67
    v_dot2_f32_bf16 v68, v114, v45, v68
    v_dot2_f32_bf16 v69, v114, v53, v69
    v_dot2_f32_bf16 v60, v116, v46, v60
    v_dot2_f32_bf16 v61, v116, v54, v61
    buffer_load_dwordx4 v[204:207], v225, s[12:15], s56 offen
    v_dot2_f32_bf16 v62, v117, v46, v62
    v_dot2_f32_bf16 v63, v117, v54, v63
    v_dot2_f32_bf16 v64, v118, v46, v64
    v_dot2_f32_bf16 v65, v118, v54, v65
    v_dot2_f32_bf16 v66, v119, v46, v66
    v_dot2_f32_bf16 v67, v119, v54, v67
    v_dot2_f32_bf16 v68, v120, v46, v68
    v_dot2_f32_bf16 v69, v120, v54, v69
    v_dot2_f32_bf16 v60, v122, v47, v60
    v_dot2_f32_bf16 v61, v122, v55, v61
    buffer_load_dwordx4 v[208:211], v225, s[12:15], s57 offen
    v_dot2_f32_bf16 v62, v123, v47, v62
    v_dot2_f32_bf16 v63, v123, v55, v63
    v_dot2_f32_bf16 v64, v124, v47, v64
    v_dot2_f32_bf16 v65, v124, v55, v65
    v_dot2_f32_bf16 v66, v125, v47, v66
    v_dot2_f32_bf16 v67, v125, v55, v67
    v_dot2_f32_bf16 v68, v126, v47, v68
    v_dot2_f32_bf16 v69, v126, v55, v69
    v_mul_u32_u24 v9, 160, v8
    v_mul_u32_u24 v10, 36, v7
    v_add_u32 v9, v9, v10
    v_lshl_add_u32 v9, v6, 4, v9
    v_cvt_pk_bf16_f32 v70, v60, v61
    ds_write_b32 v9, v70 offset:0
    v_cvt_pk_bf16_f32 v71, v62, v63
    ds_write_b32 v9, v71 offset:4
    v_cvt_pk_bf16_f32 v72, v64, v65
    ds_write_b32 v9, v72 offset:8
    v_cvt_pk_bf16_f32 v73, v66, v67
    ds_write_b32 v9, v73 offset:12
    v_cvt_pk_bf16_f32 v74, v68, v69
    ds_write_b32 v9, v74 offset:16
    s_waitcnt lgkmcnt(0)
    s_barrier
    v_mul_u32_u24 v6, 160, v1
    s_lshl_b32 s31, s3, 4
    v_add_u32 v6, s31, v6
    ds_read_b128 v[16:19], v6
    ds_read_b128 v[20:23], v6 offset:128
    v_mul_u32_u24 v7, 18432, v4
    v_and_b32 v8, 15, v1
    v_lshl_add_u32 v7, v8, 4, v7
    s_mul_i32 s31, s5, 73728
    s_mul_i32 s32, s4, 9
    s_add_u32 s32, s32, s3
    s_lshl_b32 s32, s32, 8
    s_add_u32 s31, s31, s32
    s_add_u32 s31, s31, 8388608
    s_waitcnt lgkmcnt(0)
    buffer_store_dwordx4 v[16:19], v7, s[12:15], s31 offen sc1
    s_cmp_lg_u32 s3, 0
    s_cbranch_scc1 k1_st1
    buffer_store_dwordx4 v[20:23], v7, s[12:15], s31 offen offset:2048 sc1
k1_st1:
    s_waitcnt vmcnt(0)
    s_barrier
    s_lshl_b32 s33, s5, 8
    s_add_u32 s33, s33, 131072
    v_mov_b32 v9, s33
    s_cmp_lg_u32 s3, 7
    s_cbranch_scc1 k1_nosig
    v_mov_b32 v8, 1
    s_mov_b64 exec, 1
    global_atomic_add v9, v8, s[86:87]
    s_mov_b64 exec, -1
k1_nosig:
    s_cmp_ge_u32 s3, 2
    s_cbranch_scc1 k1_noextra
    s_add_u32 s58, s53, 8
    s_mul_i32 s59, s58, 18432
    s_add_u32 s59, s59, 7340032
    buffer_load_dwordx4 v[16:19], v3, s[12:15], s59 offen offset:0
    buffer_load_dwordx4 v[20:23], v3, s[12:15], s59 offen offset:1024
    buffer_load_dwordx4 v[24:27], v3, s[12:15], s59 offen offset:2048
    buffer_load_dwordx4 v[28:31], v3, s[12:15], s59 offen offset:3072
    buffer_load_dwordx4 v[32:35], v216, s[12:15], s59 offen offset:0
    buffer_load_dwordx4 v[36:39], v216, s[12:15], s59 offen offset:1024
    buffer_load_dwordx4 v[40:43], v216, s[12:15], s59 offen offset:2048
    buffer_load_dwordx4 v[44:47], v216, s[12:15], s59 offen offset:3072
    buffer_load_dwordx4 v[48:51], v217, s[12:15], s59 offen offset:0
    buffer_load_dwordx4 v[52:55], v217, s[12:15], s59 offen offset:1024
    buffer_load_dwordx4 v[56:59], v217, s[12:15], s59 offen offset:2048
    buffer_load_dwordx4 v[60:63], v217, s[12:15], s59 offen offset:3072
    buffer_load_dwordx4 v[64:67], v218, s[12:15], s59 offen offset:0
    buffer_load_dwordx4 v[68:71], v218, s[12:15], s59 offen offset:1024
    buffer_load_dwordx4 v[72:75], v218, s[12:15], s59 offen offset:2048
    buffer_load_dwordx4 v[76:79], v218, s[12:15], s59 offen offset:3072
    buffer_load_dwordx4 v[80:83], v219, s[12:15], s59 offen offset:0
    buffer_load_dwordx4 v[84:87], v219, s[12:15], s59 offen offset:1024
    s_lshl_b32 s31, s58, 5
    s_mul_i32 s32, s3, 18432
    s_add_u32 s31, s31, s32
    v_add_u32 v10, s31, v221
    global_load_dwordx2 v[88:89], v10, s[8:9]
    s_lshl_b32 s31, s58, 6
    v_add_u32 v10, s31, v224
    buffer_load_dwordx4 v[92:95], v10, s[12:15], s56 offen
    buffer_load_dwordx4 v[96:99], v10, s[12:15], s57 offen
k1_noextra:
    s_mov_b32 s37, 0
    s_cmp_lg_u32 s3, 7
    s_cbranch_scc1 k1_ready
    s_mov_b64 exec, 1
k1_poll:
    global_load_dword v8, v9, s[86:87] sc1
    s_waitcnt vmcnt(0)
    v_readfirstlane_b32 s38, v8
    s_add_u32 s37, s37, 1
    s_nop 2
    s_cmp_ge_u32 s38, 8
    s_cbranch_scc1 k1_ready
    s_cmp_lt_u32 s37, 0x400000
    s_cbranch_scc0 k1_ready
    s_sleep 2
    s_branch k1_poll
k1_ready:
    s_mov_b64 exec, -1
    s_barrier
    s_mul_i32 s31, s52, 18432
    s_add_u32 s31, s31, 8388608
    s_lshl_b32 s32, s3, 10
    s_add_u32 s31, s31, s32
    s_add_u32 s34, s32, 32768
    s_add_u32 s35, s32, 24576
    s_cmp_lt_u32 s3, 4
    s_cselect_b32 s34, s34, s35
    s_sub_u32 s35, s34, s32
    s_add_u32 s35, s35, s31
    v_add_u32 v10, 24576, v3
    buffer_load_dwordx4 v[100:103], v3, s[12:15], s31 offen sc1
    buffer_load_dwordx4 v[104:107], v217, s[12:15], s31 offen sc1
    buffer_load_dwordx4 v[108:111], v219, s[12:15], s31 offen sc1
    buffer_load_dwordx4 v[112:115], v10, s[12:15], s31 offen sc1
    buffer_load_dwordx4 v[116:119], v3, s[12:15], s35 offen sc1
    v_add_u32 v11, s32, v3
    v_add_u32 v11, 16384, v11
    v_add_u32 v12, s34, v3
    v_add_u32 v12, 16384, v12
    s_waitcnt vmcnt(4)
    ds_write_b128 v11, v[100:103]
    s_waitcnt vmcnt(3)
    ds_write_b128 v11, v[104:107] offset:8192
    s_waitcnt vmcnt(2)
    ds_write_b128 v11, v[108:111] offset:16384
    s_waitcnt vmcnt(1)
    ds_write_b128 v11, v[112:115] offset:24576
    s_waitcnt vmcnt(0)
    ds_write_b128 v12, v[116:119]
    v_add_u32 v13, 16384, v3
    s_mul_i32 s31, s3, 18432
    v_add_u32 v14, s31, v13
    s_waitcnt lgkmcnt(0)
    s_barrier
    s_cmp_eq_u32 s3, 0
    s_cbranch_scc1 k1_g2a
    s_cmp_eq_u32 s3, 1
    s_cbranch_scc1 k1_g2b
    ds_read_b128 v[100:103], v13 offset:0
    ds_read_b128 v[104:107], v13 offset:18432
    ds_read_b128 v[108:111], v13 offset:1024
    ds_read_b128 v[112:115], v13 offset:19456
    ds_read_b128 v[116:119], v13 offset:2048
    ds_read_b128 v[120:123], v13 offset:20480
    ds_read_b128 v[212:215], v13 offset:3072
    ds_read_b128 v[216:219], v13 offset:21504
    s_waitcnt lgkmcnt(6)
    v_mfma_f32_16x16x32_bf16 v[232:235], v[128:131], v[100:103], 0
    v_mfma_f32_16x16x32_bf16 v[236:239], v[128:131], v[104:107], 0
    ds_read_b128 v[100:103], v13 offset:4096
    ds_read_b128 v[104:107], v13 offset:22528
    s_waitcnt lgkmcnt(6)
    v_mfma_f32_16x16x32_bf16 v[232:235], v[132:135], v[108:111], v[232:235]
    v_mfma_f32_16x16x32_bf16 v[236:239], v[132:135], v[112:115], v[236:239]
    ds_read_b128 v[108:111], v13 offset:5120
    ds_read_b128 v[112:115], v13 offset:23552
    s_waitcnt lgkmcnt(6)
    v_mfma_f32_16x16x32_bf16 v[232:235], v[136:139], v[116:119], v[232:235]
    v_mfma_f32_16x16x32_bf16 v[236:239], v[136:139], v[120:123], v[236:239]
    ds_read_b128 v[116:119], v13 offset:6144
    ds_read_b128 v[120:123], v13 offset:24576
    s_waitcnt lgkmcnt(6)
    v_mfma_f32_16x16x32_bf16 v[232:235], v[140:143], v[212:215], v[232:235]
    v_mfma_f32_16x16x32_bf16 v[236:239], v[140:143], v[216:219], v[236:239]
    ds_read_b128 v[212:215], v13 offset:7168
    ds_read_b128 v[216:219], v13 offset:25600
    s_waitcnt lgkmcnt(6)
    v_mfma_f32_16x16x32_bf16 v[232:235], v[144:147], v[100:103], v[232:235]
    v_mfma_f32_16x16x32_bf16 v[236:239], v[144:147], v[104:107], v[236:239]
    ds_read_b128 v[100:103], v13 offset:8192
    ds_read_b128 v[104:107], v13 offset:26624
    s_waitcnt lgkmcnt(6)
    v_mfma_f32_16x16x32_bf16 v[232:235], v[148:151], v[108:111], v[232:235]
    v_mfma_f32_16x16x32_bf16 v[236:239], v[148:151], v[112:115], v[236:239]
    ds_read_b128 v[108:111], v13 offset:9216
    ds_read_b128 v[112:115], v13 offset:27648
    s_waitcnt lgkmcnt(6)
    v_mfma_f32_16x16x32_bf16 v[232:235], v[152:155], v[116:119], v[232:235]
    v_mfma_f32_16x16x32_bf16 v[236:239], v[152:155], v[120:123], v[236:239]
    ds_read_b128 v[116:119], v13 offset:10240
    ds_read_b128 v[120:123], v13 offset:28672
    s_waitcnt lgkmcnt(6)
    v_mfma_f32_16x16x32_bf16 v[232:235], v[156:159], v[212:215], v[232:235]
    v_mfma_f32_16x16x32_bf16 v[236:239], v[156:159], v[216:219], v[236:239]
    ds_read_b128 v[212:215], v13 offset:11264
    ds_read_b128 v[216:219], v13 offset:29696
    s_waitcnt lgkmcnt(6)
    v_mfma_f32_16x16x32_bf16 v[232:235], v[160:163], v[100:103], v[232:235]
    v_mfma_f32_16x16x32_bf16 v[236:239], v[160:163], v[104:107], v[236:239]
    ds_read_b128 v[100:103], v13 offset:12288
    ds_read_b128 v[104:107], v13 offset:30720
    s_waitcnt lgkmcnt(6)
    v_mfma_f32_16x16x32_bf16 v[232:235], v[164:167], v[108:111], v[232:235]
    v_mfma_f32_16x16x32_bf16 v[236:239], v[164:167], v[112:115], v[236:239]
    ds_read_b128 v[108:111], v13 offset:13312
    ds_read_b128 v[112:115], v13 offset:31744
    s_waitcnt lgkmcnt(6)
    v_mfma_f32_16x16x32_bf16 v[232:235], v[168:171], v[116:119], v[232:235]
    v_mfma_f32_16x16x32_bf16 v[236:239], v[168:171], v[120:123], v[236:239]
    ds_read_b128 v[116:119], v13 offset:14336
    ds_read_b128 v[120:123], v13 offset:32768
    s_waitcnt lgkmcnt(6)
    v_mfma_f32_16x16x32_bf16 v[232:235], v[172:175], v[212:215], v[232:235]
    v_mfma_f32_16x16x32_bf16 v[236:239], v[172:175], v[216:219], v[236:239]
    ds_read_b128 v[212:215], v13 offset:15360
    ds_read_b128 v[216:219], v13 offset:33792
    s_waitcnt lgkmcnt(6)
    v_mfma_f32_16x16x32_bf16 v[232:235], v[176:179], v[100:103], v[232:235]
    v_mfma_f32_16x16x32_bf16 v[236:239], v[176:179], v[104:107], v[236:239]
    ds_read_b128 v[100:103], v13 offset:16384
    ds_read_b128 v[104:107], v13 offset:34816
    s_waitcnt lgkmcnt(6)
    v_mfma_f32_16x16x32_bf16 v[232:235], v[180:183], v[108:111], v[232:235]
    v_mfma_f32_16x16x32_bf16 v[236:239], v[180:183], v[112:115], v[236:239]
    ds_read_b128 v[108:111], v13 offset:17408
    ds_read_b128 v[112:115], v13 offset:35840
    s_waitcnt lgkmcnt(6)
    v_mfma_f32_16x16x32_bf16 v[232:235], v[184:187], v[116:119], v[232:235]
    v_mfma_f32_16x16x32_bf16 v[236:239], v[184:187], v[120:123], v[236:239]
    s_waitcnt lgkmcnt(4)
    v_mfma_f32_16x16x32_bf16 v[232:235], v[188:191], v[212:215], v[232:235]
    v_mfma_f32_16x16x32_bf16 v[236:239], v[188:191], v[216:219], v[236:239]
    s_waitcnt lgkmcnt(2)
    v_mfma_f32_16x16x32_bf16 v[232:235], v[192:195], v[100:103], v[232:235]
    v_mfma_f32_16x16x32_bf16 v[236:239], v[192:195], v[104:107], v[236:239]
    s_waitcnt lgkmcnt(0)
    v_mfma_f32_16x16x32_bf16 v[232:235], v[196:199], v[108:111], v[232:235]
    v_mfma_f32_16x16x32_bf16 v[236:239], v[196:199], v[112:115], v[236:239]
    s_branch k1_g2e
k1_g2a:
    ds_read_b128 v[100:103], v13 offset:0
    ds_read_b128 v[104:107], v13 offset:18432
    ds_read_b128 v[108:111], v13 offset:1024
    ds_read_b128 v[112:115], v13 offset:19456
    ds_read_b128 v[116:119], v13 offset:2048
    ds_read_b128 v[120:123], v13 offset:20480
    ds_read_b128 v[212:215], v13 offset:3072
    ds_read_b128 v[216:219], v13 offset:21504
    s_waitcnt lgkmcnt(6)
    v_mfma_f32_16x16x32_bf16 v[232:235], v[128:131], v[100:103], 0
    v_mfma_f32_16x16x32_bf16 v[236:239], v[128:131], v[104:107], 0
    v_mfma_f32_16x16x32_bf16 v[240:243], v[16:19], v[100:103], 0
    ds_read_b128 v[100:103], v13 offset:4096
    ds_read_b128 v[104:107], v13 offset:22528
    s_waitcnt lgkmcnt(6)
    v_mfma_f32_16x16x32_bf16 v[232:235], v[132:135], v[108:111], v[232:235]
    v_mfma_f32_16x16x32_bf16 v[236:239], v[132:135], v[112:115], v[236:239]
    v_mfma_f32_16x16x32_bf16 v[240:243], v[20:23], v[108:111], v[240:243]
    ds_read_b128 v[108:111], v13 offset:5120
    ds_read_b128 v[112:115], v13 offset:23552
    s_waitcnt lgkmcnt(6)
    v_mfma_f32_16x16x32_bf16 v[232:235], v[136:139], v[116:119], v[232:235]
    v_mfma_f32_16x16x32_bf16 v[236:239], v[136:139], v[120:123], v[236:239]
    v_mfma_f32_16x16x32_bf16 v[240:243], v[24:27], v[116:119], v[240:243]
    ds_read_b128 v[116:119], v13 offset:6144
    ds_read_b128 v[120:123], v13 offset:24576
    s_waitcnt lgkmcnt(6)
    v_mfma_f32_16x16x32_bf16 v[232:235], v[140:143], v[212:215], v[232:235]
    v_mfma_f32_16x16x32_bf16 v[236:239], v[140:143], v[216:219], v[236:239]
    v_mfma_f32_16x16x32_bf16 v[240:243], v[28:31], v[212:215], v[240:243]
    ds_read_b128 v[212:215], v13 offset:7168
    ds_read_b128 v[216:219], v13 offset:25600
    s_waitcnt lgkmcnt(6)
    v_mfma_f32_16x16x32_bf16 v[232:235], v[144:147], v[100:103], v[232:235]
    v_mfma_f32_16x16x32_bf16 v[236:239], v[144:147], v[104:107], v[236:239]
    v_mfma_f32_16x16x32_bf16 v[240:243], v[32:35], v[100:103], v[240:243]
    ds_read_b128 v[100:103], v13 offset:8192
    ds_read_b128 v[104:107], v13 offset:26624
    s_waitcnt lgkmcnt(6)
    v_mfma_f32_16x16x32_bf16 v[232:235], v[148:151], v[108:111], v[232:235]
    v_mfma_f32_16x16x32_bf16 v[236:239], v[148:151], v[112:115], v[236:239]
    v_mfma_f32_16x16x32_bf16 v[240:243], v[36:39], v[108:111], v[240:243]
    ds_read_b128 v[108:111], v13 offset:9216
    ds_read_b128 v[112:115], v13 offset:27648
    s_waitcnt lgkmcnt(6)
    v_mfma_f32_16x16x32_bf16 v[232:235], v[152:155], v[116:119], v[232:235]
    v_mfma_f32_16x16x32_bf16 v[236:239], v[152:155], v[120:123], v[236:239]
    v_mfma_f32_16x16x32_bf16 v[240:243], v[40:43], v[116:119], v[240:243]
    ds_read_b128 v[116:119], v13 offset:10240
    ds_read_b128 v[120:123], v13 offset:28672
    s_waitcnt lgkmcnt(6)
    v_mfma_f32_16x16x32_bf16 v[232:235], v[156:159], v[212:215], v[232:235]
    v_mfma_f32_16x16x32_bf16 v[236:239], v[156:159], v[216:219], v[236:239]
    v_mfma_f32_16x16x32_bf16 v[240:243], v[44:47], v[212:215], v[240:243]
    ds_read_b128 v[212:215], v13 offset:11264
    ds_read_b128 v[216:219], v13 offset:29696
    s_waitcnt lgkmcnt(6)
    v_mfma_f32_16x16x32_bf16 v[232:235], v[160:163], v[100:103], v[232:235]
    v_mfma_f32_16x16x32_bf16 v[236:239], v[160:163], v[104:107], v[236:239]
    v_mfma_f32_16x16x32_bf16 v[240:243], v[48:51], v[100:103], v[240:243]
    ds_read_b128 v[100:103], v13 offset:12288
    ds_read_b128 v[104:107], v13 offset:30720
    s_waitcnt lgkmcnt(6)
    v_mfma_f32_16x16x32_bf16 v[232:235], v[164:167], v[108:111], v[232:235]
    v_mfma_f32_16x16x32_bf16 v[236:239], v[164:167], v[112:115], v[236:239]
    v_mfma_f32_16x16x32_bf16 v[240:243], v[52:55], v[108:111], v[240:243]
    ds_read_b128 v[108:111], v13 offset:13312
    ds_read_b128 v[112:115], v13 offset:31744
    s_waitcnt lgkmcnt(6)
    v_mfma_f32_16x16x32_bf16 v[232:235], v[168:171], v[116:119], v[232:235]
    v_mfma_f32_16x16x32_bf16 v[236:239], v[168:171], v[120:123], v[236:239]
    v_mfma_f32_16x16x32_bf16 v[240:243], v[56:59], v[116:119], v[240:243]
    ds_read_b128 v[116:119], v13 offset:14336
    ds_read_b128 v[120:123], v13 offset:32768
    s_waitcnt lgkmcnt(6)
    v_mfma_f32_16x16x32_bf16 v[232:235], v[172:175], v[212:215], v[232:235]
    v_mfma_f32_16x16x32_bf16 v[236:239], v[172:175], v[216:219], v[236:239]
    v_mfma_f32_16x16x32_bf16 v[240:243], v[60:63], v[212:215], v[240:243]
    ds_read_b128 v[212:215], v13 offset:15360
    ds_read_b128 v[216:219], v13 offset:33792
    s_waitcnt lgkmcnt(6)
    v_mfma_f32_16x16x32_bf16 v[232:235], v[176:179], v[100:103], v[232:235]
    v_mfma_f32_16x16x32_bf16 v[236:239], v[176:179], v[104:107], v[236:239]
    v_mfma_f32_16x16x32_bf16 v[240:243], v[64:67], v[100:103], v[240:243]
    ds_read_b128 v[100:103], v13 offset:16384
    ds_read_b128 v[104:107], v13 offset:34816
    s_waitcnt lgkmcnt(6)
    v_mfma_f32_16x16x32_bf16 v[232:235], v[180:183], v[108:111], v[232:235]
    v_mfma_f32_16x16x32_bf16 v[236:239], v[180:183], v[112:115], v[236:239]
    v_mfma_f32_16x16x32_bf16 v[240:243], v[68:71], v[108:111], v[240:243]
    ds_read_b128 v[108:111], v13 offset:17408
    ds_read_b128 v[112:115], v13 offset:35840
    s_waitcnt lgkmcnt(6)
    v_mfma_f32_16x16x32_bf16 v[232:235], v[184:187], v[116:119], v[232:235]
    v_mfma_f32_16x16x32_bf16 v[236:239], v[184:187], v[120:123], v[236:239]
    v_mfma_f32_16x16x32_bf16 v[240:243], v[72:75], v[116:119], v[240:243]
    s_waitcnt lgkmcnt(4)
    v_mfma_f32_16x16x32_bf16 v[232:235], v[188:191], v[212:215], v[232:235]
    v_mfma_f32_16x16x32_bf16 v[236:239], v[188:191], v[216:219], v[236:239]
    v_mfma_f32_16x16x32_bf16 v[240:243], v[76:79], v[212:215], v[240:243]
    s_waitcnt lgkmcnt(2)
    v_mfma_f32_16x16x32_bf16 v[232:235], v[192:195], v[100:103], v[232:235]
    v_mfma_f32_16x16x32_bf16 v[236:239], v[192:195], v[104:107], v[236:239]
    v_mfma_f32_16x16x32_bf16 v[240:243], v[80:83], v[100:103], v[240:243]
    s_waitcnt lgkmcnt(0)
    v_mfma_f32_16x16x32_bf16 v[232:235], v[196:199], v[108:111], v[232:235]
    v_mfma_f32_16x16x32_bf16 v[236:239], v[196:199], v[112:115], v[236:239]
    v_mfma_f32_16x16x32_bf16 v[240:243], v[84:87], v[108:111], v[240:243]
    s_branch k1_g2e
k1_g2b:
    ds_read_b128 v[100:103], v13 offset:0
    ds_read_b128 v[104:107], v13 offset:18432
    ds_read_b128 v[108:111], v13 offset:1024
    ds_read_b128 v[112:115], v13 offset:19456
    ds_read_b128 v[116:119], v13 offset:2048
    ds_read_b128 v[120:123], v13 offset:20480
    ds_read_b128 v[212:215], v13 offset:3072
    ds_read_b128 v[216:219], v13 offset:21504
    s_waitcnt lgkmcnt(6)
    v_mfma_f32_16x16x32_bf16 v[232:235], v[128:131], v[100:103], 0
    v_mfma_f32_16x16x32_bf16 v[236:239], v[128:131], v[104:107], 0
    v_mfma_f32_16x16x32_bf16 v[240:243], v[16:19], v[104:107], 0
    ds_read_b128 v[100:103], v13 offset:4096
    ds_read_b128 v[104:107], v13 offset:22528
    s_waitcnt lgkmcnt(6)
    v_mfma_f32_16x16x32_bf16 v[232:235], v[132:135], v[108:111], v[232:235]
    v_mfma_f32_16x16x32_bf16 v[236:239], v[132:135], v[112:115], v[236:239]
    v_mfma_f32_16x16x32_bf16 v[240:243], v[20:23], v[112:115], v[240:243]
    ds_read_b128 v[108:111], v13 offset:5120
    ds_read_b128 v[112:115], v13 offset:23552
    s_waitcnt lgkmcnt(6)
    v_mfma_f32_16x16x32_bf16 v[232:235], v[136:139], v[116:119], v[232:235]
    v_mfma_f32_16x16x32_bf16 v[236:239], v[136:139], v[120:123], v[236:239]
    v_mfma_f32_16x16x32_bf16 v[240:243], v[24:27], v[120:123], v[240:243]
    ds_read_b128 v[116:119], v13 offset:6144
    ds_read_b128 v[120:123], v13 offset:24576
    s_waitcnt lgkmcnt(6)
    v_mfma_f32_16x16x32_bf16 v[232:235], v[140:143], v[212:215], v[232:235]
    v_mfma_f32_16x16x32_bf16 v[236:239], v[140:143], v[216:219], v[236:239]
    v_mfma_f32_16x16x32_bf16 v[240:243], v[28:31], v[216:219], v[240:243]
    ds_read_b128 v[212:215], v13 offset:7168
    ds_read_b128 v[216:219], v13 offset:25600
    s_waitcnt lgkmcnt(6)
    v_mfma_f32_16x16x32_bf16 v[232:235], v[144:147], v[100:103], v[232:235]
    v_mfma_f32_16x16x32_bf16 v[236:239], v[144:147], v[104:107], v[236:239]
    v_mfma_f32_16x16x32_bf16 v[240:243], v[32:35], v[104:107], v[240:243]
    ds_read_b128 v[100:103], v13 offset:8192
    ds_read_b128 v[104:107], v13 offset:26624
    s_waitcnt lgkmcnt(6)
    v_mfma_f32_16x16x32_bf16 v[232:235], v[148:151], v[108:111], v[232:235]
    v_mfma_f32_16x16x32_bf16 v[236:239], v[148:151], v[112:115], v[236:239]
    v_mfma_f32_16x16x32_bf16 v[240:243], v[36:39], v[112:115], v[240:243]
    ds_read_b128 v[108:111], v13 offset:9216
    ds_read_b128 v[112:115], v13 offset:27648
    s_waitcnt lgkmcnt(6)
    v_mfma_f32_16x16x32_bf16 v[232:235], v[152:155], v[116:119], v[232:235]
    v_mfma_f32_16x16x32_bf16 v[236:239], v[152:155], v[120:123], v[236:239]
    v_mfma_f32_16x16x32_bf16 v[240:243], v[40:43], v[120:123], v[240:243]
    ds_read_b128 v[116:119], v13 offset:10240
    ds_read_b128 v[120:123], v13 offset:28672
    s_waitcnt lgkmcnt(6)
    v_mfma_f32_16x16x32_bf16 v[232:235], v[156:159], v[212:215], v[232:235]
    v_mfma_f32_16x16x32_bf16 v[236:239], v[156:159], v[216:219], v[236:239]
    v_mfma_f32_16x16x32_bf16 v[240:243], v[44:47], v[216:219], v[240:243]
    ds_read_b128 v[212:215], v13 offset:11264
    ds_read_b128 v[216:219], v13 offset:29696
    s_waitcnt lgkmcnt(6)
    v_mfma_f32_16x16x32_bf16 v[232:235], v[160:163], v[100:103], v[232:235]
    v_mfma_f32_16x16x32_bf16 v[236:239], v[160:163], v[104:107], v[236:239]
    v_mfma_f32_16x16x32_bf16 v[240:243], v[48:51], v[104:107], v[240:243]
    ds_read_b128 v[100:103], v13 offset:12288
    ds_read_b128 v[104:107], v13 offset:30720
    s_waitcnt lgkmcnt(6)
    v_mfma_f32_16x16x32_bf16 v[232:235], v[164:167], v[108:111], v[232:235]
    v_mfma_f32_16x16x32_bf16 v[236:239], v[164:167], v[112:115], v[236:239]
    v_mfma_f32_16x16x32_bf16 v[240:243], v[52:55], v[112:115], v[240:243]
    ds_read_b128 v[108:111], v13 offset:13312
    ds_read_b128 v[112:115], v13 offset:31744
    s_waitcnt lgkmcnt(6)
    v_mfma_f32_16x16x32_bf16 v[232:235], v[168:171], v[116:119], v[232:235]
    v_mfma_f32_16x16x32_bf16 v[236:239], v[168:171], v[120:123], v[236:239]
    v_mfma_f32_16x16x32_bf16 v[240:243], v[56:59], v[120:123], v[240:243]
    ds_read_b128 v[116:119], v13 offset:14336
    ds_read_b128 v[120:123], v13 offset:32768
    s_waitcnt lgkmcnt(6)
    v_mfma_f32_16x16x32_bf16 v[232:235], v[172:175], v[212:215], v[232:235]
    v_mfma_f32_16x16x32_bf16 v[236:239], v[172:175], v[216:219], v[236:239]
    v_mfma_f32_16x16x32_bf16 v[240:243], v[60:63], v[216:219], v[240:243]
    ds_read_b128 v[212:215], v13 offset:15360
    ds_read_b128 v[216:219], v13 offset:33792
    s_waitcnt lgkmcnt(6)
    v_mfma_f32_16x16x32_bf16 v[232:235], v[176:179], v[100:103], v[232:235]
    v_mfma_f32_16x16x32_bf16 v[236:239], v[176:179], v[104:107], v[236:239]
    v_mfma_f32_16x16x32_bf16 v[240:243], v[64:67], v[104:107], v[240:243]
    ds_read_b128 v[100:103], v13 offset:16384
    ds_read_b128 v[104:107], v13 offset:34816
    s_waitcnt lgkmcnt(6)
    v_mfma_f32_16x16x32_bf16 v[232:235], v[180:183], v[108:111], v[232:235]
    v_mfma_f32_16x16x32_bf16 v[236:239], v[180:183], v[112:115], v[236:239]
    v_mfma_f32_16x16x32_bf16 v[240:243], v[68:71], v[112:115], v[240:243]
    ds_read_b128 v[108:111], v13 offset:17408
    ds_read_b128 v[112:115], v13 offset:35840
    s_waitcnt lgkmcnt(6)
    v_mfma_f32_16x16x32_bf16 v[232:235], v[184:187], v[116:119], v[232:235]
    v_mfma_f32_16x16x32_bf16 v[236:239], v[184:187], v[120:123], v[236:239]
    v_mfma_f32_16x16x32_bf16 v[240:243], v[72:75], v[120:123], v[240:243]
    s_waitcnt lgkmcnt(4)
    v_mfma_f32_16x16x32_bf16 v[232:235], v[188:191], v[212:215], v[232:235]
    v_mfma_f32_16x16x32_bf16 v[236:239], v[188:191], v[216:219], v[236:239]
    v_mfma_f32_16x16x32_bf16 v[240:243], v[76:79], v[216:219], v[240:243]
    s_waitcnt lgkmcnt(2)
    v_mfma_f32_16x16x32_bf16 v[232:235], v[192:195], v[100:103], v[232:235]
    v_mfma_f32_16x16x32_bf16 v[236:239], v[192:195], v[104:107], v[236:239]
    v_mfma_f32_16x16x32_bf16 v[240:243], v[80:83], v[104:107], v[240:243]
    s_waitcnt lgkmcnt(0)
    v_mfma_f32_16x16x32_bf16 v[232:235], v[196:199], v[108:111], v[232:235]
    v_mfma_f32_16x16x32_bf16 v[236:239], v[196:199], v[112:115], v[236:239]
    v_mfma_f32_16x16x32_bf16 v[240:243], v[84:87], v[112:115], v[240:243]
k1_g2e:
    s_nop 7
    s_lshr_b32 s33, s3, 1
    s_lshl_b32 s33, s33, 10
    s_and_b32 s32, s3, 1
    s_lshl_b32 s32, s32, 3
    s_add_u32 s33, s33, s32
    s_add_u32 s33, s33, 53248
    v_add_u32 v6, s33, v3
    s_mul_i32 s36, s52, 18432
    s_lshl_b32 s37, s54, 9
    s_add_u32 s36, s36, s37
    s_add_u32 s36, s36, 11534336
    s_add_u32 s37, s36, 18432
    v_lshlrev_b32 v7, 3, v1
    v_cvt_pk_bf16_f32 v110, v232, v233
    v_cvt_pk_bf16_f32 v111, v234, v235
    v_lshlrev_b32 v112, 16, v110
    v_and_b32 v113, 0xffff0000, v110
    v_lshlrev_b32 v114, 16, v111
    v_and_b32 v115, 0xffff0000, v111
    v_mul_f32 v112, v112, v204
    v_mul_f32 v113, v113, v205
    v_mul_f32 v114, v114, v206
    v_mul_f32 v115, v115, v207
    v_cvt_pk_bf16_f32 v110, v112, v113
    v_cvt_pk_bf16_f32 v111, v114, v115
    v_lshlrev_b32 v112, 16, v110
    v_and_b32 v113, 0xffff0000, v110
    v_lshlrev_b32 v114, 16, v111
    v_and_b32 v115, 0xffff0000, v111
    v_lshlrev_b32 v116, 16, v200
    v_and_b32 v117, 0xffff0000, v200
    v_lshlrev_b32 v118, 16, v201
    v_and_b32 v119, 0xffff0000, v201
    v_add_f32 v112, v112, v116
    v_add_f32 v113, v113, v117
    v_add_f32 v114, v114, v118
    v_add_f32 v115, v115, v119
    v_cvt_pk_bf16_f32 v244, v112, v113
    v_cvt_pk_bf16_f32 v245, v114, v115
    v_lshlrev_b32 v112, 16, v244
    v_and_b32 v113, 0xffff0000, v244
    v_lshlrev_b32 v114, 16, v245
    v_and_b32 v115, 0xffff0000, v245
    v_add_f32 v120, v112, v113
    v_mul_f32 v121, v112, v112
    v_fmac_f32 v121, v113, v113
    v_add_f32 v120, v120, v114
    v_fmac_f32 v121, v114, v114
    v_add_f32 v120, v120, v115
    v_fmac_f32 v121, v115, v115
    v_mul_f32 v112, v112, v208
    v_mul_f32 v113, v113, v209
    v_mul_f32 v114, v114, v210
    v_mul_f32 v115, v115, v211
    v_cvt_pk_bf16_f32 v248, v112, v113
    v_cvt_pk_bf16_f32 v249, v114, v115
    ds_write_b64 v6, v[248:249] offset:0
    buffer_store_dwordx2 v[244:245], v7, s[12:15], s36 offen sc1
    v_cvt_pk_bf16_f32 v110, v236, v237
    v_cvt_pk_bf16_f32 v111, v238, v239
    v_lshlrev_b32 v112, 16, v110
    v_and_b32 v113, 0xffff0000, v110
    v_lshlrev_b32 v114, 16, v111
    v_and_b32 v115, 0xffff0000, v111
    v_mul_f32 v112, v112, v204
    v_mul_f32 v113, v113, v205
    v_mul_f32 v114, v114, v206
    v_mul_f32 v115, v115, v207
    v_cvt_pk_bf16_f32 v110, v112, v113
    v_cvt_pk_bf16_f32 v111, v114, v115
    v_lshlrev_b32 v112, 16, v110
    v_and_b32 v113, 0xffff0000, v110
    v_lshlrev_b32 v114, 16, v111
    v_and_b32 v115, 0xffff0000, v111
    v_lshlrev_b32 v116, 16, v202
    v_and_b32 v117, 0xffff0000, v202
    v_lshlrev_b32 v118, 16, v203
    v_and_b32 v119, 0xffff0000, v203
    v_add_f32 v112, v112, v116
    v_add_f32 v113, v113, v117
    v_add_f32 v114, v114, v118
    v_add_f32 v115, v115, v119
    v_cvt_pk_bf16_f32 v246, v112, v113
    v_cvt_pk_bf16_f32 v247, v114, v115
    v_lshlrev_b32 v112, 16, v246
    v_and_b32 v113, 0xffff0000, v246
    v_lshlrev_b32 v114, 16, v247
    v_and_b32 v115, 0xffff0000, v247
    v_add_f32 v122, v112, v113
    v_mul_f32 v123, v112, v112
    v_fmac_f32 v123, v113, v113
    v_add_f32 v122, v122, v114
    v_fmac_f32 v123, v114, v114
    v_add_f32 v122, v122, v115
    v_fmac_f32 v123, v115, v115
    v_mul_f32 v112, v112, v208
    v_mul_f32 v113, v113, v209
    v_mul_f32 v114, v114, v210
    v_mul_f32 v115, v115, v211
    v_cvt_pk_bf16_f32 v250, v112, v113
    v_cvt_pk_bf16_f32 v251, v114, v115
    ds_write_b64 v6, v[250:251] offset:5120
    buffer_store_dwordx2 v[246:247], v7, s[12:15], s37 offen sc1
    s_cmp_lg_u32 s3, 0
    s_cbranch_scc1 k1_noex3_0
    v_cvt_pk_bf16_f32 v110, v240, v241
    v_cvt_pk_bf16_f32 v111, v242, v243
    v_lshlrev_b32 v112, 16, v110
    v_and_b32 v113, 0xffff0000, v110
    v_lshlrev_b32 v114, 16, v111
    v_and_b32 v115, 0xffff0000, v111
    v_mul_f32 v112, v112, v92
    v_mul_f32 v113, v113, v93
    v_mul_f32 v114, v114, v94
    v_mul_f32 v115, v115, v95
    v_cvt_pk_bf16_f32 v110, v112, v113
    v_cvt_pk_bf16_f32 v111, v114, v115
    v_lshlrev_b32 v112, 16, v110
    v_and_b32 v113, 0xffff0000, v110
    v_lshlrev_b32 v114, 16, v111
    v_and_b32 v115, 0xffff0000, v111
    v_lshlrev_b32 v116, 16, v88
    v_and_b32 v117, 0xffff0000, v88
    v_lshlrev_b32 v118, 16, v89
    v_and_b32 v119, 0xffff0000, v89
    v_add_f32 v112, v112, v116
    v_add_f32 v113, v113, v117
    v_add_f32 v114, v114, v118
    v_add_f32 v115, v115, v119
    v_cvt_pk_bf16_f32 v252, v112, v113
    v_cvt_pk_bf16_f32 v253, v114, v115
    v_lshlrev_b32 v112, 16, v252
    v_and_b32 v113, 0xffff0000, v252
    v_lshlrev_b32 v114, 16, v253
    v_and_b32 v115, 0xffff0000, v253
    v_add_f32 v120, v120, v112
    v_fmac_f32 v121, v112, v112
    v_add_f32 v120, v120, v113
    v_fmac_f32 v121, v113, v113
    v_add_f32 v120, v120, v114
    v_fmac_f32 v121, v114, v114
    v_add_f32 v120, v120, v115
    v_fmac_f32 v121, v115, v115
    v_mul_f32 v112, v112, v96
    v_mul_f32 v113, v113, v97
    v_mul_f32 v114, v114, v98
    v_mul_f32 v115, v115, v99
    v_cvt_pk_bf16_f32 v254, v112, v113
    v_cvt_pk_bf16_f32 v255, v114, v115
    v_add_u32 v8, 57344, v3
    ds_write_b64 v8, v[254:255]
    s_add_u32 s38, s52, 0
    s_mul_i32 s38, s38, 18432
    s_add_u32 s39, s53, 8
    s_lshl_b32 s39, s39, 9
    s_add_u32 s38, s38, s39
    s_add_u32 s38, s38, 11534336
    buffer_store_dwordx2 v[252:253], v7, s[12:15], s38 offen sc1
k1_noex3_0:
    s_cmp_lg_u32 s3, 1
    s_cbranch_scc1 k1_noex3_1
    v_cvt_pk_bf16_f32 v110, v240, v241
    v_cvt_pk_bf16_f32 v111, v242, v243
    v_lshlrev_b32 v112, 16, v110
    v_and_b32 v113, 0xffff0000, v110
    v_lshlrev_b32 v114, 16, v111
    v_and_b32 v115, 0xffff0000, v111
    v_mul_f32 v112, v112, v92
    v_mul_f32 v113, v113, v93
    v_mul_f32 v114, v114, v94
    v_mul_f32 v115, v115, v95
    v_cvt_pk_bf16_f32 v110, v112, v113
    v_cvt_pk_bf16_f32 v111, v114, v115
    v_lshlrev_b32 v112, 16, v110
    v_and_b32 v113, 0xffff0000, v110
    v_lshlrev_b32 v114, 16, v111
    v_and_b32 v115, 0xffff0000, v111
    v_lshlrev_b32 v116, 16, v88
    v_and_b32 v117, 0xffff0000, v88
    v_lshlrev_b32 v118, 16, v89
    v_and_b32 v119, 0xffff0000, v89
    v_add_f32 v112, v112, v116
    v_add_f32 v113, v113, v117
    v_add_f32 v114, v114, v118
    v_add_f32 v115, v115, v119
    v_cvt_pk_bf16_f32 v252, v112, v113
    v_cvt_pk_bf16_f32 v253, v114, v115
    v_lshlrev_b32 v112, 16, v252
    v_and_b32 v113, 0xffff0000, v252
    v_lshlrev_b32 v114, 16, v253
    v_and_b32 v115, 0xffff0000, v253
    v_add_f32 v122, v122, v112
    v_fmac_f32 v123, v112, v112
    v_add_f32 v122, v122, v113
    v_fmac_f32 v123, v113, v113
    v_add_f32 v122, v122, v114
    v_fmac_f32 v123, v114, v114
    v_add_f32 v122, v122, v115
    v_fmac_f32 v123, v115, v115
    v_mul_f32 v112, v112, v96
    v_mul_f32 v113, v113, v97
    v_mul_f32 v114, v114, v98
    v_mul_f32 v115, v115, v99
    v_cvt_pk_bf16_f32 v254, v112, v113
    v_cvt_pk_bf16_f32 v255, v114, v115
    v_add_u32 v8, 62464, v3
    ds_write_b64 v8, v[254:255]
    s_add_u32 s38, s52, 1
    s_mul_i32 s38, s38, 18432
    s_add_u32 s39, s53, 8
    s_lshl_b32 s39, s39, 9
    s_add_u32 s38, s38, s39
    s_add_u32 s38, s38, 11534336
    buffer_store_dwordx2 v[252:253], v7, s[12:15], s38 offen sc1
k1_noex3_1:
    v_mov_b32 v124, v120
    v_mov_b32 v125, v121
    v_mov_b32 v126, v122
    v_mov_b32 v127, v123
    v_permlane16_swap_b32 v120, v124
    v_permlane16_swap_b32 v121, v125
    v_permlane16_swap_b32 v122, v126
    v_permlane16_swap_b32 v123, v127
    v_add_f32 v120, v120, v124
    v_add_f32 v121, v121, v125
    v_add_f32 v122, v122, v126
    v_add_f32 v123, v123, v127
    v_mov_b32 v124, v120
    v_mov_b32 v125, v121
    v_mov_b32 v126, v122
    v_mov_b32 v127, v123
    v_permlane32_swap_b32 v120, v124
    v_permlane32_swap_b32 v121, v125
    v_permlane32_swap_b32 v122, v126
    v_permlane32_swap_b32 v123, v127
    v_add_f32 v120, v120, v124
    v_add_f32 v121, v121, v125
    v_add_f32 v122, v122, v126
    v_add_f32 v123, v123, v127
    v_cmp_gt_u32 vcc, 16, v1
    s_nop 1
    v_cndmask_b32 v120, v122, v120, vcc
    v_cndmask_b32 v121, v123, v121, vcc
    s_lshl_b32 s31, s3, 8
    s_add_u32 s31, s31, 63488
    v_lshlrev_b32 v5, 3, v1
    v_add_u32 v5, s31, v5
    s_mov_b32 exec_hi, 0
    ds_write_b64 v5, v[120:121]
    s_mov_b64 exec, -1
    s_waitcnt lgkmcnt(0)
    s_barrier
    s_lshr_b32 s32, s3, 2
    s_and_b32 s31, s3, 3
    s_mul_i32 s33, s32, 5120
    s_lshl_b32 s34, s31, 10
    s_add_u32 s33, s33, s34
    s_add_u32 s33, s33, 53248
    v_add_u32 v6, s33, v3
    ds_read_b128 v[24:27], v6
    s_lshr_b32 s35, s51, 1
    s_mul_i32 s35, s35, 9
    s_and_b32 s36, s51, 1
    s_lshl_b32 s37, s36, 2
    s_add_u32 s37, s37, s35
    s_add_u32 s37, s37, s31
    s_add_u32 s38, s52, s32
    s_mul_i32 s38, s38, 18
    s_add_u32 s37, s37, s38
    s_lshl_b32 s37, s37, 10
    s_add_u32 s37, s37, 14680064
    s_waitcnt lgkmcnt(0)
    buffer_store_dwordx4 v[24:27], v3, s[12:15], s37 offen sc1
    s_cmp_eq_u32 s3, 1
    s_cbranch_scc1 k1_stats
    s_cmp_lg_u32 s31, 0
    s_cbranch_scc1 k1_done
    ds_read_b64 v[28:29], v6 offset:4096
    s_add_u32 s37, s35, 8
    s_add_u32 s37, s37, s38
    s_lshl_b32 s37, s37, 10
    s_lshl_b32 s36, s36, 3
    s_add_u32 s37, s37, s36
    s_add_u32 s37, s37, 14680064
    s_waitcnt lgkmcnt(0)
    buffer_store_dwordx2 v[28:29], v3, s[12:15], s37 offen sc1
    s_branch k1_done
k1_stats:
    v_lshlrev_b32 v5, 2, v1
    ds_read_b32 v32, v5 offset:63488
    ds_read_b32 v33, v5 offset:63744
    ds_read_b32 v34, v5 offset:64000
    ds_read_b32 v35, v5 offset:64256
    ds_read_b32 v36, v5 offset:64512
    ds_read_b32 v37, v5 offset:64768
    ds_read_b32 v38, v5 offset:65024
    ds_read_b32 v39, v5 offset:65280
    s_waitcnt lgkmcnt(0)
    v_add_f32 v32, v32, v33
    v_add_f32 v34, v34, v35
    v_add_f32 v36, v36, v37
    v_add_f32 v38, v38, v39
    v_add_f32 v32, v32, v34
    v_add_f32 v36, v36, v38
    v_add_f32 v32, v32, v36
    s_lshl_b32 s31, s51, 14
    s_lshl_b32 s32, s52, 7
    s_add_u32 s31, s31, s32
    s_add_u32 s31, s31, 262144
    buffer_store_dword v32, v5, s[12:15], s31 offen sc1
k1_done:
    s_waitcnt vmcnt(0) lgkmcnt(0)
    s_barrier
    s_lshr_b32 s33, s5, 2
    s_lshl_b32 s33, s33, 8
    s_add_u32 s33, s33, 139264
    v_mov_b32 v9, s33
    s_cmp_lg_u32 s3, 7
    s_cbranch_scc1 k1_nosig2
    v_mov_b32 v8, 1
    s_mov_b64 exec, 1
    global_atomic_add v9, v8, s[86:87]
    s_mov_b64 exec, -1
k1_nosig2:
    s_load_dwordx2 s[56:57], s[0:1], 48
    s_and_b32 s20, s2, 7
    s_lshl_b32 s20, s20, 2
    s_bfe_u32 s21, s2, 0x20003
    s_add_u32 s20, s20, s21
    s_lshr_b32 s21, s2, 5
    s_waitcnt lgkmcnt(0)
    s_cmp_ge_u32 s3, 4
    s_cselect_b32 s8, s18, s16
    s_cselect_b32 s9, s19, s17
    s_cselect_b32 s22, 9216, 0
    s_and_b32 s9, s9, 0xffff
    s_mov_b32 s10, 5308416
    s_mov_b32 s11, 0x00020000
    s_and_b32 s23, s3, 3
    s_mul_i32 s24, s23, 2304
    s_add_u32 s22, s22, s24
    s_lshl_b32 s24, s21, 4
    s_lshl_b32 s25, s3, 1
    s_add_u32 s24, s24, s25
    s_mul_i32 s25, s24, 18432
    s_add_u32 s25, s25, 14680064
    s_add_u32 s26, s25, 18432
    s_mov_b32 s50, -1
    s_mov_b32 s51, 0xffff
    s_mov_b32 s52, 0x3ffff
    s_mov_b32 s53, 0
    s_and_b32 s27, s23, 1
    s_mul_i32 s27, s27, 73728
    s_mul_i32 s28, s20, 288
    s_add_u32 s27, s27, s28
    s_lshr_b32 s28, s23, 1
    s_mul_i32 s54, s28, 147456
    s_mul_i32 s55, s28, 1327104
    v_add_u32 v7, 0, v1
    v_mul_u32_u24 v8, 0xe39, v7
    v_lshrrev_b32 v8, 16, v8
    v_mul_u32_u24 v9, 18, v8
    v_sub_u32 v9, v7, v9
    v_mul_u32_u24 v8, 9216, v8
    v_lshl_add_u32 v8, v9, 4, v8
    v_add_u32 v10, s27, v8
    v_add_u32 v7, 48, v1
    v_mul_u32_u24 v8, 0xe39, v7
    v_lshrrev_b32 v8, 16, v8
    v_mul_u32_u24 v9, 18, v8
    v_sub_u32 v9, v7, v9
    v_mul_u32_u24 v8, 9216, v8
    v_lshl_add_u32 v8, v9, 4, v8
    v_add_u32 v11, s27, v8
    v_add_u32 v7, 96, v1
    v_mul_u32_u24 v8, 0xe39, v7
    v_lshrrev_b32 v8, 16, v8
    v_mul_u32_u24 v9, 18, v8
    v_sub_u32 v9, v7, v9
    v_mul_u32_u24 v8, 9216, v8
    v_lshl_add_u32 v8, v9, 4, v8
    v_add_u32 v12, s27, v8
    s_add_u32 s30, s22, 0
    s_add_u32 s29, s54, 0
    s_add_u32 m0, s30, 0
    s_mov_b64 exec, s[50:51]
    buffer_load_dwordx4 v10, s[8:11], s29 offen lds
    s_mov_b64 exec, -1
    s_add_u32 m0, s30, 768
    s_mov_b64 exec, s[50:51]
    buffer_load_dwordx4 v11, s[8:11], s29 offen lds
    s_mov_b64 exec, -1
    s_add_u32 m0, s30, 1536
    s_mov_b64 exec, s[50:51]
    buffer_load_dwordx4 v12, s[8:11], s29 offen lds
    s_mov_b64 exec, -1
    v_bfe_u32 v7, v1, 2, 2
    v_lshl_add_u32 v7, v4, 2, v7
    v_mul_u32_u24 v7, 288, v7
    v_and_b32 v8, 3, v1
    v_lshl_add_u32 v13, v8, 3, v7
    v_add_u32 v14, 55296, v13
    v_add_u32 v15, 110592, v13
    v_and_b32 v7, 15, v1
    v_lshlrev_b32 v8, 5, v4
    v_lshl_add_u32 v8, v7, 4, v8
    v_add_u32 v8, 149760, v8
    v_mov_b32 v9, 152064
    v_cmp_gt_u32 vcc, 2, v7
    s_nop 1
    v_cndmask_b32 v16, v9, v8, vcc
    v_mov_b32 v19, 128
    v_cndmask_b32 v19, 0, v19, vcc
    v_mov_b32 v20, 0
    v_mov_b32 v21, 0
    v_mov_b32 v22, 0
    v_mov_b32 v23, 0
    ds_write_b128 v9, v[20:23]
    s_mul_i32 s27, s3, 288
    s_add_u32 s28, s27, 149760
    s_add_u32 s27, s27, 65536
    s_mov_b32 m0, s28
    s_mov_b64 exec, s[52:53]
    buffer_load_dwordx4 v3, s[12:15], s27 offen lds
    s_mov_b64 exec, -1
    s_add_u32 s30, s22, 18432
    s_add_u32 s29, s54, 294912
    s_add_u32 m0, s30, 0
    s_mov_b64 exec, s[50:51]
    buffer_load_dwordx4 v10, s[8:11], s29 offen lds
    s_mov_b64 exec, -1
    s_add_u32 m0, s30, 768
    s_mov_b64 exec, s[50:51]
    buffer_load_dwordx4 v11, s[8:11], s29 offen lds
    s_mov_b64 exec, -1
    s_add_u32 m0, s30, 1536
    s_mov_b64 exec, s[50:51]
    buffer_load_dwordx4 v12, s[8:11], s29 offen lds
    s_mov_b64 exec, -1
    s_add_u32 s30, s22, 36864
    s_add_u32 s29, s54, 589824
    s_add_u32 m0, s30, 0
    s_mov_b64 exec, s[50:51]
    buffer_load_dwordx4 v10, s[8:11], s29 offen lds
    s_mov_b64 exec, -1
    s_add_u32 m0, s30, 768
    s_mov_b64 exec, s[50:51]
    buffer_load_dwordx4 v11, s[8:11], s29 offen lds
    s_mov_b64 exec, -1
    s_add_u32 m0, s30, 1536
    s_mov_b64 exec, s[50:51]
    buffer_load_dwordx4 v12, s[8:11], s29 offen lds
    s_mov_b64 exec, -1
    s_lshl_b32 s33, s21, 8
    s_add_u32 s33, s33, 139264
    v_mov_b32 v17, s33
    s_mov_b32 s37, 0
    s_cmp_lg_u32 s3, 7
    s_cbranch_scc1 k3_ready
    s_mov_b64 exec, 1
k3_poll:
    global_load_dword v18, v17, s[86:87] sc1
    s_waitcnt vmcnt(0)
    v_readfirstlane_b32 s38, v18
    s_add_u32 s37, s37, 1
    s_nop 2
    s_cmp_ge_u32 s38, 32
    s_cbranch_scc1 k3_ready
    s_cmp_lt_u32 s37, 0x400000
    s_cbranch_scc0 k3_ready
    s_sleep 2
    s_branch k3_poll
k3_ready:
    s_mov_b64 exec, -1
    s_barrier
    buffer_load_dwordx4 v[72:75], v3, s[12:15], s25 offen offset:0 sc1
    buffer_load_dwordx4 v[76:79], v3, s[12:15], s26 offen offset:0 sc1
    buffer_load_dwordx4 v[80:83], v3, s[12:15], s25 offen offset:1024 sc1
    buffer_load_dwordx4 v[84:87], v3, s[12:15], s26 offen offset:1024 sc1
    buffer_load_dwordx4 v[88:91], v3, s[12:15], s25 offen offset:2048 sc1
    buffer_load_dwordx4 v[92:95], v3, s[12:15], s26 offen offset:2048 sc1
    buffer_load_dwordx4 v[96:99], v3, s[12:15], s25 offen offset:3072 sc1
    buffer_load_dwordx4 v[100:103], v3, s[12:15], s26 offen offset:3072 sc1
    v_and_b32 v17, 31, v1
    s_lshl_b32 s27, s24, 4
    v_add_u32 v17, s27, v17
    v_lshlrev_b32 v17, 3, v17
    v_lshrrev_b32 v18, 5, v1
    v_mul_u32_u24 v18, 32768, v18
    v_add_u32 v17, v17, v18
    s_mov_b32 s27, 262144
    s_mov_b32 s28, 278528
    buffer_load_dwordx2 v[6:7], v17, s[12:15], s27 offen sc1
    buffer_load_dwordx2 v[8:9], v17, s[12:15], s28 offen sc1
    s_and_b32 s60, s23, 1
    s_mul_i32 s60, s60, 9216
    s_lshr_b32 s61, s23, 1
    s_lshl_b32 s61, s61, 5
    s_add_u32 s60, s60, s61
    s_add_u32 s61, s60, 64
    s_add_u32 s62, s60, 128
    s_add_u32 s63, s60, 192
    s_add_u32 s64, s60, 256
    s_cmp_lt_u32 s23, 2
    s_cselect_b32 s64, s64, s63
    s_cmp_ge_u32 s3, 4
    s_cbranch_scc1 k3_grp1
    s_waitcnt vmcnt(8) lgkmcnt(0)
    s_barrier
    ds_read_b128 v[20:23], v16
    ds_read_b64_tr_b16 v[48:49], v13 offset:0
    ds_read_b64_tr_b16 v[50:51], v13 offset:4608
    ds_read_b64_tr_b16 v[52:53], v13 offset:9216
    ds_read_b64_tr_b16 v[54:55], v13 offset:13824
    v_add_u32 v17, s60, v13
    ds_read_b64_tr_b16 v[56:57], v17 offset:0
    ds_read_b64_tr_b16 v[58:59], v17 offset:4608
    ds_read_b64_tr_b16 v[60:61], v13 offset:32
    ds_read_b64_tr_b16 v[62:63], v13 offset:4640
    ds_read_b64_tr_b16 v[64:65], v13 offset:9248
    ds_read_b64_tr_b16 v[66:67], v13 offset:13856
    s_waitcnt lgkmcnt(8)
    v_mfma_f32_16x16x32_bf16 v[112:115], v[48:51], v[72:75], 0
    v_mfma_f32_16x16x32_bf16 v[184:187], v[48:51], v[76:79], 0
    ds_read_b64_tr_b16 v[68:69], v13 offset:64
    ds_read_b64_tr_b16 v[70:71], v13 offset:4672
    s_waitcnt lgkmcnt(8)
    v_mfma_f32_16x16x32_bf16 v[148:151], v[52:55], v[72:75], 0
    v_mfma_f32_16x16x32_bf16 v[220:223], v[52:55], v[76:79], 0
    v_add_u32 v16, v16, v19
    ds_read_b128 v[24:27], v16
    ds_read_b64_tr_b16 v[48:49], v13 offset:9280
    ds_read_b64_tr_b16 v[50:51], v13 offset:13888
    s_waitcnt lgkmcnt(8)
    v_mfma_f32_16x16x32_bf16 v[28:31], v[56:59], v[20:23], 0
    v_add_u32 v18, s61, v13
    ds_read_b64_tr_b16 v[52:53], v18 offset:0
    ds_read_b64_tr_b16 v[54:55], v18 offset:4608
    s_waitcnt lgkmcnt(8)
    v_mfma_f32_16x16x32_bf16 v[116:119], v[60:63], v[72:75], 0
    v_mfma_f32_16x16x32_bf16 v[188:191], v[60:63], v[76:79], 0
    ds_read_b64_tr_b16 v[56:57], v13 offset:96
    ds_read_b64_tr_b16 v[58:59], v13 offset:4704
    s_waitcnt lgkmcnt(8)
    v_mfma_f32_16x16x32_bf16 v[152:155], v[64:67], v[72:75], 0
    v_mfma_f32_16x16x32_bf16 v[224:227], v[64:67], v[76:79], 0
    ds_read_b64_tr_b16 v[60:61], v13 offset:9312
    ds_read_b64_tr_b16 v[62:63], v13 offset:13920
    s_waitcnt lgkmcnt(8)
    v_mfma_f32_16x16x32_bf16 v[120:123], v[68:71], v[72:75], 0
    v_mfma_f32_16x16x32_bf16 v[192:195], v[68:71], v[76:79], 0
    ds_read_b64_tr_b16 v[64:65], v13 offset:128
    ds_read_b64_tr_b16 v[66:67], v13 offset:4736
    s_waitcnt lgkmcnt(8)
    v_mfma_f32_16x16x32_bf16 v[156:159], v[48:51], v[72:75], 0
    v_mfma_f32_16x16x32_bf16 v[228:231], v[48:51], v[76:79], 0
    ds_read_b64_tr_b16 v[68:69], v13 offset:9344
    ds_read_b64_tr_b16 v[70:71], v13 offset:13952
    s_waitcnt lgkmcnt(8)
    v_mfma_f32_16x16x32_bf16 v[32:35], v[52:55], v[20:23], 0
    s_waitcnt vmcnt(6)
    s_barrier
    v_add_u32 v17, s62, v13
    ds_read_b64_tr_b16 v[48:49], v17 offset:0
    ds_read_b64_tr_b16 v[50:51], v17 offset:4608
    s_waitcnt lgkmcnt(8)
    v_mfma_f32_16x16x32_bf16 v[124:127], v[56:59], v[72:75], 0
    v_mfma_f32_16x16x32_bf16 v[196:199], v[56:59], v[76:79], 0
    ds_read_b64_tr_b16 v[52:53], v13 offset:160
    ds_read_b64_tr_b16 v[54:55], v13 offset:4768
    s_waitcnt lgkmcnt(8)
    v_mfma_f32_16x16x32_bf16 v[160:163], v[60:63], v[72:75], 0
    v_mfma_f32_16x16x32_bf16 v[232:235], v[60:63], v[76:79], 0
    ds_read_b64_tr_b16 v[56:57], v13 offset:9376
    ds_read_b64_tr_b16 v[58:59], v13 offset:13984
    s_waitcnt lgkmcnt(8)
    v_mfma_f32_16x16x32_bf16 v[128:131], v[64:67], v[72:75], 0
    v_mfma_f32_16x16x32_bf16 v[200:203], v[64:67], v[76:79], 0
    ds_read_b64_tr_b16 v[60:61], v13 offset:192
    ds_read_b64_tr_b16 v[62:63], v13 offset:4800
    s_waitcnt lgkmcnt(8)
    v_mfma_f32_16x16x32_bf16 v[164:167], v[68:71], v[72:75], 0
    v_mfma_f32_16x16x32_bf16 v[236:239], v[68:71], v[76:79], 0
    ds_read_b64_tr_b16 v[64:65], v13 offset:9408
    ds_read_b64_tr_b16 v[66:67], v13 offset:14016
    s_waitcnt lgkmcnt(8)
    v_mfma_f32_16x16x32_bf16 v[36:39], v[48:51], v[20:23], 0
    s_add_u32 s30, s22, 55296
    s_add_u32 s29, s54, 884736
    s_add_u32 m0, s30, 0
    s_mov_b64 exec, s[50:51]
    buffer_load_dwordx4 v10, s[8:11], s29 offen lds
    s_mov_b64 exec, -1
    v_add_u32 v18, s63, v13
    ds_read_b64_tr_b16 v[68:69], v18 offset:0
    ds_read_b64_tr_b16 v[70:71], v18 offset:4608
    s_waitcnt lgkmcnt(8)
    v_mfma_f32_16x16x32_bf16 v[132:135], v[52:55], v[72:75], 0
    v_mfma_f32_16x16x32_bf16 v[204:207], v[52:55], v[76:79], 0
    s_add_u32 m0, s30, 768
    s_mov_b64 exec, s[50:51]
    buffer_load_dwordx4 v11, s[8:11], s29 offen lds
    s_mov_b64 exec, -1
    ds_read_b64_tr_b16 v[48:49], v13 offset:224
    ds_read_b64_tr_b16 v[50:51], v13 offset:4832
    s_waitcnt lgkmcnt(8)
    v_mfma_f32_16x16x32_bf16 v[168:171], v[56:59], v[72:75], 0
    v_mfma_f32_16x16x32_bf16 v[240:243], v[56:59], v[76:79], 0
    s_add_u32 m0, s30, 1536
    s_mov_b64 exec, s[50:51]
    buffer_load_dwordx4 v12, s[8:11], s29 offen lds
    s_mov_b64 exec, -1
    ds_read_b64_tr_b16 v[52:53], v13 offset:9440
    ds_read_b64_tr_b16 v[54:55], v13 offset:14048
    s_waitcnt lgkmcnt(8)
    v_mfma_f32_16x16x32_bf16 v[136:139], v[60:63], v[72:75], 0
    v_mfma_f32_16x16x32_bf16 v[208:211], v[60:63], v[76:79], 0
    s_add_u32 s25, s25, 4096
    s_add_u32 s26, s26, 4096
    buffer_load_dwordx4 v[104:107], v3, s[12:15], s25 offen offset:0 sc1
    ds_read_b64_tr_b16 v[56:57], v13 offset:256
    ds_read_b64_tr_b16 v[58:59], v13 offset:4864
    s_waitcnt lgkmcnt(8)
    v_mfma_f32_16x16x32_bf16 v[172:175], v[64:67], v[72:75], 0
    v_mfma_f32_16x16x32_bf16 v[244:247], v[64:67], v[76:79], 0
    buffer_load_dwordx4 v[108:111], v3, s[12:15], s26 offen offset:0 sc1
    ds_read_b64_tr_b16 v[60:61], v13 offset:9472
    ds_read_b64_tr_b16 v[62:63], v13 offset:14080
    s_waitcnt lgkmcnt(8)
    v_mfma_f32_16x16x32_bf16 v[40:43], v[68:71], v[20:23], 0
    v_add_u32 v17, s64, v13
    ds_read_b64_tr_b16 v[64:65], v17 offset:0
    ds_read_b64_tr_b16 v[66:67], v17 offset:4608
    s_waitcnt lgkmcnt(8)
    v_mfma_f32_16x16x32_bf16 v[140:143], v[48:51], v[72:75], 0
    v_mfma_f32_16x16x32_bf16 v[212:215], v[48:51], v[76:79], 0
    ds_read_b64_tr_b16 v[68:69], v13 offset:18432
    ds_read_b64_tr_b16 v[70:71], v13 offset:23040
    s_waitcnt lgkmcnt(8)
    v_mfma_f32_16x16x32_bf16 v[176:179], v[52:55], v[72:75], 0
    v_mfma_f32_16x16x32_bf16 v[248:251], v[52:55], v[76:79], 0
    ds_read_b64_tr_b16 v[48:49], v13 offset:27648
    ds_read_b64_tr_b16 v[50:51], v13 offset:32256
    s_waitcnt lgkmcnt(8)
    v_mfma_f32_16x16x32_bf16 v[144:147], v[56:59], v[72:75], 0
    v_mfma_f32_16x16x32_bf16 v[216:219], v[56:59], v[76:79], 0
    v_add_u32 v17, s60, v13
    ds_read_b64_tr_b16 v[52:53], v17 offset:18432
    ds_read_b64_tr_b16 v[54:55], v17 offset:23040
    s_waitcnt lgkmcnt(8)
    v_mfma_f32_16x16x32_bf16 v[180:183], v[60:63], v[72:75], 0
    v_mfma_f32_16x16x32_bf16 v[252:255], v[60:63], v[76:79], 0
    ds_read_b64_tr_b16 v[56:57], v13 offset:18464
    ds_read_b64_tr_b16 v[58:59], v13 offset:23072
    s_waitcnt lgkmcnt(8)
    v_mfma_f32_16x16x32_bf16 v[44:47], v[64:67], v[20:23], 0
    ds_read_b64_tr_b16 v[60:61], v13 offset:27680
    ds_read_b64_tr_b16 v[62:63], v13 offset:32288
    s_waitcnt lgkmcnt(8)
    v_mfma_f32_16x16x32_bf16 v[112:115], v[68:71], v[80:83], v[112:115]
    v_mfma_f32_16x16x32_bf16 v[184:187], v[68:71], v[84:87], v[184:187]
    ds_read_b64_tr_b16 v[64:65], v13 offset:18496
    ds_read_b64_tr_b16 v[66:67], v13 offset:23104
    s_waitcnt lgkmcnt(8)
    v_mfma_f32_16x16x32_bf16 v[148:151], v[48:51], v[80:83], v[148:151]
    v_mfma_f32_16x16x32_bf16 v[220:223], v[48:51], v[84:87], v[220:223]
    v_add_u32 v16, v16, v19
    ds_read_b128 v[20:23], v16
    ds_read_b64_tr_b16 v[68:69], v13 offset:27712
    ds_read_b64_tr_b16 v[70:71], v13 offset:32320
    s_waitcnt lgkmcnt(8)
    v_mfma_f32_16x16x32_bf16 v[28:31], v[52:55], v[24:27], v[28:31]
    v_add_u32 v18, s61, v13
    ds_read_b64_tr_b16 v[48:49], v18 offset:18432
    ds_read_b64_tr_b16 v[50:51], v18 offset:23040
    s_waitcnt lgkmcnt(8)
    v_mfma_f32_16x16x32_bf16 v[116:119], v[56:59], v[80:83], v[116:119]
    v_mfma_f32_16x16x32_bf16 v[188:191], v[56:59], v[84:87], v[188:191]
    ds_read_b64_tr_b16 v[52:53], v13 offset:18528
    ds_read_b64_tr_b16 v[54:55], v13 offset:23136
    s_waitcnt lgkmcnt(8)
    v_mfma_f32_16x16x32_bf16 v[152:155], v[60:63], v[80:83], v[152:155]
    v_mfma_f32_16x16x32_bf16 v[224:227], v[60:63], v[84:87], v[224:227]
    ds_read_b64_tr_b16 v[56:57], v13 offset:27744
    ds_read_b64_tr_b16 v[58:59], v13 offset:32352
    s_waitcnt lgkmcnt(8)
    v_mfma_f32_16x16x32_bf16 v[120:123], v[64:67], v[80:83], v[120:123]
    v_mfma_f32_16x16x32_bf16 v[192:195], v[64:67], v[84:87], v[192:195]
    ds_read_b64_tr_b16 v[60:61], v13 offset:18560
    ds_read_b64_tr_b16 v[62:63], v13 offset:23168
    s_waitcnt lgkmcnt(8)
    v_mfma_f32_16x16x32_bf16 v[156:159], v[68:71], v[80:83], v[156:159]
    v_mfma_f32_16x16x32_bf16 v[228:231], v[68:71], v[84:87], v[228:231]
    ds_read_b64_tr_b16 v[64:65], v13 offset:27776
    ds_read_b64_tr_b16 v[66:67], v13 offset:32384
    s_waitcnt lgkmcnt(8)
    v_mfma_f32_16x16x32_bf16 v[32:35], v[48:51], v[24:27], v[32:35]
    s_waitcnt vmcnt(9)
    s_barrier
    v_add_u32 v17, s62, v13
    ds_read_b64_tr_b16 v[68:69], v17 offset:18432
    ds_read_b64_tr_b16 v[70:71], v17 offset:23040
    s_waitcnt lgkmcnt(8)
    v_mfma_f32_16x16x32_bf16 v[124:127], v[52:55], v[80:83], v[124:127]
    v_mfma_f32_16x16x32_bf16 v[196:199], v[52:55], v[84:87], v[196:199]
    ds_read_b64_tr_b16 v[48:49], v13 offset:18592
    ds_read_b64_tr_b16 v[50:51], v13 offset:23200
    s_waitcnt lgkmcnt(8)
    v_mfma_f32_16x16x32_bf16 v[160:163], v[56:59], v[80:83], v[160:163]
    v_mfma_f32_16x16x32_bf16 v[232:235], v[56:59], v[84:87], v[232:235]
    ds_read_b64_tr_b16 v[52:53], v13 offset:27808
    ds_read_b64_tr_b16 v[54:55], v13 offset:32416
    s_waitcnt lgkmcnt(8)
    v_mfma_f32_16x16x32_bf16 v[128:131], v[60:63], v[80:83], v[128:131]
    v_mfma_f32_16x16x32_bf16 v[200:203], v[60:63], v[84:87], v[200:203]
    ds_read_b64_tr_b16 v[56:57], v13 offset:18624
    ds_read_b64_tr_b16 v[58:59], v13 offset:23232
    s_waitcnt lgkmcnt(8)
    v_mfma_f32_16x16x32_bf16 v[164:167], v[64:67], v[80:83], v[164:167]
    v_mfma_f32_16x16x32_bf16 v[236:239], v[64:67], v[84:87], v[236:239]
    ds_read_b64_tr_b16 v[60:61], v13 offset:27840
    ds_read_b64_tr_b16 v[62:63], v13 offset:32448
    s_waitcnt lgkmcnt(8)
    v_mfma_f32_16x16x32_bf16 v[36:39], v[68:71], v[24:27], v[36:39]
    s_add_u32 s30, s22, 73728
    s_add_u32 s29, s54, 1327104
    s_add_u32 m0, s30, 0
    s_mov_b64 exec, s[50:51]
    buffer_load_dwordx4 v10, s[8:11], s29 offen lds
    s_mov_b64 exec, -1
    v_add_u32 v18, s63, v13
    ds_read_b64_tr_b16 v[64:65], v18 offset:18432
    ds_read_b64_tr_b16 v[66:67], v18 offset:23040
    s_waitcnt lgkmcnt(8)
    v_mfma_f32_16x16x32_bf16 v[132:135], v[48:51], v[80:83], v[132:135]
    v_mfma_f32_16x16x32_bf16 v[204:207], v[48:51], v[84:87], v[204:207]
    s_add_u32 m0, s30, 768
    s_mov_b64 exec, s[50:51]
    buffer_load_dwordx4 v11, s[8:11], s29 offen lds
    s_mov_b64 exec, -1
    ds_read_b64_tr_b16 v[68:69], v13 offset:18656
    ds_read_b64_tr_b16 v[70:71], v13 offset:23264
    s_waitcnt lgkmcnt(8)
    v_mfma_f32_16x16x32_bf16 v[168:171], v[52:55], v[80:83], v[168:171]
    v_mfma_f32_16x16x32_bf16 v[240:243], v[52:55], v[84:87], v[240:243]
    s_add_u32 m0, s30, 1536
    s_mov_b64 exec, s[50:51]
    buffer_load_dwordx4 v12, s[8:11], s29 offen lds
    s_mov_b64 exec, -1
    ds_read_b64_tr_b16 v[48:49], v13 offset:27872
    ds_read_b64_tr_b16 v[50:51], v13 offset:32480
    s_waitcnt lgkmcnt(8)
    v_mfma_f32_16x16x32_bf16 v[136:139], v[56:59], v[80:83], v[136:139]
    v_mfma_f32_16x16x32_bf16 v[208:211], v[56:59], v[84:87], v[208:211]
    buffer_load_dwordx4 v[72:75], v3, s[12:15], s25 offen offset:1024 sc1
    ds_read_b64_tr_b16 v[52:53], v13 offset:18688
    ds_read_b64_tr_b16 v[54:55], v13 offset:23296
    s_waitcnt lgkmcnt(8)
    v_mfma_f32_16x16x32_bf16 v[172:175], v[60:63], v[80:83], v[172:175]
    v_mfma_f32_16x16x32_bf16 v[244:247], v[60:63], v[84:87], v[244:247]
    buffer_load_dwordx4 v[76:79], v3, s[12:15], s26 offen offset:1024 sc1
    ds_read_b64_tr_b16 v[56:57], v13 offset:27904
    ds_read_b64_tr_b16 v[58:59], v13 offset:32512
    s_waitcnt lgkmcnt(8)
    v_mfma_f32_16x16x32_bf16 v[40:43], v[64:67], v[24:27], v[40:43]
    v_add_u32 v17, s64, v13
    ds_read_b64_tr_b16 v[60:61], v17 offset:18432
    ds_read_b64_tr_b16 v[62:63], v17 offset:23040
    s_waitcnt lgkmcnt(8)
    v_mfma_f32_16x16x32_bf16 v[140:143], v[68:71], v[80:83], v[140:143]
    v_mfma_f32_16x16x32_bf16 v[212:215], v[68:71], v[84:87], v[212:215]
    ds_read_b64_tr_b16 v[64:65], v13 offset:36864
    ds_read_b64_tr_b16 v[66:67], v13 offset:41472
    s_waitcnt lgkmcnt(8)
    v_mfma_f32_16x16x32_bf16 v[176:179], v[48:51], v[80:83], v[176:179]
    v_mfma_f32_16x16x32_bf16 v[248:251], v[48:51], v[84:87], v[248:251]
    ds_read_b64_tr_b16 v[68:69], v13 offset:46080
    ds_read_b64_tr_b16 v[70:71], v13 offset:50688
    s_waitcnt lgkmcnt(8)
    v_mfma_f32_16x16x32_bf16 v[144:147], v[52:55], v[80:83], v[144:147]
    v_mfma_f32_16x16x32_bf16 v[216:219], v[52:55], v[84:87], v[216:219]
    v_add_u32 v17, s60, v13
    ds_read_b64_tr_b16 v[48:49], v17 offset:36864
    ds_read_b64_tr_b16 v[50:51], v17 offset:41472
    s_waitcnt lgkmcnt(8)
    v_mfma_f32_16x16x32_bf16 v[180:183], v[56:59], v[80:83], v[180:183]
    v_mfma_f32_16x16x32_bf16 v[252:255], v[56:59], v[84:87], v[252:255]
    ds_read_b64_tr_b16 v[52:53], v13 offset:36896
    ds_read_b64_tr_b16 v[54:55], v13 offset:41504
    s_waitcnt lgkmcnt(8)
    v_mfma_f32_16x16x32_bf16 v[44:47], v[60:63], v[24:27], v[44:47]
    ds_read_b64_tr_b16 v[56:57], v13 offset:46112
    ds_read_b64_tr_b16 v[58:59], v13 offset:50720
    s_waitcnt lgkmcnt(8)
    v_mfma_f32_16x16x32_bf16 v[112:115], v[64:67], v[88:91], v[112:115]
    v_mfma_f32_16x16x32_bf16 v[184:187], v[64:67], v[92:95], v[184:187]
    ds_read_b64_tr_b16 v[60:61], v13 offset:36928
    ds_read_b64_tr_b16 v[62:63], v13 offset:41536
    s_waitcnt lgkmcnt(8)
    v_mfma_f32_16x16x32_bf16 v[148:151], v[68:71], v[88:91], v[148:151]
    v_mfma_f32_16x16x32_bf16 v[220:223], v[68:71], v[92:95], v[220:223]
    v_add_u32 v16, v16, v19
    ds_read_b128 v[24:27], v16
    ds_read_b64_tr_b16 v[64:65], v13 offset:46144
    ds_read_b64_tr_b16 v[66:67], v13 offset:50752
    s_waitcnt lgkmcnt(8)
    v_mfma_f32_16x16x32_bf16 v[28:31], v[48:51], v[20:23], v[28:31]
    v_add_u32 v18, s61, v13
    ds_read_b64_tr_b16 v[68:69], v18 offset:36864
    ds_read_b64_tr_b16 v[70:71], v18 offset:41472
    s_waitcnt lgkmcnt(8)
    v_mfma_f32_16x16x32_bf16 v[116:119], v[52:55], v[88:91], v[116:119]
    v_mfma_f32_16x16x32_bf16 v[188:191], v[52:55], v[92:95], v[188:191]
    ds_read_b64_tr_b16 v[48:49], v13 offset:36960
    ds_read_b64_tr_b16 v[50:51], v13 offset:41568
    s_waitcnt lgkmcnt(8)
    v_mfma_f32_16x16x32_bf16 v[152:155], v[56:59], v[88:91], v[152:155]
    v_mfma_f32_16x16x32_bf16 v[224:227], v[56:59], v[92:95], v[224:227]
    ds_read_b64_tr_b16 v[52:53], v13 offset:46176
    ds_read_b64_tr_b16 v[54:55], v13 offset:50784
    s_waitcnt lgkmcnt(8)
    v_mfma_f32_16x16x32_bf16 v[120:123], v[60:63], v[88:91], v[120:123]
    v_mfma_f32_16x16x32_bf16 v[192:195], v[60:63], v[92:95], v[192:195]
    ds_read_b64_tr_b16 v[56:57], v13 offset:36992
    ds_read_b64_tr_b16 v[58:59], v13 offset:41600
    s_waitcnt lgkmcnt(8)
    v_mfma_f32_16x16x32_bf16 v[156:159], v[64:67], v[88:91], v[156:159]
    v_mfma_f32_16x16x32_bf16 v[228:231], v[64:67], v[92:95], v[228:231]
    ds_read_b64_tr_b16 v[60:61], v13 offset:46208
    ds_read_b64_tr_b16 v[62:63], v13 offset:50816
    s_waitcnt lgkmcnt(8)
    v_mfma_f32_16x16x32_bf16 v[32:35], v[68:71], v[20:23], v[32:35]
    s_waitcnt vmcnt(7)
    s_barrier
    v_add_u32 v17, s62, v13
    ds_read_b64_tr_b16 v[64:65], v17 offset:36864
    ds_read_b64_tr_b16 v[66:67], v17 offset:41472
    s_waitcnt lgkmcnt(8)
    v_mfma_f32_16x16x32_bf16 v[124:127], v[48:51], v[88:91], v[124:127]
    v_mfma_f32_16x16x32_bf16 v[196:199], v[48:51], v[92:95], v[196:199]
    ds_read_b64_tr_b16 v[68:69], v13 offset:37024
    ds_read_b64_tr_b16 v[70:71], v13 offset:41632
    s_waitcnt lgkmcnt(8)
    v_mfma_f32_16x16x32_bf16 v[160:163], v[52:55], v[88:91], v[160:163]
    v_mfma_f32_16x16x32_bf16 v[232:235], v[52:55], v[92:95], v[232:235]
    ds_read_b64_tr_b16 v[48:49], v13 offset:46240
    ds_read_b64_tr_b16 v[50:51], v13 offset:50848
    s_waitcnt lgkmcnt(8)
    v_mfma_f32_16x16x32_bf16 v[128:131], v[56:59], v[88:91], v[128:131]
    v_mfma_f32_16x16x32_bf16 v[200:203], v[56:59], v[92:95], v[200:203]
    ds_read_b64_tr_b16 v[52:53], v13 offset:37056
    ds_read_b64_tr_b16 v[54:55], v13 offset:41664
    s_waitcnt lgkmcnt(8)
    v_mfma_f32_16x16x32_bf16 v[164:167], v[60:63], v[88:91], v[164:167]
    v_mfma_f32_16x16x32_bf16 v[236:239], v[60:63], v[92:95], v[236:239]
    ds_read_b64_tr_b16 v[56:57], v13 offset:46272
    ds_read_b64_tr_b16 v[58:59], v13 offset:50880
    s_waitcnt lgkmcnt(8)
    v_mfma_f32_16x16x32_bf16 v[36:39], v[64:67], v[20:23], v[36:39]
    s_add_u32 s30, s22, 92160
    s_add_u32 s29, s54, 1622016
    s_add_u32 m0, s30, 0
    s_mov_b64 exec, s[50:51]
    buffer_load_dwordx4 v10, s[8:11], s29 offen lds
    s_mov_b64 exec, -1
    v_add_u32 v18, s63, v13
    ds_read_b64_tr_b16 v[60:61], v18 offset:36864
    ds_read_b64_tr_b16 v[62:63], v18 offset:41472
    s_waitcnt lgkmcnt(8)
    v_mfma_f32_16x16x32_bf16 v[132:135], v[68:71], v[88:91], v[132:135]
    v_mfma_f32_16x16x32_bf16 v[204:207], v[68:71], v[92:95], v[204:207]
    s_add_u32 m0, s30, 768
    s_mov_b64 exec, s[50:51]
    buffer_load_dwordx4 v11, s[8:11], s29 offen lds
    s_mov_b64 exec, -1
    ds_read_b64_tr_b16 v[64:65], v13 offset:37088
    ds_read_b64_tr_b16 v[66:67], v13 offset:41696
    s_waitcnt lgkmcnt(8)
    v_mfma_f32_16x16x32_bf16 v[168:171], v[48:51], v[88:91], v[168:171]
    v_mfma_f32_16x16x32_bf16 v[240:243], v[48:51], v[92:95], v[240:243]
    s_add_u32 m0, s30, 1536
    s_mov_b64 exec, s[50:51]
    buffer_load_dwordx4 v12, s[8:11], s29 offen lds
    s_mov_b64 exec, -1
    ds_read_b64_tr_b16 v[68:69], v13 offset:46304
    ds_read_b64_tr_b16 v[70:71], v13 offset:50912
    s_waitcnt lgkmcnt(8)
    v_mfma_f32_16x16x32_bf16 v[136:139], v[52:55], v[88:91], v[136:139]
    v_mfma_f32_16x16x32_bf16 v[208:211], v[52:55], v[92:95], v[208:211]
    buffer_load_dwordx4 v[80:83], v3, s[12:15], s25 offen offset:2048 sc1
    ds_read_b64_tr_b16 v[48:49], v13 offset:37120
    ds_read_b64_tr_b16 v[50:51], v13 offset:41728
    s_waitcnt lgkmcnt(8)
    v_mfma_f32_16x16x32_bf16 v[172:175], v[56:59], v[88:91], v[172:175]
    v_mfma_f32_16x16x32_bf16 v[244:247], v[56:59], v[92:95], v[244:247]
    buffer_load_dwordx4 v[84:87], v3, s[12:15], s26 offen offset:2048 sc1
    ds_read_b64_tr_b16 v[52:53], v13 offset:46336
    ds_read_b64_tr_b16 v[54:55], v13 offset:50944
    s_waitcnt lgkmcnt(8)
    v_mfma_f32_16x16x32_bf16 v[40:43], v[60:63], v[20:23], v[40:43]
    v_add_u32 v17, s64, v13
    ds_read_b64_tr_b16 v[56:57], v17 offset:36864
    ds_read_b64_tr_b16 v[58:59], v17 offset:41472
    s_waitcnt lgkmcnt(8)
    v_mfma_f32_16x16x32_bf16 v[140:143], v[64:67], v[88:91], v[140:143]
    v_mfma_f32_16x16x32_bf16 v[212:215], v[64:67], v[92:95], v[212:215]
    ds_read_b64_tr_b16 v[60:61], v14 offset:0
    ds_read_b64_tr_b16 v[62:63], v14 offset:4608
    s_waitcnt lgkmcnt(8)
    v_mfma_f32_16x16x32_bf16 v[176:179], v[68:71], v[88:91], v[176:179]
    v_mfma_f32_16x16x32_bf16 v[248:251], v[68:71], v[92:95], v[248:251]
    ds_read_b64_tr_b16 v[64:65], v14 offset:9216
    ds_read_b64_tr_b16 v[66:67], v14 offset:13824
    s_waitcnt lgkmcnt(8)
    v_mfma_f32_16x16x32_bf16 v[144:147], v[48:51], v[88:91], v[144:147]
    v_mfma_f32_16x16x32_bf16 v[216:219], v[48:51], v[92:95], v[216:219]
    v_add_u32 v17, s60, v14
    ds_read_b64_tr_b16 v[68:69], v17 offset:0
    ds_read_b64_tr_b16 v[70:71], v17 offset:4608
    s_waitcnt lgkmcnt(8)
    v_mfma_f32_16x16x32_bf16 v[180:183], v[52:55], v[88:91], v[180:183]
    v_mfma_f32_16x16x32_bf16 v[252:255], v[52:55], v[92:95], v[252:255]
    ds_read_b64_tr_b16 v[48:49], v14 offset:32
    ds_read_b64_tr_b16 v[50:51], v14 offset:4640
    s_waitcnt lgkmcnt(8)
    v_mfma_f32_16x16x32_bf16 v[44:47], v[56:59], v[20:23], v[44:47]
    ds_read_b64_tr_b16 v[52:53], v14 offset:9248
    ds_read_b64_tr_b16 v[54:55], v14 offset:13856
    s_waitcnt lgkmcnt(8)
    v_mfma_f32_16x16x32_bf16 v[112:115], v[60:63], v[96:99], v[112:115]
    v_mfma_f32_16x16x32_bf16 v[184:187], v[60:63], v[100:103], v[184:187]
    ds_read_b64_tr_b16 v[56:57], v14 offset:64
    ds_read_b64_tr_b16 v[58:59], v14 offset:4672
    s_waitcnt lgkmcnt(8)
    v_mfma_f32_16x16x32_bf16 v[148:151], v[64:67], v[96:99], v[148:151]
    v_mfma_f32_16x16x32_bf16 v[220:223], v[64:67], v[100:103], v[220:223]
    v_add_u32 v16, v16, v19
    ds_read_b128 v[20:23], v16
    ds_read_b64_tr_b16 v[60:61], v14 offset:9280
    ds_read_b64_tr_b16 v[62:63], v14 offset:13888
    s_waitcnt lgkmcnt(8)
    v_mfma_f32_16x16x32_bf16 v[28:31], v[68:71], v[24:27], v[28:31]
    v_add_u32 v18, s61, v14
    ds_read_b64_tr_b16 v[64:65], v18 offset:0
    ds_read_b64_tr_b16 v[66:67], v18 offset:4608
    s_waitcnt lgkmcnt(8)
    v_mfma_f32_16x16x32_bf16 v[116:119], v[48:51], v[96:99], v[116:119]
    v_mfma_f32_16x16x32_bf16 v[188:191], v[48:51], v[100:103], v[188:191]
    ds_read_b64_tr_b16 v[68:69], v14 offset:96
    ds_read_b64_tr_b16 v[70:71], v14 offset:4704
    s_waitcnt lgkmcnt(8)
    v_mfma_f32_16x16x32_bf16 v[152:155], v[52:55], v[96:99], v[152:155]
    v_mfma_f32_16x16x32_bf16 v[224:227], v[52:55], v[100:103], v[224:227]
    ds_read_b64_tr_b16 v[48:49], v14 offset:9312
    ds_read_b64_tr_b16 v[50:51], v14 offset:13920
    s_waitcnt lgkmcnt(8)
    v_mfma_f32_16x16x32_bf16 v[120:123], v[56:59], v[96:99], v[120:123]
    v_mfma_f32_16x16x32_bf16 v[192:195], v[56:59], v[100:103], v[192:195]
    ds_read_b64_tr_b16 v[52:53], v14 offset:128
    ds_read_b64_tr_b16 v[54:55], v14 offset:4736
    s_waitcnt lgkmcnt(8)
    v_mfma_f32_16x16x32_bf16 v[156:159], v[60:63], v[96:99], v[156:159]
    v_mfma_f32_16x16x32_bf16 v[228:231], v[60:63], v[100:103], v[228:231]
    ds_read_b64_tr_b16 v[56:57], v14 offset:9344
    ds_read_b64_tr_b16 v[58:59], v14 offset:13952
    s_waitcnt lgkmcnt(8)
    v_mfma_f32_16x16x32_bf16 v[32:35], v[64:67], v[24:27], v[32:35]
    s_waitcnt vmcnt(7)
    s_barrier
    v_add_u32 v17, s62, v14
    ds_read_b64_tr_b16 v[60:61], v17 offset:0
    ds_read_b64_tr_b16 v[62:63], v17 offset:4608
    s_waitcnt lgkmcnt(8)
    v_mfma_f32_16x16x32_bf16 v[124:127], v[68:71], v[96:99], v[124:127]
    v_mfma_f32_16x16x32_bf16 v[196:199], v[68:71], v[100:103], v[196:199]
    ds_read_b64_tr_b16 v[64:65], v14 offset:160
    ds_read_b64_tr_b16 v[66:67], v14 offset:4768
    s_waitcnt lgkmcnt(8)
    v_mfma_f32_16x16x32_bf16 v[160:163], v[48:51], v[96:99], v[160:163]
    v_mfma_f32_16x16x32_bf16 v[232:235], v[48:51], v[100:103], v[232:235]
    ds_read_b64_tr_b16 v[68:69], v14 offset:9376
    ds_read_b64_tr_b16 v[70:71], v14 offset:13984
    s_waitcnt lgkmcnt(8)
    v_mfma_f32_16x16x32_bf16 v[128:131], v[52:55], v[96:99], v[128:131]
    v_mfma_f32_16x16x32_bf16 v[200:203], v[52:55], v[100:103], v[200:203]
    ds_read_b64_tr_b16 v[48:49], v14 offset:192
    ds_read_b64_tr_b16 v[50:51], v14 offset:4800
    s_waitcnt lgkmcnt(8)
    v_mfma_f32_16x16x32_bf16 v[164:167], v[56:59], v[96:99], v[164:167]
    v_mfma_f32_16x16x32_bf16 v[236:239], v[56:59], v[100:103], v[236:239]
    ds_read_b64_tr_b16 v[52:53], v14 offset:9408
    ds_read_b64_tr_b16 v[54:55], v14 offset:14016
    s_waitcnt lgkmcnt(8)
    v_mfma_f32_16x16x32_bf16 v[36:39], v[60:63], v[24:27], v[36:39]
    s_add_u32 s30, s22, 110592
    s_add_u32 s29, s54, 1916928
    s_add_u32 m0, s30, 0
    s_mov_b64 exec, s[50:51]
    buffer_load_dwordx4 v10, s[8:11], s29 offen lds
    s_mov_b64 exec, -1
    v_add_u32 v18, s63, v14
    ds_read_b64_tr_b16 v[56:57], v18 offset:0
    ds_read_b64_tr_b16 v[58:59], v18 offset:4608
    s_waitcnt lgkmcnt(8)
    v_mfma_f32_16x16x32_bf16 v[132:135], v[64:67], v[96:99], v[132:135]
    v_mfma_f32_16x16x32_bf16 v[204:207], v[64:67], v[100:103], v[204:207]
    s_add_u32 m0, s30, 768
    s_mov_b64 exec, s[50:51]
    buffer_load_dwordx4 v11, s[8:11], s29 offen lds
    s_mov_b64 exec, -1
    ds_read_b64_tr_b16 v[60:61], v14 offset:224
    ds_read_b64_tr_b16 v[62:63], v14 offset:4832
    s_waitcnt lgkmcnt(8)
    v_mfma_f32_16x16x32_bf16 v[168:171], v[68:71], v[96:99], v[168:171]
    v_mfma_f32_16x16x32_bf16 v[240:243], v[68:71], v[100:103], v[240:243]
    s_add_u32 m0, s30, 1536
    s_mov_b64 exec, s[50:51]
    buffer_load_dwordx4 v12, s[8:11], s29 offen lds
    s_mov_b64 exec, -1
    ds_read_b64_tr_b16 v[64:65], v14 offset:9440
    ds_read_b64_tr_b16 v[66:67], v14 offset:14048
    s_waitcnt lgkmcnt(8)
    v_mfma_f32_16x16x32_bf16 v[136:139], v[48:51], v[96:99], v[136:139]
    v_mfma_f32_16x16x32_bf16 v[208:211], v[48:51], v[100:103], v[208:211]
    buffer_load_dwordx4 v[88:91], v3, s[12:15], s25 offen offset:3072 sc1
    ds_read_b64_tr_b16 v[68:69], v14 offset:256
    ds_read_b64_tr_b16 v[70:71], v14 offset:4864
    s_waitcnt lgkmcnt(8)
    v_mfma_f32_16x16x32_bf16 v[172:175], v[52:55], v[96:99], v[172:175]
    v_mfma_f32_16x16x32_bf16 v[244:247], v[52:55], v[100:103], v[244:247]
    buffer_load_dwordx4 v[92:95], v3, s[12:15], s26 offen offset:3072 sc1
    ds_read_b64_tr_b16 v[48:49], v14 offset:9472
    ds_read_b64_tr_b16 v[50:51], v14 offset:14080
    s_waitcnt lgkmcnt(8)
    v_mfma_f32_16x16x32_bf16 v[40:43], v[56:59], v[24:27], v[40:43]
    v_add_u32 v17, s64, v14
    ds_read_b64_tr_b16 v[52:53], v17 offset:0
    ds_read_b64_tr_b16 v[54:55], v17 offset:4608
    s_waitcnt lgkmcnt(8)
    v_mfma_f32_16x16x32_bf16 v[140:143], v[60:63], v[96:99], v[140:143]
    v_mfma_f32_16x16x32_bf16 v[212:215], v[60:63], v[100:103], v[212:215]
    ds_read_b64_tr_b16 v[56:57], v14 offset:18432
    ds_read_b64_tr_b16 v[58:59], v14 offset:23040
    s_waitcnt lgkmcnt(8)
    v_mfma_f32_16x16x32_bf16 v[176:179], v[64:67], v[96:99], v[176:179]
    v_mfma_f32_16x16x32_bf16 v[248:251], v[64:67], v[100:103], v[248:251]
    ds_read_b64_tr_b16 v[60:61], v14 offset:27648
    ds_read_b64_tr_b16 v[62:63], v14 offset:32256
    s_waitcnt lgkmcnt(8)
    v_mfma_f32_16x16x32_bf16 v[144:147], v[68:71], v[96:99], v[144:147]
    v_mfma_f32_16x16x32_bf16 v[216:219], v[68:71], v[100:103], v[216:219]
    v_add_u32 v17, s60, v14
    ds_read_b64_tr_b16 v[64:65], v17 offset:18432
    ds_read_b64_tr_b16 v[66:67], v17 offset:23040
    s_waitcnt lgkmcnt(8)
    v_mfma_f32_16x16x32_bf16 v[180:183], v[48:51], v[96:99], v[180:183]
    v_mfma_f32_16x16x32_bf16 v[252:255], v[48:51], v[100:103], v[252:255]
    ds_read_b64_tr_b16 v[68:69], v14 offset:18464
    ds_read_b64_tr_b16 v[70:71], v14 offset:23072
    s_waitcnt lgkmcnt(8)
    v_mfma_f32_16x16x32_bf16 v[44:47], v[52:55], v[24:27], v[44:47]
    ds_read_b64_tr_b16 v[48:49], v14 offset:27680
    ds_read_b64_tr_b16 v[50:51], v14 offset:32288
    s_waitcnt lgkmcnt(8)
    v_mfma_f32_16x16x32_bf16 v[112:115], v[56:59], v[104:107], v[112:115]
    v_mfma_f32_16x16x32_bf16 v[184:187], v[56:59], v[108:111], v[184:187]
    ds_read_b64_tr_b16 v[52:53], v14 offset:18496
    ds_read_b64_tr_b16 v[54:55], v14 offset:23104
    s_waitcnt lgkmcnt(8)
    v_mfma_f32_16x16x32_bf16 v[148:151], v[60:63], v[104:107], v[148:151]
    v_mfma_f32_16x16x32_bf16 v[220:223], v[60:63], v[108:111], v[220:223]
    v_add_u32 v16, v16, v19
    ds_read_b128 v[24:27], v16
    ds_read_b64_tr_b16 v[56:57], v14 offset:27712
    ds_read_b64_tr_b16 v[58:59], v14 offset:32320
    s_waitcnt lgkmcnt(8)
    v_mfma_f32_16x16x32_bf16 v[28:31], v[64:67], v[20:23], v[28:31]
    v_add_u32 v18, s61, v14
    ds_read_b64_tr_b16 v[60:61], v18 offset:18432
    ds_read_b64_tr_b16 v[62:63], v18 offset:23040
    s_waitcnt lgkmcnt(8)
    v_mfma_f32_16x16x32_bf16 v[116:119], v[68:71], v[104:107], v[116:119]
    v_mfma_f32_16x16x32_bf16 v[188:191], v[68:71], v[108:111], v[188:191]
    ds_read_b64_tr_b16 v[64:65], v14 offset:18528
    ds_read_b64_tr_b16 v[66:67], v14 offset:23136
    s_waitcnt lgkmcnt(8)
    v_mfma_f32_16x16x32_bf16 v[152:155], v[48:51], v[104:107], v[152:155]
    v_mfma_f32_16x16x32_bf16 v[224:227], v[48:51], v[108:111], v[224:227]
    ds_read_b64_tr_b16 v[68:69], v14 offset:27744
    ds_read_b64_tr_b16 v[70:71], v14 offset:32352
    s_waitcnt lgkmcnt(8)
    v_mfma_f32_16x16x32_bf16 v[120:123], v[52:55], v[104:107], v[120:123]
    v_mfma_f32_16x16x32_bf16 v[192:195], v[52:55], v[108:111], v[192:195]
    ds_read_b64_tr_b16 v[48:49], v14 offset:18560
    ds_read_b64_tr_b16 v[50:51], v14 offset:23168
    s_waitcnt lgkmcnt(8)
    v_mfma_f32_16x16x32_bf16 v[156:159], v[56:59], v[104:107], v[156:159]
    v_mfma_f32_16x16x32_bf16 v[228:231], v[56:59], v[108:111], v[228:231]
    ds_read_b64_tr_b16 v[52:53], v14 offset:27776
    ds_read_b64_tr_b16 v[54:55], v14 offset:32384
    s_waitcnt lgkmcnt(8)
    v_mfma_f32_16x16x32_bf16 v[32:35], v[60:63], v[20:23], v[32:35]
    s_waitcnt vmcnt(7)
    s_barrier
    v_add_u32 v17, s62, v14
    ds_read_b64_tr_b16 v[56:57], v17 offset:18432
    ds_read_b64_tr_b16 v[58:59], v17 offset:23040
    s_waitcnt lgkmcnt(8)
    v_mfma_f32_16x16x32_bf16 v[124:127], v[64:67], v[104:107], v[124:127]
    v_mfma_f32_16x16x32_bf16 v[196:199], v[64:67], v[108:111], v[196:199]
    ds_read_b64_tr_b16 v[60:61], v14 offset:18592
    ds_read_b64_tr_b16 v[62:63], v14 offset:23200
    s_waitcnt lgkmcnt(8)
    v_mfma_f32_16x16x32_bf16 v[160:163], v[68:71], v[104:107], v[160:163]
    v_mfma_f32_16x16x32_bf16 v[232:235], v[68:71], v[108:111], v[232:235]
    ds_read_b64_tr_b16 v[64:65], v14 offset:27808
    ds_read_b64_tr_b16 v[66:67], v14 offset:32416
    s_waitcnt lgkmcnt(8)
    v_mfma_f32_16x16x32_bf16 v[128:131], v[48:51], v[104:107], v[128:131]
    v_mfma_f32_16x16x32_bf16 v[200:203], v[48:51], v[108:111], v[200:203]
    ds_read_b64_tr_b16 v[68:69], v14 offset:18624
    ds_read_b64_tr_b16 v[70:71], v14 offset:23232
    s_waitcnt lgkmcnt(8)
    v_mfma_f32_16x16x32_bf16 v[164:167], v[52:55], v[104:107], v[164:167]
    v_mfma_f32_16x16x32_bf16 v[236:239], v[52:55], v[108:111], v[236:239]
    ds_read_b64_tr_b16 v[48:49], v14 offset:27840
    ds_read_b64_tr_b16 v[50:51], v14 offset:32448
    s_waitcnt lgkmcnt(8)
    v_mfma_f32_16x16x32_bf16 v[36:39], v[56:59], v[20:23], v[36:39]
    s_add_u32 s30, s22, 129024
    s_add_u32 s29, s54, 2211840
    s_add_u32 m0, s30, 0
    s_mov_b64 exec, s[50:51]
    buffer_load_dwordx4 v10, s[8:11], s29 offen lds
    s_mov_b64 exec, -1
    v_add_u32 v18, s63, v14
    ds_read_b64_tr_b16 v[52:53], v18 offset:18432
    ds_read_b64_tr_b16 v[54:55], v18 offset:23040
    s_waitcnt lgkmcnt(8)
    v_mfma_f32_16x16x32_bf16 v[132:135], v[60:63], v[104:107], v[132:135]
    v_mfma_f32_16x16x32_bf16 v[204:207], v[60:63], v[108:111], v[204:207]
    s_add_u32 m0, s30, 768
    s_mov_b64 exec, s[50:51]
    buffer_load_dwordx4 v11, s[8:11], s29 offen lds
    s_mov_b64 exec, -1
    ds_read_b64_tr_b16 v[56:57], v14 offset:18656
    ds_read_b64_tr_b16 v[58:59], v14 offset:23264
    s_waitcnt lgkmcnt(8)
    v_mfma_f32_16x16x32_bf16 v[168:171], v[64:67], v[104:107], v[168:171]
    v_mfma_f32_16x16x32_bf16 v[240:243], v[64:67], v[108:111], v[240:243]
    s_add_u32 m0, s30, 1536
    s_mov_b64 exec, s[50:51]
    buffer_load_dwordx4 v12, s[8:11], s29 offen lds
    s_mov_b64 exec, -1
    ds_read_b64_tr_b16 v[60:61], v14 offset:27872
    ds_read_b64_tr_b16 v[62:63], v14 offset:32480
    s_waitcnt lgkmcnt(8)
    v_mfma_f32_16x16x32_bf16 v[136:139], v[68:71], v[104:107], v[136:139]
    v_mfma_f32_16x16x32_bf16 v[208:211], v[68:71], v[108:111], v[208:211]
    s_add_u32 s25, s25, 4096
    s_add_u32 s26, s26, 4096
    buffer_load_dwordx4 v[96:99], v3, s[12:15], s25 offen offset:0 sc1
    ds_read_b64_tr_b16 v[64:65], v14 offset:18688
    ds_read_b64_tr_b16 v[66:67], v14 offset:23296
    s_waitcnt lgkmcnt(8)
    v_mfma_f32_16x16x32_bf16 v[172:175], v[48:51], v[104:107], v[172:175]
    v_mfma_f32_16x16x32_bf16 v[244:247], v[48:51], v[108:111], v[244:247]
    buffer_load_dwordx4 v[100:103], v3, s[12:15], s26 offen offset:0 sc1
    ds_read_b64_tr_b16 v[68:69], v14 offset:27904
    ds_read_b64_tr_b16 v[70:71], v14 offset:32512
    s_waitcnt lgkmcnt(8)
    v_mfma_f32_16x16x32_bf16 v[40:43], v[52:55], v[20:23], v[40:43]
    v_add_u32 v17, s64, v14
    ds_read_b64_tr_b16 v[48:49], v17 offset:18432
    ds_read_b64_tr_b16 v[50:51], v17 offset:23040
    s_waitcnt lgkmcnt(8)
    v_mfma_f32_16x16x32_bf16 v[140:143], v[56:59], v[104:107], v[140:143]
    v_mfma_f32_16x16x32_bf16 v[212:215], v[56:59], v[108:111], v[212:215]
    ds_read_b64_tr_b16 v[52:53], v14 offset:36864
    ds_read_b64_tr_b16 v[54:55], v14 offset:41472
    s_waitcnt lgkmcnt(8)
    v_mfma_f32_16x16x32_bf16 v[176:179], v[60:63], v[104:107], v[176:179]
    v_mfma_f32_16x16x32_bf16 v[248:251], v[60:63], v[108:111], v[248:251]
    ds_read_b64_tr_b16 v[56:57], v14 offset:46080
    ds_read_b64_tr_b16 v[58:59], v14 offset:50688
    s_waitcnt lgkmcnt(8)
    v_mfma_f32_16x16x32_bf16 v[144:147], v[64:67], v[104:107], v[144:147]
    v_mfma_f32_16x16x32_bf16 v[216:219], v[64:67], v[108:111], v[216:219]
    v_add_u32 v17, s60, v14
    ds_read_b64_tr_b16 v[60:61], v17 offset:36864
    ds_read_b64_tr_b16 v[62:63], v17 offset:41472
    s_waitcnt lgkmcnt(8)
    v_mfma_f32_16x16x32_bf16 v[180:183], v[68:71], v[104:107], v[180:183]
    v_mfma_f32_16x16x32_bf16 v[252:255], v[68:71], v[108:111], v[252:255]
    ds_read_b64_tr_b16 v[64:65], v14 offset:36896
    ds_read_b64_tr_b16 v[66:67], v14 offset:41504
    s_waitcnt lgkmcnt(8)
    v_mfma_f32_16x16x32_bf16 v[44:47], v[48:51], v[20:23], v[44:47]
    ds_read_b64_tr_b16 v[68:69], v14 offset:46112
    ds_read_b64_tr_b16 v[70:71], v14 offset:50720
    s_waitcnt lgkmcnt(8)
    v_mfma_f32_16x16x32_bf16 v[112:115], v[52:55], v[72:75], v[112:115]
    v_mfma_f32_16x16x32_bf16 v[184:187], v[52:55], v[76:79], v[184:187]
    ds_read_b64_tr_b16 v[48:49], v14 offset:36928
    ds_read_b64_tr_b16 v[50:51], v14 offset:41536
    s_waitcnt lgkmcnt(8)
    v_mfma_f32_16x16x32_bf16 v[148:151], v[56:59], v[72:75], v[148:151]
    v_mfma_f32_16x16x32_bf16 v[220:223], v[56:59], v[76:79], v[220:223]
    v_add_u32 v16, v16, v19
    ds_read_b128 v[20:23], v16
    ds_read_b64_tr_b16 v[52:53], v14 offset:46144
    ds_read_b64_tr_b16 v[54:55], v14 offset:50752
    s_waitcnt lgkmcnt(8)
    v_mfma_f32_16x16x32_bf16 v[28:31], v[60:63], v[24:27], v[28:31]
    v_add_u32 v18, s61, v14
    ds_read_b64_tr_b16 v[56:57], v18 offset:36864
    ds_read_b64_tr_b16 v[58:59], v18 offset:41472
    s_waitcnt lgkmcnt(8)
    v_mfma_f32_16x16x32_bf16 v[116:119], v[64:67], v[72:75], v[116:119]
    v_mfma_f32_16x16x32_bf16 v[188:191], v[64:67], v[76:79], v[188:191]
    ds_read_b64_tr_b16 v[60:61], v14 offset:36960
    ds_read_b64_tr_b16 v[62:63], v14 offset:41568
    s_waitcnt lgkmcnt(8)
    v_mfma_f32_16x16x32_bf16 v[152:155], v[68:71], v[72:75], v[152:155]
    v_mfma_f32_16x16x32_bf16 v[224:227], v[68:71], v[76:79], v[224:227]
    ds_read_b64_tr_b16 v[64:65], v14 offset:46176
    ds_read_b64_tr_b16 v[66:67], v14 offset:50784
    s_waitcnt lgkmcnt(8)
    v_mfma_f32_16x16x32_bf16 v[120:123], v[48:51], v[72:75], v[120:123]
    v_mfma_f32_16x16x32_bf16 v[192:195], v[48:51], v[76:79], v[192:195]
    ds_read_b64_tr_b16 v[68:69], v14 offset:36992
    ds_read_b64_tr_b16 v[70:71], v14 offset:41600
    s_waitcnt lgkmcnt(8)
    v_mfma_f32_16x16x32_bf16 v[156:159], v[52:55], v[72:75], v[156:159]
    v_mfma_f32_16x16x32_bf16 v[228:231], v[52:55], v[76:79], v[228:231]
    ds_read_b64_tr_b16 v[48:49], v14 offset:46208
    ds_read_b64_tr_b16 v[50:51], v14 offset:50816
    s_waitcnt lgkmcnt(8)
    v_mfma_f32_16x16x32_bf16 v[32:35], v[56:59], v[24:27], v[32:35]
    s_waitcnt vmcnt(7)
    s_barrier
    v_add_u32 v17, s62, v14
    ds_read_b64_tr_b16 v[52:53], v17 offset:36864
    ds_read_b64_tr_b16 v[54:55], v17 offset:41472
    s_waitcnt lgkmcnt(8)
    v_mfma_f32_16x16x32_bf16 v[124:127], v[60:63], v[72:75], v[124:127]
    v_mfma_f32_16x16x32_bf16 v[196:199], v[60:63], v[76:79], v[196:199]
    ds_read_b64_tr_b16 v[56:57], v14 offset:37024
    ds_read_b64_tr_b16 v[58:59], v14 offset:41632
    s_waitcnt lgkmcnt(8)
    v_mfma_f32_16x16x32_bf16 v[160:163], v[64:67], v[72:75], v[160:163]
    v_mfma_f32_16x16x32_bf16 v[232:235], v[64:67], v[76:79], v[232:235]
    ds_read_b64_tr_b16 v[60:61], v14 offset:46240
    ds_read_b64_tr_b16 v[62:63], v14 offset:50848
    s_waitcnt lgkmcnt(8)
    v_mfma_f32_16x16x32_bf16 v[128:131], v[68:71], v[72:75], v[128:131]
    v_mfma_f32_16x16x32_bf16 v[200:203], v[68:71], v[76:79], v[200:203]
    ds_read_b64_tr_b16 v[64:65], v14 offset:37056
    ds_read_b64_tr_b16 v[66:67], v14 offset:41664
    s_waitcnt lgkmcnt(8)
    v_mfma_f32_16x16x32_bf16 v[164:167], v[48:51], v[72:75], v[164:167]
    v_mfma_f32_16x16x32_bf16 v[236:239], v[48:51], v[76:79], v[236:239]
    ds_read_b64_tr_b16 v[68:69], v14 offset:46272
    ds_read_b64_tr_b16 v[70:71], v14 offset:50880
    s_waitcnt lgkmcnt(8)
    v_mfma_f32_16x16x32_bf16 v[36:39], v[52:55], v[24:27], v[36:39]
    s_add_u32 s30, s22, 0
    s_add_u32 s29, s55, 1179648
    s_add_u32 m0, s30, 0
    s_mov_b64 exec, s[50:51]
    buffer_load_dwordx4 v10, s[8:11], s29 offen lds
    s_mov_b64 exec, -1
    v_add_u32 v18, s63, v14
    ds_read_b64_tr_b16 v[48:49], v18 offset:36864
    ds_read_b64_tr_b16 v[50:51], v18 offset:41472
    s_waitcnt lgkmcnt(8)
    v_mfma_f32_16x16x32_bf16 v[132:135], v[56:59], v[72:75], v[132:135]
    v_mfma_f32_16x16x32_bf16 v[204:207], v[56:59], v[76:79], v[204:207]
    s_add_u32 m0, s30, 768
    s_mov_b64 exec, s[50:51]
    buffer_load_dwordx4 v11, s[8:11], s29 offen lds
    s_mov_b64 exec, -1
    ds_read_b64_tr_b16 v[52:53], v14 offset:37088
    ds_read_b64_tr_b16 v[54:55], v14 offset:41696
    s_waitcnt lgkmcnt(8)
    v_mfma_f32_16x16x32_bf16 v[168:171], v[60:63], v[72:75], v[168:171]
    v_mfma_f32_16x16x32_bf16 v[240:243], v[60:63], v[76:79], v[240:243]
    s_add_u32 m0, s30, 1536
    s_mov_b64 exec, s[50:51]
    buffer_load_dwordx4 v12, s[8:11], s29 offen lds
    s_mov_b64 exec, -1
    ds_read_b64_tr_b16 v[56:57], v14 offset:46304
    ds_read_b64_tr_b16 v[58:59], v14 offset:50912
    s_waitcnt lgkmcnt(8)
    v_mfma_f32_16x16x32_bf16 v[136:139], v[64:67], v[72:75], v[136:139]
    v_mfma_f32_16x16x32_bf16 v[208:211], v[64:67], v[76:79], v[208:211]
    buffer_load_dwordx4 v[104:107], v3, s[12:15], s25 offen offset:1024 sc1
    ds_read_b64_tr_b16 v[60:61], v14 offset:37120
    ds_read_b64_tr_b16 v[62:63], v14 offset:41728
    s_waitcnt lgkmcnt(8)
    v_mfma_f32_16x16x32_bf16 v[172:175], v[68:71], v[72:75], v[172:175]
    v_mfma_f32_16x16x32_bf16 v[244:247], v[68:71], v[76:79], v[244:247]
    buffer_load_dwordx4 v[108:111], v3, s[12:15], s26 offen offset:1024 sc1
    ds_read_b64_tr_b16 v[64:65], v14 offset:46336
    ds_read_b64_tr_b16 v[66:67], v14 offset:50944
    s_waitcnt lgkmcnt(8)
    v_mfma_f32_16x16x32_bf16 v[40:43], v[48:51], v[24:27], v[40:43]
    v_add_u32 v17, s64, v14
    ds_read_b64_tr_b16 v[68:69], v17 offset:36864
    ds_read_b64_tr_b16 v[70:71], v17 offset:41472
    s_waitcnt lgkmcnt(8)
    v_mfma_f32_16x16x32_bf16 v[140:143], v[52:55], v[72:75], v[140:143]
    v_mfma_f32_16x16x32_bf16 v[212:215], v[52:55], v[76:79], v[212:215]
    ds_read_b64_tr_b16 v[48:49], v15 offset:0
    ds_read_b64_tr_b16 v[50:51], v15 offset:4608
    s_waitcnt lgkmcnt(8)
    v_mfma_f32_16x16x32_bf16 v[176:179], v[56:59], v[72:75], v[176:179]
    v_mfma_f32_16x16x32_bf16 v[248:251], v[56:59], v[76:79], v[248:251]
    ds_read_b64_tr_b16 v[52:53], v15 offset:9216
    ds_read_b64_tr_b16 v[54:55], v15 offset:13824
    s_waitcnt lgkmcnt(8)
    v_mfma_f32_16x16x32_bf16 v[144:147], v[60:63], v[72:75], v[144:147]
    v_mfma_f32_16x16x32_bf16 v[216:219], v[60:63], v[76:79], v[216:219]
    v_add_u32 v17, s60, v15
    ds_read_b64_tr_b16 v[56:57], v17 offset:0
    ds_read_b64_tr_b16 v[58:59], v17 offset:4608
    s_waitcnt lgkmcnt(8)
    v_mfma_f32_16x16x32_bf16 v[180:183], v[64:67], v[72:75], v[180:183]
    v_mfma_f32_16x16x32_bf16 v[252:255], v[64:67], v[76:79], v[252:255]
    ds_read_b64_tr_b16 v[60:61], v15 offset:32
    ds_read_b64_tr_b16 v[62:63], v15 offset:4640
    s_waitcnt lgkmcnt(8)
    v_mfma_f32_16x16x32_bf16 v[44:47], v[68:71], v[24:27], v[44:47]
    ds_read_b64_tr_b16 v[64:65], v15 offset:9248
    ds_read_b64_tr_b16 v[66:67], v15 offset:13856
    s_waitcnt lgkmcnt(8)
    v_mfma_f32_16x16x32_bf16 v[112:115], v[48:51], v[80:83], v[112:115]
    v_mfma_f32_16x16x32_bf16 v[184:187], v[48:51], v[84:87], v[184:187]
    ds_read_b64_tr_b16 v[68:69], v15 offset:64
    ds_read_b64_tr_b16 v[70:71], v15 offset:4672
    s_waitcnt lgkmcnt(8)
    v_mfma_f32_16x16x32_bf16 v[148:151], v[52:55], v[80:83], v[148:151]
    v_mfma_f32_16x16x32_bf16 v[220:223], v[52:55], v[84:87], v[220:223]
    v_add_u32 v16, v16, v19
    ds_read_b128 v[24:27], v16
    ds_read_b64_tr_b16 v[48:49], v15 offset:9280
    ds_read_b64_tr_b16 v[50:51], v15 offset:13888
    s_waitcnt lgkmcnt(8)
    v_mfma_f32_16x16x32_bf16 v[28:31], v[56:59], v[20:23], v[28:31]
    v_add_u32 v18, s61, v15
    ds_read_b64_tr_b16 v[52:53], v18 offset:0
    ds_read_b64_tr_b16 v[54:55], v18 offset:4608
    s_waitcnt lgkmcnt(8)
    v_mfma_f32_16x16x32_bf16 v[116:119], v[60:63], v[80:83], v[116:119]
    v_mfma_f32_16x16x32_bf16 v[188:191], v[60:63], v[84:87], v[188:191]
    ds_read_b64_tr_b16 v[56:57], v15 offset:96
    ds_read_b64_tr_b16 v[58:59], v15 offset:4704
    s_waitcnt lgkmcnt(8)
    v_mfma_f32_16x16x32_bf16 v[152:155], v[64:67], v[80:83], v[152:155]
    v_mfma_f32_16x16x32_bf16 v[224:227], v[64:67], v[84:87], v[224:227]
    ds_read_b64_tr_b16 v[60:61], v15 offset:9312
    ds_read_b64_tr_b16 v[62:63], v15 offset:13920
    s_waitcnt lgkmcnt(8)
    v_mfma_f32_16x16x32_bf16 v[120:123], v[68:71], v[80:83], v[120:123]
    v_mfma_f32_16x16x32_bf16 v[192:195], v[68:71], v[84:87], v[192:195]
    ds_read_b64_tr_b16 v[64:65], v15 offset:128
    ds_read_b64_tr_b16 v[66:67], v15 offset:4736
    s_waitcnt lgkmcnt(8)
    v_mfma_f32_16x16x32_bf16 v[156:159], v[48:51], v[80:83], v[156:159]
    v_mfma_f32_16x16x32_bf16 v[228:231], v[48:51], v[84:87], v[228:231]
    ds_read_b64_tr_b16 v[68:69], v15 offset:9344
    ds_read_b64_tr_b16 v[70:71], v15 offset:13952
    s_waitcnt lgkmcnt(8)
    v_mfma_f32_16x16x32_bf16 v[32:35], v[52:55], v[20:23], v[32:35]
    s_waitcnt vmcnt(7)
    s_barrier
    v_add_u32 v17, s62, v15
    ds_read_b64_tr_b16 v[48:49], v17 offset:0
    ds_read_b64_tr_b16 v[50:51], v17 offset:4608
    s_waitcnt lgkmcnt(8)
    v_mfma_f32_16x16x32_bf16 v[124:127], v[56:59], v[80:83], v[124:127]
    v_mfma_f32_16x16x32_bf16 v[196:199], v[56:59], v[84:87], v[196:199]
    ds_read_b64_tr_b16 v[52:53], v15 offset:160
    ds_read_b64_tr_b16 v[54:55], v15 offset:4768
    s_waitcnt lgkmcnt(8)
    v_mfma_f32_16x16x32_bf16 v[160:163], v[60:63], v[80:83], v[160:163]
    v_mfma_f32_16x16x32_bf16 v[232:235], v[60:63], v[84:87], v[232:235]
    ds_read_b64_tr_b16 v[56:57], v15 offset:9376
    ds_read_b64_tr_b16 v[58:59], v15 offset:13984
    s_waitcnt lgkmcnt(8)
    v_mfma_f32_16x16x32_bf16 v[128:131], v[64:67], v[80:83], v[128:131]
    v_mfma_f32_16x16x32_bf16 v[200:203], v[64:67], v[84:87], v[200:203]
    ds_read_b64_tr_b16 v[60:61], v15 offset:192
    ds_read_b64_tr_b16 v[62:63], v15 offset:4800
    s_waitcnt lgkmcnt(8)
    v_mfma_f32_16x16x32_bf16 v[164:167], v[68:71], v[80:83], v[164:167]
    v_mfma_f32_16x16x32_bf16 v[236:239], v[68:71], v[84:87], v[236:239]
    ds_read_b64_tr_b16 v[64:65], v15 offset:9408
    ds_read_b64_tr_b16 v[66:67], v15 offset:14016
    s_waitcnt lgkmcnt(8)
    v_mfma_f32_16x16x32_bf16 v[36:39], v[48:51], v[20:23], v[36:39]
    s_add_u32 s30, s22, 18432
    s_add_u32 s29, s54, 2654208
    s_add_u32 m0, s30, 0
    s_mov_b64 exec, s[50:51]
    buffer_load_dwordx4 v10, s[8:11], s29 offen lds
    s_mov_b64 exec, -1
    v_add_u32 v18, s63, v15
    ds_read_b64_tr_b16 v[68:69], v18 offset:0
    ds_read_b64_tr_b16 v[70:71], v18 offset:4608
    s_waitcnt lgkmcnt(8)
    v_mfma_f32_16x16x32_bf16 v[132:135], v[52:55], v[80:83], v[132:135]
    v_mfma_f32_16x16x32_bf16 v[204:207], v[52:55], v[84:87], v[204:207]
    s_add_u32 m0, s30, 768
    s_mov_b64 exec, s[50:51]
    buffer_load_dwordx4 v11, s[8:11], s29 offen lds
    s_mov_b64 exec, -1
    ds_read_b64_tr_b16 v[48:49], v15 offset:224
    ds_read_b64_tr_b16 v[50:51], v15 offset:4832
    s_waitcnt lgkmcnt(8)
    v_mfma_f32_16x16x32_bf16 v[168:171], v[56:59], v[80:83], v[168:171]
    v_mfma_f32_16x16x32_bf16 v[240:243], v[56:59], v[84:87], v[240:243]
    s_add_u32 m0, s30, 1536
    s_mov_b64 exec, s[50:51]
    buffer_load_dwordx4 v12, s[8:11], s29 offen lds
    s_mov_b64 exec, -1
    ds_read_b64_tr_b16 v[52:53], v15 offset:9440
    ds_read_b64_tr_b16 v[54:55], v15 offset:14048
    s_waitcnt lgkmcnt(8)
    v_mfma_f32_16x16x32_bf16 v[136:139], v[60:63], v[80:83], v[136:139]
    v_mfma_f32_16x16x32_bf16 v[208:211], v[60:63], v[84:87], v[208:211]
    buffer_load_dwordx4 v[72:75], v3, s[12:15], s25 offen offset:2048 sc1
    ds_read_b64_tr_b16 v[56:57], v15 offset:256
    ds_read_b64_tr_b16 v[58:59], v15 offset:4864
    s_waitcnt lgkmcnt(8)
    v_mfma_f32_16x16x32_bf16 v[172:175], v[64:67], v[80:83], v[172:175]
    v_mfma_f32_16x16x32_bf16 v[244:247], v[64:67], v[84:87], v[244:247]
    buffer_load_dwordx4 v[76:79], v3, s[12:15], s26 offen offset:2048 sc1
    ds_read_b64_tr_b16 v[60:61], v15 offset:9472
    ds_read_b64_tr_b16 v[62:63], v15 offset:14080
    s_waitcnt lgkmcnt(8)
    v_mfma_f32_16x16x32_bf16 v[40:43], v[68:71], v[20:23], v[40:43]
    v_add_u32 v17, s64, v15
    ds_read_b64_tr_b16 v[64:65], v17 offset:0
    ds_read_b64_tr_b16 v[66:67], v17 offset:4608
    s_waitcnt lgkmcnt(8)
    v_mfma_f32_16x16x32_bf16 v[140:143], v[48:51], v[80:83], v[140:143]
    v_mfma_f32_16x16x32_bf16 v[212:215], v[48:51], v[84:87], v[212:215]
    ds_read_b64_tr_b16 v[68:69], v15 offset:18432
    ds_read_b64_tr_b16 v[70:71], v15 offset:23040
    s_waitcnt lgkmcnt(8)
    v_mfma_f32_16x16x32_bf16 v[176:179], v[52:55], v[80:83], v[176:179]
    v_mfma_f32_16x16x32_bf16 v[248:251], v[52:55], v[84:87], v[248:251]
    ds_read_b64_tr_b16 v[48:49], v15 offset:27648
    ds_read_b64_tr_b16 v[50:51], v15 offset:32256
    s_waitcnt lgkmcnt(8)
    v_mfma_f32_16x16x32_bf16 v[144:147], v[56:59], v[80:83], v[144:147]
    v_mfma_f32_16x16x32_bf16 v[216:219], v[56:59], v[84:87], v[216:219]
    v_add_u32 v17, s60, v15
    ds_read_b64_tr_b16 v[52:53], v17 offset:18432
    ds_read_b64_tr_b16 v[54:55], v17 offset:23040
    s_waitcnt lgkmcnt(8)
    v_mfma_f32_16x16x32_bf16 v[180:183], v[60:63], v[80:83], v[180:183]
    v_mfma_f32_16x16x32_bf16 v[252:255], v[60:63], v[84:87], v[252:255]
    ds_read_b64_tr_b16 v[56:57], v15 offset:18464
    ds_read_b64_tr_b16 v[58:59], v15 offset:23072
    s_waitcnt lgkmcnt(8)
    v_mfma_f32_16x16x32_bf16 v[44:47], v[64:67], v[20:23], v[44:47]
    ds_read_b64_tr_b16 v[60:61], v15 offset:27680
    ds_read_b64_tr_b16 v[62:63], v15 offset:32288
    s_waitcnt lgkmcnt(8)
    v_mfma_f32_16x16x32_bf16 v[112:115], v[68:71], v[88:91], v[112:115]
    v_mfma_f32_16x16x32_bf16 v[184:187], v[68:71], v[92:95], v[184:187]
    ds_read_b64_tr_b16 v[64:65], v15 offset:18496
    ds_read_b64_tr_b16 v[66:67], v15 offset:23104
    s_waitcnt lgkmcnt(8)
    v_mfma_f32_16x16x32_bf16 v[148:151], v[48:51], v[88:91], v[148:151]
    v_mfma_f32_16x16x32_bf16 v[220:223], v[48:51], v[92:95], v[220:223]
    v_add_u32 v16, v16, v19
    ds_read_b128 v[20:23], v16
    ds_read_b64_tr_b16 v[68:69], v15 offset:27712
    ds_read_b64_tr_b16 v[70:71], v15 offset:32320
    s_waitcnt lgkmcnt(8)
    v_mfma_f32_16x16x32_bf16 v[28:31], v[52:55], v[24:27], v[28:31]
    v_add_u32 v18, s61, v15
    ds_read_b64_tr_b16 v[48:49], v18 offset:18432
    ds_read_b64_tr_b16 v[50:51], v18 offset:23040
    s_waitcnt lgkmcnt(8)
    v_mfma_f32_16x16x32_bf16 v[116:119], v[56:59], v[88:91], v[116:119]
    v_mfma_f32_16x16x32_bf16 v[188:191], v[56:59], v[92:95], v[188:191]
    ds_read_b64_tr_b16 v[52:53], v15 offset:18528
    ds_read_b64_tr_b16 v[54:55], v15 offset:23136
    s_waitcnt lgkmcnt(8)
    v_mfma_f32_16x16x32_bf16 v[152:155], v[60:63], v[88:91], v[152:155]
    v_mfma_f32_16x16x32_bf16 v[224:227], v[60:63], v[92:95], v[224:227]
    ds_read_b64_tr_b16 v[56:57], v15 offset:27744
    ds_read_b64_tr_b16 v[58:59], v15 offset:32352
    s_waitcnt lgkmcnt(8)
    v_mfma_f32_16x16x32_bf16 v[120:123], v[64:67], v[88:91], v[120:123]
    v_mfma_f32_16x16x32_bf16 v[192:195], v[64:67], v[92:95], v[192:195]
    ds_read_b64_tr_b16 v[60:61], v15 offset:18560
    ds_read_b64_tr_b16 v[62:63], v15 offset:23168
    s_waitcnt lgkmcnt(8)
    v_mfma_f32_16x16x32_bf16 v[156:159], v[68:71], v[88:91], v[156:159]
    v_mfma_f32_16x16x32_bf16 v[228:231], v[68:71], v[92:95], v[228:231]
    ds_read_b64_tr_b16 v[64:65], v15 offset:27776
    ds_read_b64_tr_b16 v[66:67], v15 offset:32384
    s_waitcnt lgkmcnt(8)
    v_mfma_f32_16x16x32_bf16 v[32:35], v[48:51], v[24:27], v[32:35]
    s_waitcnt vmcnt(7)
    s_barrier
    v_add_u32 v17, s62, v15
    ds_read_b64_tr_b16 v[68:69], v17 offset:18432
    ds_read_b64_tr_b16 v[70:71], v17 offset:23040
    s_waitcnt lgkmcnt(8)
    v_mfma_f32_16x16x32_bf16 v[124:127], v[52:55], v[88:91], v[124:127]
    v_mfma_f32_16x16x32_bf16 v[196:199], v[52:55], v[92:95], v[196:199]
    ds_read_b64_tr_b16 v[48:49], v15 offset:18592
    ds_read_b64_tr_b16 v[50:51], v15 offset:23200
    s_waitcnt lgkmcnt(8)
    v_mfma_f32_16x16x32_bf16 v[160:163], v[56:59], v[88:91], v[160:163]
    v_mfma_f32_16x16x32_bf16 v[232:235], v[56:59], v[92:95], v[232:235]
    ds_read_b64_tr_b16 v[52:53], v15 offset:27808
    ds_read_b64_tr_b16 v[54:55], v15 offset:32416
    s_waitcnt lgkmcnt(8)
    v_mfma_f32_16x16x32_bf16 v[128:131], v[60:63], v[88:91], v[128:131]
    v_mfma_f32_16x16x32_bf16 v[200:203], v[60:63], v[92:95], v[200:203]
    ds_read_b64_tr_b16 v[56:57], v15 offset:18624
    ds_read_b64_tr_b16 v[58:59], v15 offset:23232
    s_waitcnt lgkmcnt(8)
    v_mfma_f32_16x16x32_bf16 v[164:167], v[64:67], v[88:91], v[164:167]
    v_mfma_f32_16x16x32_bf16 v[236:239], v[64:67], v[92:95], v[236:239]
    ds_read_b64_tr_b16 v[60:61], v15 offset:27840
    ds_read_b64_tr_b16 v[62:63], v15 offset:32448
    s_waitcnt lgkmcnt(8)
    v_mfma_f32_16x16x32_bf16 v[36:39], v[68:71], v[24:27], v[36:39]
    s_add_u32 s30, s22, 36864
    s_add_u32 s29, s54, 2949120
    s_add_u32 m0, s30, 0
    s_mov_b64 exec, s[50:51]
    buffer_load_dwordx4 v10, s[8:11], s29 offen lds
    s_mov_b64 exec, -1
    v_add_u32 v18, s63, v15
    ds_read_b64_tr_b16 v[64:65], v18 offset:18432
    ds_read_b64_tr_b16 v[66:67], v18 offset:23040
    s_waitcnt lgkmcnt(8)
    v_mfma_f32_16x16x32_bf16 v[132:135], v[48:51], v[88:91], v[132:135]
    v_mfma_f32_16x16x32_bf16 v[204:207], v[48:51], v[92:95], v[204:207]
    s_add_u32 m0, s30, 768
    s_mov_b64 exec, s[50:51]
    buffer_load_dwordx4 v11, s[8:11], s29 offen lds
    s_mov_b64 exec, -1
    ds_read_b64_tr_b16 v[68:69], v15 offset:18656
    ds_read_b64_tr_b16 v[70:71], v15 offset:23264
    s_waitcnt lgkmcnt(8)
    v_mfma_f32_16x16x32_bf16 v[168:171], v[52:55], v[88:91], v[168:171]
    v_mfma_f32_16x16x32_bf16 v[240:243], v[52:55], v[92:95], v[240:243]
    s_add_u32 m0, s30, 1536
    s_mov_b64 exec, s[50:51]
    buffer_load_dwordx4 v12, s[8:11], s29 offen lds
    s_mov_b64 exec, -1
    ds_read_b64_tr_b16 v[48:49], v15 offset:27872
    ds_read_b64_tr_b16 v[50:51], v15 offset:32480
    s_waitcnt lgkmcnt(8)
    v_mfma_f32_16x16x32_bf16 v[136:139], v[56:59], v[88:91], v[136:139]
    v_mfma_f32_16x16x32_bf16 v[208:211], v[56:59], v[92:95], v[208:211]
    buffer_load_dwordx4 v[80:83], v3, s[12:15], s25 offen offset:3072 sc1
    ds_read_b64_tr_b16 v[52:53], v15 offset:18688
    ds_read_b64_tr_b16 v[54:55], v15 offset:23296
    s_waitcnt lgkmcnt(8)
    v_mfma_f32_16x16x32_bf16 v[172:175], v[60:63], v[88:91], v[172:175]
    v_mfma_f32_16x16x32_bf16 v[244:247], v[60:63], v[92:95], v[244:247]
    buffer_load_dwordx4 v[84:87], v3, s[12:15], s26 offen offset:3072 sc1
    ds_read_b64_tr_b16 v[56:57], v15 offset:27904
    ds_read_b64_tr_b16 v[58:59], v15 offset:32512
    s_waitcnt lgkmcnt(8)
    v_mfma_f32_16x16x32_bf16 v[40:43], v[64:67], v[24:27], v[40:43]
    v_add_u32 v17, s64, v15
    ds_read_b64_tr_b16 v[60:61], v17 offset:18432
    ds_read_b64_tr_b16 v[62:63], v17 offset:23040
    s_waitcnt lgkmcnt(8)
    v_mfma_f32_16x16x32_bf16 v[140:143], v[68:71], v[88:91], v[140:143]
    v_mfma_f32_16x16x32_bf16 v[212:215], v[68:71], v[92:95], v[212:215]
    ds_read_b64_tr_b16 v[64:65], v13 offset:0
    ds_read_b64_tr_b16 v[66:67], v13 offset:4608
    s_waitcnt lgkmcnt(8)
    v_mfma_f32_16x16x32_bf16 v[176:179], v[48:51], v[88:91], v[176:179]
    v_mfma_f32_16x16x32_bf16 v[248:251], v[48:51], v[92:95], v[248:251]
    ds_read_b64_tr_b16 v[68:69], v13 offset:9216
    ds_read_b64_tr_b16 v[70:71], v13 offset:13824
    s_waitcnt lgkmcnt(8)
    v_mfma_f32_16x16x32_bf16 v[144:147], v[52:55], v[88:91], v[144:147]
    v_mfma_f32_16x16x32_bf16 v[216:219], v[52:55], v[92:95], v[216:219]
    v_add_u32 v17, s60, v13
    ds_read_b64_tr_b16 v[48:49], v17 offset:0
    ds_read_b64_tr_b16 v[50:51], v17 offset:4608
    s_waitcnt lgkmcnt(8)
    v_mfma_f32_16x16x32_bf16 v[180:183], v[56:59], v[88:91], v[180:183]
    v_mfma_f32_16x16x32_bf16 v[252:255], v[56:59], v[92:95], v[252:255]
    ds_read_b64_tr_b16 v[52:53], v13 offset:32
    ds_read_b64_tr_b16 v[54:55], v13 offset:4640
    s_waitcnt lgkmcnt(8)
    v_mfma_f32_16x16x32_bf16 v[44:47], v[60:63], v[24:27], v[44:47]
    ds_read_b64_tr_b16 v[56:57], v13 offset:9248
    ds_read_b64_tr_b16 v[58:59], v13 offset:13856
    s_waitcnt lgkmcnt(8)
    v_mfma_f32_16x16x32_bf16 v[112:115], v[64:67], v[96:99], v[112:115]
    v_mfma_f32_16x16x32_bf16 v[184:187], v[64:67], v[100:103], v[184:187]
    ds_read_b64_tr_b16 v[60:61], v13 offset:64
    ds_read_b64_tr_b16 v[62:63], v13 offset:4672
    s_waitcnt lgkmcnt(8)
    v_mfma_f32_16x16x32_bf16 v[148:151], v[68:71], v[96:99], v[148:151]
    v_mfma_f32_16x16x32_bf16 v[220:223], v[68:71], v[100:103], v[220:223]
    v_add_u32 v16, v16, v19
    ds_read_b128 v[24:27], v16
    ds_read_b64_tr_b16 v[64:65], v13 offset:9280
    ds_read_b64_tr_b16 v[66:67], v13 offset:13888
    s_waitcnt lgkmcnt(8)
    v_mfma_f32_16x16x32_bf16 v[28:31], v[48:51], v[20:23], v[28:31]
    v_add_u32 v18, s61, v13
    ds_read_b64_tr_b16 v[68:69], v18 offset:0
    ds_read_b64_tr_b16 v[70:71], v18 offset:4608
    s_waitcnt lgkmcnt(8)
    v_mfma_f32_16x16x32_bf16 v[116:119], v[52:55], v[96:99], v[116:119]
    v_mfma_f32_16x16x32_bf16 v[188:191], v[52:55], v[100:103], v[188:191]
    ds_read_b64_tr_b16 v[48:49], v13 offset:96
    ds_read_b64_tr_b16 v[50:51], v13 offset:4704
    s_waitcnt lgkmcnt(8)
    v_mfma_f32_16x16x32_bf16 v[152:155], v[56:59], v[96:99], v[152:155]
    v_mfma_f32_16x16x32_bf16 v[224:227], v[56:59], v[100:103], v[224:227]
    ds_read_b64_tr_b16 v[52:53], v13 offset:9312
    ds_read_b64_tr_b16 v[54:55], v13 offset:13920
    s_waitcnt lgkmcnt(8)
    v_mfma_f32_16x16x32_bf16 v[120:123], v[60:63], v[96:99], v[120:123]
    v_mfma_f32_16x16x32_bf16 v[192:195], v[60:63], v[100:103], v[192:195]
    ds_read_b64_tr_b16 v[56:57], v13 offset:128
    ds_read_b64_tr_b16 v[58:59], v13 offset:4736
    s_waitcnt lgkmcnt(8)
    v_mfma_f32_16x16x32_bf16 v[156:159], v[64:67], v[96:99], v[156:159]
    v_mfma_f32_16x16x32_bf16 v[228:231], v[64:67], v[100:103], v[228:231]
    ds_read_b64_tr_b16 v[60:61], v13 offset:9344
    ds_read_b64_tr_b16 v[62:63], v13 offset:13952
    s_waitcnt lgkmcnt(8)
    v_mfma_f32_16x16x32_bf16 v[32:35], v[68:71], v[20:23], v[32:35]
    s_waitcnt vmcnt(7)
    s_barrier
    v_add_u32 v17, s62, v13
    ds_read_b64_tr_b16 v[64:65], v17 offset:0
    ds_read_b64_tr_b16 v[66:67], v17 offset:4608
    s_waitcnt lgkmcnt(8)
    v_mfma_f32_16x16x32_bf16 v[124:127], v[48:51], v[96:99], v[124:127]
    v_mfma_f32_16x16x32_bf16 v[196:199], v[48:51], v[100:103], v[196:199]
    ds_read_b64_tr_b16 v[68:69], v13 offset:160
    ds_read_b64_tr_b16 v[70:71], v13 offset:4768
    s_waitcnt lgkmcnt(8)
    v_mfma_f32_16x16x32_bf16 v[160:163], v[52:55], v[96:99], v[160:163]
    v_mfma_f32_16x16x32_bf16 v[232:235], v[52:55], v[100:103], v[232:235]
    ds_read_b64_tr_b16 v[48:49], v13 offset:9376
    ds_read_b64_tr_b16 v[50:51], v13 offset:13984
    s_waitcnt lgkmcnt(8)
    v_mfma_f32_16x16x32_bf16 v[128:131], v[56:59], v[96:99], v[128:131]
    v_mfma_f32_16x16x32_bf16 v[200:203], v[56:59], v[100:103], v[200:203]
    ds_read_b64_tr_b16 v[52:53], v13 offset:192
    ds_read_b64_tr_b16 v[54:55], v13 offset:4800
    s_waitcnt lgkmcnt(8)
    v_mfma_f32_16x16x32_bf16 v[164:167], v[60:63], v[96:99], v[164:167]
    v_mfma_f32_16x16x32_bf16 v[236:239], v[60:63], v[100:103], v[236:239]
    ds_read_b64_tr_b16 v[56:57], v13 offset:9408
    ds_read_b64_tr_b16 v[58:59], v13 offset:14016
    s_waitcnt lgkmcnt(8)
    v_mfma_f32_16x16x32_bf16 v[36:39], v[64:67], v[20:23], v[36:39]
    s_add_u32 s30, s22, 55296
    s_add_u32 s29, s54, 3244032
    s_add_u32 m0, s30, 0
    s_mov_b64 exec, s[50:51]
    buffer_load_dwordx4 v10, s[8:11], s29 offen lds
    s_mov_b64 exec, -1
    v_add_u32 v18, s63, v13
    ds_read_b64_tr_b16 v[60:61], v18 offset:0
    ds_read_b64_tr_b16 v[62:63], v18 offset:4608
    s_waitcnt lgkmcnt(8)
    v_mfma_f32_16x16x32_bf16 v[132:135], v[68:71], v[96:99], v[132:135]
    v_mfma_f32_16x16x32_bf16 v[204:207], v[68:71], v[100:103], v[204:207]
    s_add_u32 m0, s30, 768
    s_mov_b64 exec, s[50:51]
    buffer_load_dwordx4 v11, s[8:11], s29 offen lds
    s_mov_b64 exec, -1
    ds_read_b64_tr_b16 v[64:65], v13 offset:224
    ds_read_b64_tr_b16 v[66:67], v13 offset:4832
    s_waitcnt lgkmcnt(8)
    v_mfma_f32_16x16x32_bf16 v[168:171], v[48:51], v[96:99], v[168:171]
    v_mfma_f32_16x16x32_bf16 v[240:243], v[48:51], v[100:103], v[240:243]
    s_add_u32 m0, s30, 1536
    s_mov_b64 exec, s[50:51]
    buffer_load_dwordx4 v12, s[8:11], s29 offen lds
    s_mov_b64 exec, -1
    ds_read_b64_tr_b16 v[68:69], v13 offset:9440
    ds_read_b64_tr_b16 v[70:71], v13 offset:14048
    s_waitcnt lgkmcnt(8)
    v_mfma_f32_16x16x32_bf16 v[136:139], v[52:55], v[96:99], v[136:139]
    v_mfma_f32_16x16x32_bf16 v[208:211], v[52:55], v[100:103], v[208:211]
    s_add_u32 s25, s25, 4096
    s_add_u32 s26, s26, 4096
    buffer_load_dwordx4 v[88:91], v3, s[12:15], s25 offen offset:0 sc1
    ds_read_b64_tr_b16 v[48:49], v13 offset:256
    ds_read_b64_tr_b16 v[50:51], v13 offset:4864
    s_waitcnt lgkmcnt(8)
    v_mfma_f32_16x16x32_bf16 v[172:175], v[56:59], v[96:99], v[172:175]
    v_mfma_f32_16x16x32_bf16 v[244:247], v[56:59], v[100:103], v[244:247]
    buffer_load_dwordx4 v[92:95], v3, s[12:15], s26 offen offset:0 sc1
    ds_read_b64_tr_b16 v[52:53], v13 offset:9472
    ds_read_b64_tr_b16 v[54:55], v13 offset:14080
    s_waitcnt lgkmcnt(8)
    v_mfma_f32_16x16x32_bf16 v[40:43], v[60:63], v[20:23], v[40:43]
    v_add_u32 v17, s64, v13
    ds_read_b64_tr_b16 v[56:57], v17 offset:0
    ds_read_b64_tr_b16 v[58:59], v17 offset:4608
    s_waitcnt lgkmcnt(8)
    v_mfma_f32_16x16x32_bf16 v[140:143], v[64:67], v[96:99], v[140:143]
    v_mfma_f32_16x16x32_bf16 v[212:215], v[64:67], v[100:103], v[212:215]
    ds_read_b64_tr_b16 v[60:61], v13 offset:18432
    ds_read_b64_tr_b16 v[62:63], v13 offset:23040
    s_waitcnt lgkmcnt(8)
    v_mfma_f32_16x16x32_bf16 v[176:179], v[68:71], v[96:99], v[176:179]
    v_mfma_f32_16x16x32_bf16 v[248:251], v[68:71], v[100:103], v[248:251]
    ds_read_b64_tr_b16 v[64:65], v13 offset:27648
    ds_read_b64_tr_b16 v[66:67], v13 offset:32256
    s_waitcnt lgkmcnt(8)
    v_mfma_f32_16x16x32_bf16 v[144:147], v[48:51], v[96:99], v[144:147]
    v_mfma_f32_16x16x32_bf16 v[216:219], v[48:51], v[100:103], v[216:219]
    v_add_u32 v17, s60, v13
    ds_read_b64_tr_b16 v[68:69], v17 offset:18432
    ds_read_b64_tr_b16 v[70:71], v17 offset:23040
    s_waitcnt lgkmcnt(8)
    v_mfma_f32_16x16x32_bf16 v[180:183], v[52:55], v[96:99], v[180:183]
    v_mfma_f32_16x16x32_bf16 v[252:255], v[52:55], v[100:103], v[252:255]
    ds_read_b64_tr_b16 v[48:49], v13 offset:18464
    ds_read_b64_tr_b16 v[50:51], v13 offset:23072
    s_waitcnt lgkmcnt(8)
    v_mfma_f32_16x16x32_bf16 v[44:47], v[56:59], v[20:23], v[44:47]
    ds_read_b64_tr_b16 v[52:53], v13 offset:27680
    ds_read_b64_tr_b16 v[54:55], v13 offset:32288
    s_waitcnt lgkmcnt(8)
    v_mfma_f32_16x16x32_bf16 v[112:115], v[60:63], v[104:107], v[112:115]
    v_mfma_f32_16x16x32_bf16 v[184:187], v[60:63], v[108:111], v[184:187]
    ds_read_b64_tr_b16 v[56:57], v13 offset:18496
    ds_read_b64_tr_b16 v[58:59], v13 offset:23104
    s_waitcnt lgkmcnt(8)
    v_mfma_f32_16x16x32_bf16 v[148:151], v[64:67], v[104:107], v[148:151]
    v_mfma_f32_16x16x32_bf16 v[220:223], v[64:67], v[108:111], v[220:223]
    v_add_u32 v16, v16, v19
    ds_read_b128 v[20:23], v16
    ds_read_b64_tr_b16 v[60:61], v13 offset:27712
    ds_read_b64_tr_b16 v[62:63], v13 offset:32320
    s_waitcnt lgkmcnt(8)
    v_mfma_f32_16x16x32_bf16 v[28:31], v[68:71], v[24:27], v[28:31]
    v_add_u32 v18, s61, v13
    ds_read_b64_tr_b16 v[64:65], v18 offset:18432
    ds_read_b64_tr_b16 v[66:67], v18 offset:23040
    s_waitcnt lgkmcnt(8)
    v_mfma_f32_16x16x32_bf16 v[116:119], v[48:51], v[104:107], v[116:119]
    v_mfma_f32_16x16x32_bf16 v[188:191], v[48:51], v[108:111], v[188:191]
    ds_read_b64_tr_b16 v[68:69], v13 offset:18528
    ds_read_b64_tr_b16 v[70:71], v13 offset:23136
    s_waitcnt lgkmcnt(8)
    v_mfma_f32_16x16x32_bf16 v[152:155], v[52:55], v[104:107], v[152:155]
    v_mfma_f32_16x16x32_bf16 v[224:227], v[52:55], v[108:111], v[224:227]
    ds_read_b64_tr_b16 v[48:49], v13 offset:27744
    ds_read_b64_tr_b16 v[50:51], v13 offset:32352
    s_waitcnt lgkmcnt(8)
    v_mfma_f32_16x16x32_bf16 v[120:123], v[56:59], v[104:107], v[120:123]
    v_mfma_f32_16x16x32_bf16 v[192:195], v[56:59], v[108:111], v[192:195]
    ds_read_b64_tr_b16 v[52:53], v13 offset:18560
    ds_read_b64_tr_b16 v[54:55], v13 offset:23168
    s_waitcnt lgkmcnt(8)
    v_mfma_f32_16x16x32_bf16 v[156:159], v[60:63], v[104:107], v[156:159]
    v_mfma_f32_16x16x32_bf16 v[228:231], v[60:63], v[108:111], v[228:231]
    ds_read_b64_tr_b16 v[56:57], v13 offset:27776
    ds_read_b64_tr_b16 v[58:59], v13 offset:32384
    s_waitcnt lgkmcnt(8)
    v_mfma_f32_16x16x32_bf16 v[32:35], v[64:67], v[24:27], v[32:35]
    s_waitcnt vmcnt(7)
    s_barrier
    v_add_u32 v17, s62, v13
    ds_read_b64_tr_b16 v[60:61], v17 offset:18432
    ds_read_b64_tr_b16 v[62:63], v17 offset:23040
    s_waitcnt lgkmcnt(8)
    v_mfma_f32_16x16x32_bf16 v[124:127], v[68:71], v[104:107], v[124:127]
    v_mfma_f32_16x16x32_bf16 v[196:199], v[68:71], v[108:111], v[196:199]
    ds_read_b64_tr_b16 v[64:65], v13 offset:18592
    ds_read_b64_tr_b16 v[66:67], v13 offset:23200
    s_waitcnt lgkmcnt(8)
    v_mfma_f32_16x16x32_bf16 v[160:163], v[48:51], v[104:107], v[160:163]
    v_mfma_f32_16x16x32_bf16 v[232:235], v[48:51], v[108:111], v[232:235]
    ds_read_b64_tr_b16 v[68:69], v13 offset:27808
    ds_read_b64_tr_b16 v[70:71], v13 offset:32416
    s_waitcnt lgkmcnt(8)
    v_mfma_f32_16x16x32_bf16 v[128:131], v[52:55], v[104:107], v[128:131]
    v_mfma_f32_16x16x32_bf16 v[200:203], v[52:55], v[108:111], v[200:203]
    ds_read_b64_tr_b16 v[48:49], v13 offset:18624
    ds_read_b64_tr_b16 v[50:51], v13 offset:23232
    s_waitcnt lgkmcnt(8)
    v_mfma_f32_16x16x32_bf16 v[164:167], v[56:59], v[104:107], v[164:167]
    v_mfma_f32_16x16x32_bf16 v[236:239], v[56:59], v[108:111], v[236:239]
    ds_read_b64_tr_b16 v[52:53], v13 offset:27840
    ds_read_b64_tr_b16 v[54:55], v13 offset:32448
    s_waitcnt lgkmcnt(8)
    v_mfma_f32_16x16x32_bf16 v[36:39], v[60:63], v[24:27], v[36:39]
    s_add_u32 s30, s22, 73728
    s_add_u32 s29, s54, 3538944
    s_add_u32 m0, s30, 0
    s_mov_b64 exec, s[50:51]
    buffer_load_dwordx4 v10, s[8:11], s29 offen lds
    s_mov_b64 exec, -1
    v_add_u32 v18, s63, v13
    ds_read_b64_tr_b16 v[56:57], v18 offset:18432
    ds_read_b64_tr_b16 v[58:59], v18 offset:23040
    s_waitcnt lgkmcnt(8)
    v_mfma_f32_16x16x32_bf16 v[132:135], v[64:67], v[104:107], v[132:135]
    v_mfma_f32_16x16x32_bf16 v[204:207], v[64:67], v[108:111], v[204:207]
    s_add_u32 m0, s30, 768
    s_mov_b64 exec, s[50:51]
    buffer_load_dwordx4 v11, s[8:11], s29 offen lds
    s_mov_b64 exec, -1
    ds_read_b64_tr_b16 v[60:61], v13 offset:18656
    ds_read_b64_tr_b16 v[62:63], v13 offset:23264
    s_waitcnt lgkmcnt(8)
    v_mfma_f32_16x16x32_bf16 v[168:171], v[68:71], v[104:107], v[168:171]
    v_mfma_f32_16x16x32_bf16 v[240:243], v[68:71], v[108:111], v[240:243]
    s_add_u32 m0, s30, 1536
    s_mov_b64 exec, s[50:51]
    buffer_load_dwordx4 v12, s[8:11], s29 offen lds
    s_mov_b64 exec, -1
    ds_read_b64_tr_b16 v[64:65], v13 offset:27872
    ds_read_b64_tr_b16 v[66:67], v13 offset:32480
    s_waitcnt lgkmcnt(8)
    v_mfma_f32_16x16x32_bf16 v[136:139], v[48:51], v[104:107], v[136:139]
    v_mfma_f32_16x16x32_bf16 v[208:211], v[48:51], v[108:111], v[208:211]
    buffer_load_dwordx4 v[96:99], v3, s[12:15], s25 offen offset:1024 sc1
    ds_read_b64_tr_b16 v[68:69], v13 offset:18688
    ds_read_b64_tr_b16 v[70:71], v13 offset:23296
    s_waitcnt lgkmcnt(8)
    v_mfma_f32_16x16x32_bf16 v[172:175], v[52:55], v[104:107], v[172:175]
    v_mfma_f32_16x16x32_bf16 v[244:247], v[52:55], v[108:111], v[244:247]
    buffer_load_dwordx4 v[100:103], v3, s[12:15], s26 offen offset:1024 sc1
    ds_read_b64_tr_b16 v[48:49], v13 offset:27904
    ds_read_b64_tr_b16 v[50:51], v13 offset:32512
    s_waitcnt lgkmcnt(8)
    v_mfma_f32_16x16x32_bf16 v[40:43], v[56:59], v[24:27], v[40:43]
    v_add_u32 v17, s64, v13
    ds_read_b64_tr_b16 v[52:53], v17 offset:18432
    ds_read_b64_tr_b16 v[54:55], v17 offset:23040
    s_waitcnt lgkmcnt(8)
    v_mfma_f32_16x16x32_bf16 v[140:143], v[60:63], v[104:107], v[140:143]
    v_mfma_f32_16x16x32_bf16 v[212:215], v[60:63], v[108:111], v[212:215]
    ds_read_b64_tr_b16 v[56:57], v13 offset:36864
    ds_read_b64_tr_b16 v[58:59], v13 offset:41472
    s_waitcnt lgkmcnt(8)
    v_mfma_f32_16x16x32_bf16 v[176:179], v[64:67], v[104:107], v[176:179]
    v_mfma_f32_16x16x32_bf16 v[248:251], v[64:67], v[108:111], v[248:251]
    ds_read_b64_tr_b16 v[60:61], v13 offset:46080
    ds_read_b64_tr_b16 v[62:63], v13 offset:50688
    s_waitcnt lgkmcnt(8)
    v_mfma_f32_16x16x32_bf16 v[144:147], v[68:71], v[104:107], v[144:147]
    v_mfma_f32_16x16x32_bf16 v[216:219], v[68:71], v[108:111], v[216:219]
    v_add_u32 v17, s60, v13
    ds_read_b64_tr_b16 v[64:65], v17 offset:36864
    ds_read_b64_tr_b16 v[66:67], v17 offset:41472
    s_waitcnt lgkmcnt(8)
    v_mfma_f32_16x16x32_bf16 v[180:183], v[48:51], v[104:107], v[180:183]
    v_mfma_f32_16x16x32_bf16 v[252:255], v[48:51], v[108:111], v[252:255]
    ds_read_b64_tr_b16 v[68:69], v13 offset:36896
    ds_read_b64_tr_b16 v[70:71], v13 offset:41504
    s_waitcnt lgkmcnt(8)
    v_mfma_f32_16x16x32_bf16 v[44:47], v[52:55], v[24:27], v[44:47]
    ds_read_b64_tr_b16 v[48:49], v13 offset:46112
    ds_read_b64_tr_b16 v[50:51], v13 offset:50720
    s_waitcnt lgkmcnt(8)
    v_mfma_f32_16x16x32_bf16 v[112:115], v[56:59], v[72:75], v[112:115]
    v_mfma_f32_16x16x32_bf16 v[184:187], v[56:59], v[76:79], v[184:187]
    ds_read_b64_tr_b16 v[52:53], v13 offset:36928
    ds_read_b64_tr_b16 v[54:55], v13 offset:41536
    s_waitcnt lgkmcnt(8)
    v_mfma_f32_16x16x32_bf16 v[148:151], v[60:63], v[72:75], v[148:151]
    v_mfma_f32_16x16x32_bf16 v[220:223], v[60:63], v[76:79], v[220:223]
    v_add_u32 v16, v16, v19
    ds_read_b128 v[24:27], v16
    ds_read_b64_tr_b16 v[56:57], v13 offset:46144
    ds_read_b64_tr_b16 v[58:59], v13 offset:50752
    s_waitcnt lgkmcnt(8)
    v_mfma_f32_16x16x32_bf16 v[28:31], v[64:67], v[20:23], v[28:31]
    v_add_u32 v18, s61, v13
    ds_read_b64_tr_b16 v[60:61], v18 offset:36864
    ds_read_b64_tr_b16 v[62:63], v18 offset:41472
    s_waitcnt lgkmcnt(8)
    v_mfma_f32_16x16x32_bf16 v[116:119], v[68:71], v[72:75], v[116:119]
    v_mfma_f32_16x16x32_bf16 v[188:191], v[68:71], v[76:79], v[188:191]
    ds_read_b64_tr_b16 v[64:65], v13 offset:36960
    ds_read_b64_tr_b16 v[66:67], v13 offset:41568
    s_waitcnt lgkmcnt(8)
    v_mfma_f32_16x16x32_bf16 v[152:155], v[48:51], v[72:75], v[152:155]
    v_mfma_f32_16x16x32_bf16 v[224:227], v[48:51], v[76:79], v[224:227]
    ds_read_b64_tr_b16 v[68:69], v13 offset:46176
    ds_read_b64_tr_b16 v[70:71], v13 offset:50784
    s_waitcnt lgkmcnt(8)
    v_mfma_f32_16x16x32_bf16 v[120:123], v[52:55], v[72:75], v[120:123]
    v_mfma_f32_16x16x32_bf16 v[192:195], v[52:55], v[76:79], v[192:195]
    ds_read_b64_tr_b16 v[48:49], v13 offset:36992
    ds_read_b64_tr_b16 v[50:51], v13 offset:41600
    s_waitcnt lgkmcnt(8)
    v_mfma_f32_16x16x32_bf16 v[156:159], v[56:59], v[72:75], v[156:159]
    v_mfma_f32_16x16x32_bf16 v[228:231], v[56:59], v[76:79], v[228:231]
    ds_read_b64_tr_b16 v[52:53], v13 offset:46208
    ds_read_b64_tr_b16 v[54:55], v13 offset:50816
    s_waitcnt lgkmcnt(8)
    v_mfma_f32_16x16x32_bf16 v[32:35], v[60:63], v[20:23], v[32:35]
    s_waitcnt vmcnt(7)
    s_barrier
    v_add_u32 v17, s62, v13
    ds_read_b64_tr_b16 v[56:57], v17 offset:36864
    ds_read_b64_tr_b16 v[58:59], v17 offset:41472
    s_waitcnt lgkmcnt(8)
    v_mfma_f32_16x16x32_bf16 v[124:127], v[64:67], v[72:75], v[124:127]
    v_mfma_f32_16x16x32_bf16 v[196:199], v[64:67], v[76:79], v[196:199]
    ds_read_b64_tr_b16 v[60:61], v13 offset:37024
    ds_read_b64_tr_b16 v[62:63], v13 offset:41632
    s_waitcnt lgkmcnt(8)
    v_mfma_f32_16x16x32_bf16 v[160:163], v[68:71], v[72:75], v[160:163]
    v_mfma_f32_16x16x32_bf16 v[232:235], v[68:71], v[76:79], v[232:235]
    ds_read_b64_tr_b16 v[64:65], v13 offset:46240
    ds_read_b64_tr_b16 v[66:67], v13 offset:50848
    s_waitcnt lgkmcnt(8)
    v_mfma_f32_16x16x32_bf16 v[128:131], v[48:51], v[72:75], v[128:131]
    v_mfma_f32_16x16x32_bf16 v[200:203], v[48:51], v[76:79], v[200:203]
    ds_read_b64_tr_b16 v[68:69], v13 offset:37056
    ds_read_b64_tr_b16 v[70:71], v13 offset:41664
    s_waitcnt lgkmcnt(8)
    v_mfma_f32_16x16x32_bf16 v[164:167], v[52:55], v[72:75], v[164:167]
    v_mfma_f32_16x16x32_bf16 v[236:239], v[52:55], v[76:79], v[236:239]
    ds_read_b64_tr_b16 v[48:49], v13 offset:46272
    ds_read_b64_tr_b16 v[50:51], v13 offset:50880
    s_waitcnt lgkmcnt(8)
    v_mfma_f32_16x16x32_bf16 v[36:39], v[56:59], v[20:23], v[36:39]
    s_add_u32 s30, s22, 92160
    s_add_u32 s29, s54, 3981312
    s_add_u32 m0, s30, 0
    s_mov_b64 exec, s[50:51]
    buffer_load_dwordx4 v10, s[8:11], s29 offen lds
    s_mov_b64 exec, -1
    v_add_u32 v18, s63, v13
    ds_read_b64_tr_b16 v[52:53], v18 offset:36864
    ds_read_b64_tr_b16 v[54:55], v18 offset:41472
    s_waitcnt lgkmcnt(8)
    v_mfma_f32_16x16x32_bf16 v[132:135], v[60:63], v[72:75], v[132:135]
    v_mfma_f32_16x16x32_bf16 v[204:207], v[60:63], v[76:79], v[204:207]
    s_add_u32 m0, s30, 768
    s_mov_b64 exec, s[50:51]
    buffer_load_dwordx4 v11, s[8:11], s29 offen lds
    s_mov_b64 exec, -1
    ds_read_b64_tr_b16 v[56:57], v13 offset:37088
    ds_read_b64_tr_b16 v[58:59], v13 offset:41696
    s_waitcnt lgkmcnt(8)
    v_mfma_f32_16x16x32_bf16 v[168:171], v[64:67], v[72:75], v[168:171]
    v_mfma_f32_16x16x32_bf16 v[240:243], v[64:67], v[76:79], v[240:243]
    s_add_u32 m0, s30, 1536
    s_mov_b64 exec, s[50:51]
    buffer_load_dwordx4 v12, s[8:11], s29 offen lds
    s_mov_b64 exec, -1
    ds_read_b64_tr_b16 v[60:61], v13 offset:46304
    ds_read_b64_tr_b16 v[62:63], v13 offset:50912
    s_waitcnt lgkmcnt(8)
    v_mfma_f32_16x16x32_bf16 v[136:139], v[68:71], v[72:75], v[136:139]
    v_mfma_f32_16x16x32_bf16 v[208:211], v[68:71], v[76:79], v[208:211]
    buffer_load_dwordx4 v[104:107], v3, s[12:15], s25 offen offset:2048 sc1
    ds_read_b64_tr_b16 v[64:65], v13 offset:37120
    ds_read_b64_tr_b16 v[66:67], v13 offset:41728
    s_waitcnt lgkmcnt(8)
    v_mfma_f32_16x16x32_bf16 v[172:175], v[48:51], v[72:75], v[172:175]
    v_mfma_f32_16x16x32_bf16 v[244:247], v[48:51], v[76:79], v[244:247]
    buffer_load_dwordx4 v[108:111], v3, s[12:15], s26 offen offset:2048 sc1
    ds_read_b64_tr_b16 v[68:69], v13 offset:46336
    ds_read_b64_tr_b16 v[70:71], v13 offset:50944
    s_waitcnt lgkmcnt(8)
    v_mfma_f32_16x16x32_bf16 v[40:43], v[52:55], v[20:23], v[40:43]
    v_add_u32 v17, s64, v13
    ds_read_b64_tr_b16 v[48:49], v17 offset:36864
    ds_read_b64_tr_b16 v[50:51], v17 offset:41472
    s_waitcnt lgkmcnt(8)
    v_mfma_f32_16x16x32_bf16 v[140:143], v[56:59], v[72:75], v[140:143]
    v_mfma_f32_16x16x32_bf16 v[212:215], v[56:59], v[76:79], v[212:215]
    ds_read_b64_tr_b16 v[52:53], v14 offset:0
    ds_read_b64_tr_b16 v[54:55], v14 offset:4608
    s_waitcnt lgkmcnt(8)
    v_mfma_f32_16x16x32_bf16 v[176:179], v[60:63], v[72:75], v[176:179]
    v_mfma_f32_16x16x32_bf16 v[248:251], v[60:63], v[76:79], v[248:251]
    ds_read_b64_tr_b16 v[56:57], v14 offset:9216
    ds_read_b64_tr_b16 v[58:59], v14 offset:13824
    s_waitcnt lgkmcnt(8)
    v_mfma_f32_16x16x32_bf16 v[144:147], v[64:67], v[72:75], v[144:147]
    v_mfma_f32_16x16x32_bf16 v[216:219], v[64:67], v[76:79], v[216:219]
    v_add_u32 v17, s60, v14
    ds_read_b64_tr_b16 v[60:61], v17 offset:0
    ds_read_b64_tr_b16 v[62:63], v17 offset:4608
    s_waitcnt lgkmcnt(8)
    v_mfma_f32_16x16x32_bf16 v[180:183], v[68:71], v[72:75], v[180:183]
    v_mfma_f32_16x16x32_bf16 v[252:255], v[68:71], v[76:79], v[252:255]
    ds_read_b64_tr_b16 v[64:65], v14 offset:32
    ds_read_b64_tr_b16 v[66:67], v14 offset:4640
    s_waitcnt lgkmcnt(8)
    v_mfma_f32_16x16x32_bf16 v[44:47], v[48:51], v[20:23], v[44:47]
    ds_read_b64_tr_b16 v[68:69], v14 offset:9248
    ds_read_b64_tr_b16 v[70:71], v14 offset:13856
    s_waitcnt lgkmcnt(8)
    v_mfma_f32_16x16x32_bf16 v[112:115], v[52:55], v[80:83], v[112:115]
    v_mfma_f32_16x16x32_bf16 v[184:187], v[52:55], v[84:87], v[184:187]
    ds_read_b64_tr_b16 v[48:49], v14 offset:64
    ds_read_b64_tr_b16 v[50:51], v14 offset:4672
    s_waitcnt lgkmcnt(8)
    v_mfma_f32_16x16x32_bf16 v[148:151], v[56:59], v[80:83], v[148:151]
    v_mfma_f32_16x16x32_bf16 v[220:223], v[56:59], v[84:87], v[220:223]
    v_add_u32 v16, v16, v19
    ds_read_b128 v[20:23], v16
    ds_read_b64_tr_b16 v[52:53], v14 offset:9280
    ds_read_b64_tr_b16 v[54:55], v14 offset:13888
    s_waitcnt lgkmcnt(8)
    v_mfma_f32_16x16x32_bf16 v[28:31], v[60:63], v[24:27], v[28:31]
    v_add_u32 v18, s61, v14
    ds_read_b64_tr_b16 v[56:57], v18 offset:0
    ds_read_b64_tr_b16 v[58:59], v18 offset:4608
    s_waitcnt lgkmcnt(8)
    v_mfma_f32_16x16x32_bf16 v[116:119], v[64:67], v[80:83], v[116:119]
    v_mfma_f32_16x16x32_bf16 v[188:191], v[64:67], v[84:87], v[188:191]
    ds_read_b64_tr_b16 v[60:61], v14 offset:96
    ds_read_b64_tr_b16 v[62:63], v14 offset:4704
    s_waitcnt lgkmcnt(8)
    v_mfma_f32_16x16x32_bf16 v[152:155], v[68:71], v[80:83], v[152:155]
    v_mfma_f32_16x16x32_bf16 v[224:227], v[68:71], v[84:87], v[224:227]
    ds_read_b64_tr_b16 v[64:65], v14 offset:9312
    ds_read_b64_tr_b16 v[66:67], v14 offset:13920
    s_waitcnt lgkmcnt(8)
    v_mfma_f32_16x16x32_bf16 v[120:123], v[48:51], v[80:83], v[120:123]
    v_mfma_f32_16x16x32_bf16 v[192:195], v[48:51], v[84:87], v[192:195]
    ds_read_b64_tr_b16 v[68:69], v14 offset:128
    ds_read_b64_tr_b16 v[70:71], v14 offset:4736
    s_waitcnt lgkmcnt(8)
    v_mfma_f32_16x16x32_bf16 v[156:159], v[52:55], v[80:83], v[156:159]
    v_mfma_f32_16x16x32_bf16 v[228:231], v[52:55], v[84:87], v[228:231]
    ds_read_b64_tr_b16 v[48:49], v14 offset:9344
    ds_read_b64_tr_b16 v[50:51], v14 offset:13952
    s_waitcnt lgkmcnt(8)
    v_mfma_f32_16x16x32_bf16 v[32:35], v[56:59], v[24:27], v[32:35]
    s_waitcnt vmcnt(7)
    s_barrier
    v_add_u32 v17, s62, v14
    ds_read_b64_tr_b16 v[52:53], v17 offset:0
    ds_read_b64_tr_b16 v[54:55], v17 offset:4608
    s_waitcnt lgkmcnt(8)
    v_mfma_f32_16x16x32_bf16 v[124:127], v[60:63], v[80:83], v[124:127]
    v_mfma_f32_16x16x32_bf16 v[196:199], v[60:63], v[84:87], v[196:199]
    ds_read_b64_tr_b16 v[56:57], v14 offset:160
    ds_read_b64_tr_b16 v[58:59], v14 offset:4768
    s_waitcnt lgkmcnt(8)
    v_mfma_f32_16x16x32_bf16 v[160:163], v[64:67], v[80:83], v[160:163]
    v_mfma_f32_16x16x32_bf16 v[232:235], v[64:67], v[84:87], v[232:235]
    ds_read_b64_tr_b16 v[60:61], v14 offset:9376
    ds_read_b64_tr_b16 v[62:63], v14 offset:13984
    s_waitcnt lgkmcnt(8)
    v_mfma_f32_16x16x32_bf16 v[128:131], v[68:71], v[80:83], v[128:131]
    v_mfma_f32_16x16x32_bf16 v[200:203], v[68:71], v[84:87], v[200:203]
    ds_read_b64_tr_b16 v[64:65], v14 offset:192
    ds_read_b64_tr_b16 v[66:67], v14 offset:4800
    s_waitcnt lgkmcnt(8)
    v_mfma_f32_16x16x32_bf16 v[164:167], v[48:51], v[80:83], v[164:167]
    v_mfma_f32_16x16x32_bf16 v[236:239], v[48:51], v[84:87], v[236:239]
    ds_read_b64_tr_b16 v[68:69], v14 offset:9408
    ds_read_b64_tr_b16 v[70:71], v14 offset:14016
    s_waitcnt lgkmcnt(8)
    v_mfma_f32_16x16x32_bf16 v[36:39], v[52:55], v[24:27], v[36:39]
    s_add_u32 s30, s22, 110592
    s_add_u32 s29, s54, 4276224
    s_add_u32 m0, s30, 0
    s_mov_b64 exec, s[50:51]
    buffer_load_dwordx4 v10, s[8:11], s29 offen lds
    s_mov_b64 exec, -1
    v_add_u32 v18, s63, v14
    ds_read_b64_tr_b16 v[48:49], v18 offset:0
    ds_read_b64_tr_b16 v[50:51], v18 offset:4608
    s_waitcnt lgkmcnt(8)
    v_mfma_f32_16x16x32_bf16 v[132:135], v[56:59], v[80:83], v[132:135]
    v_mfma_f32_16x16x32_bf16 v[204:207], v[56:59], v[84:87], v[204:207]
    s_add_u32 m0, s30, 768
    s_mov_b64 exec, s[50:51]
    buffer_load_dwordx4 v11, s[8:11], s29 offen lds
    s_mov_b64 exec, -1
    ds_read_b64_tr_b16 v[52:53], v14 offset:224
    ds_read_b64_tr_b16 v[54:55], v14 offset:4832
    s_waitcnt lgkmcnt(8)
    v_mfma_f32_16x16x32_bf16 v[168:171], v[60:63], v[80:83], v[168:171]
    v_mfma_f32_16x16x32_bf16 v[240:243], v[60:63], v[84:87], v[240:243]
    s_add_u32 m0, s30, 1536
    s_mov_b64 exec, s[50:51]
    buffer_load_dwordx4 v12, s[8:11], s29 offen lds
    s_mov_b64 exec, -1
    ds_read_b64_tr_b16 v[56:57], v14 offset:9440
    ds_read_b64_tr_b16 v[58:59], v14 offset:14048
    s_waitcnt lgkmcnt(8)
    v_mfma_f32_16x16x32_bf16 v[136:139], v[64:67], v[80:83], v[136:139]
    v_mfma_f32_16x16x32_bf16 v[208:211], v[64:67], v[84:87], v[208:211]
    buffer_load_dwordx4 v[72:75], v3, s[12:15], s25 offen offset:3072 sc1
    ds_read_b64_tr_b16 v[60:61], v14 offset:256
    ds_read_b64_tr_b16 v[62:63], v14 offset:4864
    s_waitcnt lgkmcnt(8)
    v_mfma_f32_16x16x32_bf16 v[172:175], v[68:71], v[80:83], v[172:175]
    v_mfma_f32_16x16x32_bf16 v[244:247], v[68:71], v[84:87], v[244:247]
    buffer_load_dwordx4 v[76:79], v3, s[12:15], s26 offen offset:3072 sc1
    ds_read_b64_tr_b16 v[64:65], v14 offset:9472
    ds_read_b64_tr_b16 v[66:67], v14 offset:14080
    s_waitcnt lgkmcnt(8)
    v_mfma_f32_16x16x32_bf16 v[40:43], v[48:51], v[24:27], v[40:43]
    v_add_u32 v17, s64, v14
    ds_read_b64_tr_b16 v[68:69], v17 offset:0
    ds_read_b64_tr_b16 v[70:71], v17 offset:4608
    s_waitcnt lgkmcnt(8)
    v_mfma_f32_16x16x32_bf16 v[140:143], v[52:55], v[80:83], v[140:143]
    v_mfma_f32_16x16x32_bf16 v[212:215], v[52:55], v[84:87], v[212:215]
    ds_read_b64_tr_b16 v[48:49], v14 offset:18432
    ds_read_b64_tr_b16 v[50:51], v14 offset:23040
    s_waitcnt lgkmcnt(8)
    v_mfma_f32_16x16x32_bf16 v[176:179], v[56:59], v[80:83], v[176:179]
    v_mfma_f32_16x16x32_bf16 v[248:251], v[56:59], v[84:87], v[248:251]
    ds_read_b64_tr_b16 v[52:53], v14 offset:27648
    ds_read_b64_tr_b16 v[54:55], v14 offset:32256
    s_waitcnt lgkmcnt(8)
    v_mfma_f32_16x16x32_bf16 v[144:147], v[60:63], v[80:83], v[144:147]
    v_mfma_f32_16x16x32_bf16 v[216:219], v[60:63], v[84:87], v[216:219]
    v_add_u32 v17, s60, v14
    ds_read_b64_tr_b16 v[56:57], v17 offset:18432
    ds_read_b64_tr_b16 v[58:59], v17 offset:23040
    s_waitcnt lgkmcnt(8)
    v_mfma_f32_16x16x32_bf16 v[180:183], v[64:67], v[80:83], v[180:183]
    v_mfma_f32_16x16x32_bf16 v[252:255], v[64:67], v[84:87], v[252:255]
    ds_read_b64_tr_b16 v[60:61], v14 offset:18464
    ds_read_b64_tr_b16 v[62:63], v14 offset:23072
    s_waitcnt lgkmcnt(8)
    v_mfma_f32_16x16x32_bf16 v[44:47], v[68:71], v[24:27], v[44:47]
    ds_read_b64_tr_b16 v[64:65], v14 offset:27680
    ds_read_b64_tr_b16 v[66:67], v14 offset:32288
    s_waitcnt lgkmcnt(8)
    v_mfma_f32_16x16x32_bf16 v[112:115], v[48:51], v[88:91], v[112:115]
    v_mfma_f32_16x16x32_bf16 v[184:187], v[48:51], v[92:95], v[184:187]
    ds_read_b64_tr_b16 v[68:69], v14 offset:18496
    ds_read_b64_tr_b16 v[70:71], v14 offset:23104
    s_waitcnt lgkmcnt(8)
    v_mfma_f32_16x16x32_bf16 v[148:151], v[52:55], v[88:91], v[148:151]
    v_mfma_f32_16x16x32_bf16 v[220:223], v[52:55], v[92:95], v[220:223]
    v_add_u32 v16, v16, v19
    ds_read_b128 v[24:27], v16
    ds_read_b64_tr_b16 v[48:49], v14 offset:27712
    ds_read_b64_tr_b16 v[50:51], v14 offset:32320
    s_waitcnt lgkmcnt(8)
    v_mfma_f32_16x16x32_bf16 v[28:31], v[56:59], v[20:23], v[28:31]
    v_add_u32 v18, s61, v14
    ds_read_b64_tr_b16 v[52:53], v18 offset:18432
    ds_read_b64_tr_b16 v[54:55], v18 offset:23040
    s_waitcnt lgkmcnt(8)
    v_mfma_f32_16x16x32_bf16 v[116:119], v[60:63], v[88:91], v[116:119]
    v_mfma_f32_16x16x32_bf16 v[188:191], v[60:63], v[92:95], v[188:191]
    ds_read_b64_tr_b16 v[56:57], v14 offset:18528
    ds_read_b64_tr_b16 v[58:59], v14 offset:23136
    s_waitcnt lgkmcnt(8)
    v_mfma_f32_16x16x32_bf16 v[152:155], v[64:67], v[88:91], v[152:155]
    v_mfma_f32_16x16x32_bf16 v[224:227], v[64:67], v[92:95], v[224:227]
    ds_read_b64_tr_b16 v[60:61], v14 offset:27744
    ds_read_b64_tr_b16 v[62:63], v14 offset:32352
    s_waitcnt lgkmcnt(8)
    v_mfma_f32_16x16x32_bf16 v[120:123], v[68:71], v[88:91], v[120:123]
    v_mfma_f32_16x16x32_bf16 v[192:195], v[68:71], v[92:95], v[192:195]
    ds_read_b64_tr_b16 v[64:65], v14 offset:18560
    ds_read_b64_tr_b16 v[66:67], v14 offset:23168
    s_waitcnt lgkmcnt(8)
    v_mfma_f32_16x16x32_bf16 v[156:159], v[48:51], v[88:91], v[156:159]
    v_mfma_f32_16x16x32_bf16 v[228:231], v[48:51], v[92:95], v[228:231]
    ds_read_b64_tr_b16 v[68:69], v14 offset:27776
    ds_read_b64_tr_b16 v[70:71], v14 offset:32384
    s_waitcnt lgkmcnt(8)
    v_mfma_f32_16x16x32_bf16 v[32:35], v[52:55], v[20:23], v[32:35]
    s_waitcnt vmcnt(7)
    s_barrier
    v_add_u32 v17, s62, v14
    ds_read_b64_tr_b16 v[48:49], v17 offset:18432
    ds_read_b64_tr_b16 v[50:51], v17 offset:23040
    s_waitcnt lgkmcnt(8)
    v_mfma_f32_16x16x32_bf16 v[124:127], v[56:59], v[88:91], v[124:127]
    v_mfma_f32_16x16x32_bf16 v[196:199], v[56:59], v[92:95], v[196:199]
    ds_read_b64_tr_b16 v[52:53], v14 offset:18592
    ds_read_b64_tr_b16 v[54:55], v14 offset:23200
    s_waitcnt lgkmcnt(8)
    v_mfma_f32_16x16x32_bf16 v[160:163], v[60:63], v[88:91], v[160:163]
    v_mfma_f32_16x16x32_bf16 v[232:235], v[60:63], v[92:95], v[232:235]
    ds_read_b64_tr_b16 v[56:57], v14 offset:27808
    ds_read_b64_tr_b16 v[58:59], v14 offset:32416
    s_waitcnt lgkmcnt(8)
    v_mfma_f32_16x16x32_bf16 v[128:131], v[64:67], v[88:91], v[128:131]
    v_mfma_f32_16x16x32_bf16 v[200:203], v[64:67], v[92:95], v[200:203]
    ds_read_b64_tr_b16 v[60:61], v14 offset:18624
    ds_read_b64_tr_b16 v[62:63], v14 offset:23232
    s_waitcnt lgkmcnt(8)
    v_mfma_f32_16x16x32_bf16 v[164:167], v[68:71], v[88:91], v[164:167]
    v_mfma_f32_16x16x32_bf16 v[236:239], v[68:71], v[92:95], v[236:239]
    ds_read_b64_tr_b16 v[64:65], v14 offset:27840
    ds_read_b64_tr_b16 v[66:67], v14 offset:32448
    s_waitcnt lgkmcnt(8)
    v_mfma_f32_16x16x32_bf16 v[36:39], v[48:51], v[20:23], v[36:39]
    s_add_u32 s30, s22, 129024
    s_add_u32 s29, s54, 4571136
    s_add_u32 m0, s30, 0
    s_mov_b64 exec, s[50:51]
    buffer_load_dwordx4 v10, s[8:11], s29 offen lds
    s_mov_b64 exec, -1
    v_add_u32 v18, s63, v14
    ds_read_b64_tr_b16 v[68:69], v18 offset:18432
    ds_read_b64_tr_b16 v[70:71], v18 offset:23040
    s_waitcnt lgkmcnt(8)
    v_mfma_f32_16x16x32_bf16 v[132:135], v[52:55], v[88:91], v[132:135]
    v_mfma_f32_16x16x32_bf16 v[204:207], v[52:55], v[92:95], v[204:207]
    s_add_u32 m0, s30, 768
    s_mov_b64 exec, s[50:51]
    buffer_load_dwordx4 v11, s[8:11], s29 offen lds
    s_mov_b64 exec, -1
    ds_read_b64_tr_b16 v[48:49], v14 offset:18656
    ds_read_b64_tr_b16 v[50:51], v14 offset:23264
    s_waitcnt lgkmcnt(8)
    v_mfma_f32_16x16x32_bf16 v[168:171], v[56:59], v[88:91], v[168:171]
    v_mfma_f32_16x16x32_bf16 v[240:243], v[56:59], v[92:95], v[240:243]
    s_add_u32 m0, s30, 1536
    s_mov_b64 exec, s[50:51]
    buffer_load_dwordx4 v12, s[8:11], s29 offen lds
    s_mov_b64 exec, -1
    ds_read_b64_tr_b16 v[52:53], v14 offset:27872
    ds_read_b64_tr_b16 v[54:55], v14 offset:32480
    s_waitcnt lgkmcnt(8)
    v_mfma_f32_16x16x32_bf16 v[136:139], v[60:63], v[88:91], v[136:139]
    v_mfma_f32_16x16x32_bf16 v[208:211], v[60:63], v[92:95], v[208:211]
    s_add_u32 s25, s25, 4096
    s_add_u32 s26, s26, 4096
    buffer_load_dwordx4 v[80:83], v3, s[12:15], s25 offen offset:0 sc1
    ds_read_b64_tr_b16 v[56:57], v14 offset:18688
    ds_read_b64_tr_b16 v[58:59], v14 offset:23296
    s_waitcnt lgkmcnt(8)
    v_mfma_f32_16x16x32_bf16 v[172:175], v[64:67], v[88:91], v[172:175]
    v_mfma_f32_16x16x32_bf16 v[244:247], v[64:67], v[92:95], v[244:247]
    buffer_load_dwordx4 v[84:87], v3, s[12:15], s26 offen offset:0 sc1
    ds_read_b64_tr_b16 v[60:61], v14 offset:27904
    ds_read_b64_tr_b16 v[62:63], v14 offset:32512
    s_waitcnt lgkmcnt(8)
    v_mfma_f32_16x16x32_bf16 v[40:43], v[68:71], v[20:23], v[40:43]
    v_add_u32 v17, s64, v14
    ds_read_b64_tr_b16 v[64:65], v17 offset:18432
    ds_read_b64_tr_b16 v[66:67], v17 offset:23040
    s_waitcnt lgkmcnt(8)
    v_mfma_f32_16x16x32_bf16 v[140:143], v[48:51], v[88:91], v[140:143]
    v_mfma_f32_16x16x32_bf16 v[212:215], v[48:51], v[92:95], v[212:215]
    ds_read_b64_tr_b16 v[68:69], v14 offset:36864
    ds_read_b64_tr_b16 v[70:71], v14 offset:41472
    s_waitcnt lgkmcnt(8)
    v_mfma_f32_16x16x32_bf16 v[176:179], v[52:55], v[88:91], v[176:179]
    v_mfma_f32_16x16x32_bf16 v[248:251], v[52:55], v[92:95], v[248:251]
    ds_read_b64_tr_b16 v[48:49], v14 offset:46080
    ds_read_b64_tr_b16 v[50:51], v14 offset:50688
    s_waitcnt lgkmcnt(8)
    v_mfma_f32_16x16x32_bf16 v[144:147], v[56:59], v[88:91], v[144:147]
    v_mfma_f32_16x16x32_bf16 v[216:219], v[56:59], v[92:95], v[216:219]
    v_add_u32 v17, s60, v14
    ds_read_b64_tr_b16 v[52:53], v17 offset:36864
    ds_read_b64_tr_b16 v[54:55], v17 offset:41472
    s_waitcnt lgkmcnt(8)
    v_mfma_f32_16x16x32_bf16 v[180:183], v[60:63], v[88:91], v[180:183]
    v_mfma_f32_16x16x32_bf16 v[252:255], v[60:63], v[92:95], v[252:255]
    ds_read_b64_tr_b16 v[56:57], v14 offset:36896
    ds_read_b64_tr_b16 v[58:59], v14 offset:41504
    s_waitcnt lgkmcnt(8)
    v_mfma_f32_16x16x32_bf16 v[44:47], v[64:67], v[20:23], v[44:47]
    ds_read_b64_tr_b16 v[60:61], v14 offset:46112
    ds_read_b64_tr_b16 v[62:63], v14 offset:50720
    s_waitcnt lgkmcnt(8)
    v_mfma_f32_16x16x32_bf16 v[112:115], v[68:71], v[96:99], v[112:115]
    v_mfma_f32_16x16x32_bf16 v[184:187], v[68:71], v[100:103], v[184:187]
    ds_read_b64_tr_b16 v[64:65], v14 offset:36928
    ds_read_b64_tr_b16 v[66:67], v14 offset:41536
    s_waitcnt lgkmcnt(8)
    v_mfma_f32_16x16x32_bf16 v[148:151], v[48:51], v[96:99], v[148:151]
    v_mfma_f32_16x16x32_bf16 v[220:223], v[48:51], v[100:103], v[220:223]
    v_add_u32 v16, v16, v19
    ds_read_b128 v[20:23], v16
    ds_read_b64_tr_b16 v[68:69], v14 offset:46144
    ds_read_b64_tr_b16 v[70:71], v14 offset:50752
    s_waitcnt lgkmcnt(8)
    v_mfma_f32_16x16x32_bf16 v[28:31], v[52:55], v[24:27], v[28:31]
    v_add_u32 v18, s61, v14
    ds_read_b64_tr_b16 v[48:49], v18 offset:36864
    ds_read_b64_tr_b16 v[50:51], v18 offset:41472
    s_waitcnt lgkmcnt(8)
    v_mfma_f32_16x16x32_bf16 v[116:119], v[56:59], v[96:99], v[116:119]
    v_mfma_f32_16x16x32_bf16 v[188:191], v[56:59], v[100:103], v[188:191]
    ds_read_b64_tr_b16 v[52:53], v14 offset:36960
    ds_read_b64_tr_b16 v[54:55], v14 offset:41568
    s_waitcnt lgkmcnt(8)
    v_mfma_f32_16x16x32_bf16 v[152:155], v[60:63], v[96:99], v[152:155]
    v_mfma_f32_16x16x32_bf16 v[224:227], v[60:63], v[100:103], v[224:227]
    ds_read_b64_tr_b16 v[56:57], v14 offset:46176
    ds_read_b64_tr_b16 v[58:59], v14 offset:50784
    s_waitcnt lgkmcnt(8)
    v_mfma_f32_16x16x32_bf16 v[120:123], v[64:67], v[96:99], v[120:123]
    v_mfma_f32_16x16x32_bf16 v[192:195], v[64:67], v[100:103], v[192:195]
    ds_read_b64_tr_b16 v[60:61], v14 offset:36992
    ds_read_b64_tr_b16 v[62:63], v14 offset:41600
    s_waitcnt lgkmcnt(8)
    v_mfma_f32_16x16x32_bf16 v[156:159], v[68:71], v[96:99], v[156:159]
    v_mfma_f32_16x16x32_bf16 v[228:231], v[68:71], v[100:103], v[228:231]
    ds_read_b64_tr_b16 v[64:65], v14 offset:46208
    ds_read_b64_tr_b16 v[66:67], v14 offset:50816
    s_waitcnt lgkmcnt(8)
    v_mfma_f32_16x16x32_bf16 v[32:35], v[48:51], v[24:27], v[32:35]
    s_waitcnt vmcnt(7)
    s_barrier
    v_add_u32 v17, s62, v14
    ds_read_b64_tr_b16 v[68:69], v17 offset:36864
    ds_read_b64_tr_b16 v[70:71], v17 offset:41472
    s_waitcnt lgkmcnt(8)
    v_mfma_f32_16x16x32_bf16 v[124:127], v[52:55], v[96:99], v[124:127]
    v_mfma_f32_16x16x32_bf16 v[196:199], v[52:55], v[100:103], v[196:199]
    ds_read_b64_tr_b16 v[48:49], v14 offset:37024
    ds_read_b64_tr_b16 v[50:51], v14 offset:41632
    s_waitcnt lgkmcnt(8)
    v_mfma_f32_16x16x32_bf16 v[160:163], v[56:59], v[96:99], v[160:163]
    v_mfma_f32_16x16x32_bf16 v[232:235], v[56:59], v[100:103], v[232:235]
    ds_read_b64_tr_b16 v[52:53], v14 offset:46240
    ds_read_b64_tr_b16 v[54:55], v14 offset:50848
    s_waitcnt lgkmcnt(8)
    v_mfma_f32_16x16x32_bf16 v[128:131], v[60:63], v[96:99], v[128:131]
    v_mfma_f32_16x16x32_bf16 v[200:203], v[60:63], v[100:103], v[200:203]
    ds_read_b64_tr_b16 v[56:57], v14 offset:37056
    ds_read_b64_tr_b16 v[58:59], v14 offset:41664
    s_waitcnt lgkmcnt(8)
    v_mfma_f32_16x16x32_bf16 v[164:167], v[64:67], v[96:99], v[164:167]
    v_mfma_f32_16x16x32_bf16 v[236:239], v[64:67], v[100:103], v[236:239]
    ds_read_b64_tr_b16 v[60:61], v14 offset:46272
    ds_read_b64_tr_b16 v[62:63], v14 offset:50880
    s_waitcnt lgkmcnt(8)
    v_mfma_f32_16x16x32_bf16 v[36:39], v[68:71], v[24:27], v[36:39]
    s_add_u32 s30, s22, 0
    s_add_u32 s29, s54, 4866048
    s_add_u32 m0, s30, 0
    s_mov_b64 exec, s[50:51]
    buffer_load_dwordx4 v10, s[8:11], s29 offen lds
    s_mov_b64 exec, -1
    v_add_u32 v18, s63, v14
    ds_read_b64_tr_b16 v[64:65], v18 offset:36864
    ds_read_b64_tr_b16 v[66:67], v18 offset:41472
    s_waitcnt lgkmcnt(8)
    v_mfma_f32_16x16x32_bf16 v[132:135], v[48:51], v[96:99], v[132:135]
    v_mfma_f32_16x16x32_bf16 v[204:207], v[48:51], v[100:103], v[204:207]
    s_add_u32 m0, s30, 768
    s_mov_b64 exec, s[50:51]
    buffer_load_dwordx4 v11, s[8:11], s29 offen lds
    s_mov_b64 exec, -1
    ds_read_b64_tr_b16 v[68:69], v14 offset:37088
    ds_read_b64_tr_b16 v[70:71], v14 offset:41696
    s_waitcnt lgkmcnt(8)
    v_mfma_f32_16x16x32_bf16 v[168:171], v[52:55], v[96:99], v[168:171]
    v_mfma_f32_16x16x32_bf16 v[240:243], v[52:55], v[100:103], v[240:243]
    s_add_u32 m0, s30, 1536
    s_mov_b64 exec, s[50:51]
    buffer_load_dwordx4 v12, s[8:11], s29 offen lds
    s_mov_b64 exec, -1
    ds_read_b64_tr_b16 v[48:49], v14 offset:46304
    ds_read_b64_tr_b16 v[50:51], v14 offset:50912
    s_waitcnt lgkmcnt(8)
    v_mfma_f32_16x16x32_bf16 v[136:139], v[56:59], v[96:99], v[136:139]
    v_mfma_f32_16x16x32_bf16 v[208:211], v[56:59], v[100:103], v[208:211]
    buffer_load_dwordx4 v[88:91], v3, s[12:15], s25 offen offset:1024 sc1
    ds_read_b64_tr_b16 v[52:53], v14 offset:37120
    ds_read_b64_tr_b16 v[54:55], v14 offset:41728
    s_waitcnt lgkmcnt(8)
    v_mfma_f32_16x16x32_bf16 v[172:175], v[60:63], v[96:99], v[172:175]
    v_mfma_f32_16x16x32_bf16 v[244:247], v[60:63], v[100:103], v[244:247]
    buffer_load_dwordx4 v[92:95], v3, s[12:15], s26 offen offset:1024 sc1
    ds_read_b64_tr_b16 v[56:57], v14 offset:46336
    ds_read_b64_tr_b16 v[58:59], v14 offset:50944
    s_waitcnt lgkmcnt(8)
    v_mfma_f32_16x16x32_bf16 v[40:43], v[64:67], v[24:27], v[40:43]
    v_add_u32 v17, s64, v14
    ds_read_b64_tr_b16 v[60:61], v17 offset:36864
    ds_read_b64_tr_b16 v[62:63], v17 offset:41472
    s_waitcnt lgkmcnt(8)
    v_mfma_f32_16x16x32_bf16 v[140:143], v[68:71], v[96:99], v[140:143]
    v_mfma_f32_16x16x32_bf16 v[212:215], v[68:71], v[100:103], v[212:215]
    ds_read_b64_tr_b16 v[64:65], v15 offset:0
    ds_read_b64_tr_b16 v[66:67], v15 offset:4608
    s_waitcnt lgkmcnt(8)
    v_mfma_f32_16x16x32_bf16 v[176:179], v[48:51], v[96:99], v[176:179]
    v_mfma_f32_16x16x32_bf16 v[248:251], v[48:51], v[100:103], v[248:251]
    ds_read_b64_tr_b16 v[68:69], v15 offset:9216
    ds_read_b64_tr_b16 v[70:71], v15 offset:13824
    s_waitcnt lgkmcnt(8)
    v_mfma_f32_16x16x32_bf16 v[144:147], v[52:55], v[96:99], v[144:147]
    v_mfma_f32_16x16x32_bf16 v[216:219], v[52:55], v[100:103], v[216:219]
    v_add_u32 v17, s60, v15
    ds_read_b64_tr_b16 v[48:49], v17 offset:0
    ds_read_b64_tr_b16 v[50:51], v17 offset:4608
    s_waitcnt lgkmcnt(8)
    v_mfma_f32_16x16x32_bf16 v[180:183], v[56:59], v[96:99], v[180:183]
    v_mfma_f32_16x16x32_bf16 v[252:255], v[56:59], v[100:103], v[252:255]
    ds_read_b64_tr_b16 v[52:53], v15 offset:32
    ds_read_b64_tr_b16 v[54:55], v15 offset:4640
    s_waitcnt lgkmcnt(8)
    v_mfma_f32_16x16x32_bf16 v[44:47], v[60:63], v[24:27], v[44:47]
    ds_read_b64_tr_b16 v[56:57], v15 offset:9248
    ds_read_b64_tr_b16 v[58:59], v15 offset:13856
    s_waitcnt lgkmcnt(8)
    v_mfma_f32_16x16x32_bf16 v[112:115], v[64:67], v[104:107], v[112:115]
    v_mfma_f32_16x16x32_bf16 v[184:187], v[64:67], v[108:111], v[184:187]
    ds_read_b64_tr_b16 v[60:61], v15 offset:64
    ds_read_b64_tr_b16 v[62:63], v15 offset:4672
    s_waitcnt lgkmcnt(8)
    v_mfma_f32_16x16x32_bf16 v[148:151], v[68:71], v[104:107], v[148:151]
    v_mfma_f32_16x16x32_bf16 v[220:223], v[68:71], v[108:111], v[220:223]
    v_add_u32 v16, v16, v19
    ds_read_b128 v[24:27], v16
    ds_read_b64_tr_b16 v[64:65], v15 offset:9280
    ds_read_b64_tr_b16 v[66:67], v15 offset:13888
    s_waitcnt lgkmcnt(8)
    v_mfma_f32_16x16x32_bf16 v[28:31], v[48:51], v[20:23], v[28:31]
    v_add_u32 v18, s61, v15
    ds_read_b64_tr_b16 v[68:69], v18 offset:0
    ds_read_b64_tr_b16 v[70:71], v18 offset:4608
    s_waitcnt lgkmcnt(8)
    v_mfma_f32_16x16x32_bf16 v[116:119], v[52:55], v[104:107], v[116:119]
    v_mfma_f32_16x16x32_bf16 v[188:191], v[52:55], v[108:111], v[188:191]
    ds_read_b64_tr_b16 v[48:49], v15 offset:96
    ds_read_b64_tr_b16 v[50:51], v15 offset:4704
    s_waitcnt lgkmcnt(8)
    v_mfma_f32_16x16x32_bf16 v[152:155], v[56:59], v[104:107], v[152:155]
    v_mfma_f32_16x16x32_bf16 v[224:227], v[56:59], v[108:111], v[224:227]
    ds_read_b64_tr_b16 v[52:53], v15 offset:9312
    ds_read_b64_tr_b16 v[54:55], v15 offset:13920
    s_waitcnt lgkmcnt(8)
    v_mfma_f32_16x16x32_bf16 v[120:123], v[60:63], v[104:107], v[120:123]
    v_mfma_f32_16x16x32_bf16 v[192:195], v[60:63], v[108:111], v[192:195]
    ds_read_b64_tr_b16 v[56:57], v15 offset:128
    ds_read_b64_tr_b16 v[58:59], v15 offset:4736
    s_waitcnt lgkmcnt(8)
    v_mfma_f32_16x16x32_bf16 v[156:159], v[64:67], v[104:107], v[156:159]
    v_mfma_f32_16x16x32_bf16 v[228:231], v[64:67], v[108:111], v[228:231]
    ds_read_b64_tr_b16 v[60:61], v15 offset:9344
    ds_read_b64_tr_b16 v[62:63], v15 offset:13952
    s_waitcnt lgkmcnt(8)
    v_mfma_f32_16x16x32_bf16 v[32:35], v[68:71], v[20:23], v[32:35]
    s_waitcnt vmcnt(7)
    s_barrier
    v_add_u32 v17, s62, v15
    ds_read_b64_tr_b16 v[64:65], v17 offset:0
    ds_read_b64_tr_b16 v[66:67], v17 offset:4608
    s_waitcnt lgkmcnt(8)
    v_mfma_f32_16x16x32_bf16 v[124:127], v[48:51], v[104:107], v[124:127]
    v_mfma_f32_16x16x32_bf16 v[196:199], v[48:51], v[108:111], v[196:199]
    ds_read_b64_tr_b16 v[68:69], v15 offset:160
    ds_read_b64_tr_b16 v[70:71], v15 offset:4768
    s_waitcnt lgkmcnt(8)
    v_mfma_f32_16x16x32_bf16 v[160:163], v[52:55], v[104:107], v[160:163]
    v_mfma_f32_16x16x32_bf16 v[232:235], v[52:55], v[108:111], v[232:235]
    ds_read_b64_tr_b16 v[48:49], v15 offset:9376
    ds_read_b64_tr_b16 v[50:51], v15 offset:13984
    s_waitcnt lgkmcnt(8)
    v_mfma_f32_16x16x32_bf16 v[128:131], v[56:59], v[104:107], v[128:131]
    v_mfma_f32_16x16x32_bf16 v[200:203], v[56:59], v[108:111], v[200:203]
    ds_read_b64_tr_b16 v[52:53], v15 offset:192
    ds_read_b64_tr_b16 v[54:55], v15 offset:4800
    s_waitcnt lgkmcnt(8)
    v_mfma_f32_16x16x32_bf16 v[164:167], v[60:63], v[104:107], v[164:167]
    v_mfma_f32_16x16x32_bf16 v[236:239], v[60:63], v[108:111], v[236:239]
    ds_read_b64_tr_b16 v[56:57], v15 offset:9408
    ds_read_b64_tr_b16 v[58:59], v15 offset:14016
    s_waitcnt lgkmcnt(8)
    v_mfma_f32_16x16x32_bf16 v[36:39], v[64:67], v[20:23], v[36:39]
    s_add_u32 s30, s22, 18432
    s_add_u32 s29, s55, 3833856
    s_add_u32 m0, s30, 0
    s_mov_b64 exec, s[50:51]
    buffer_load_dwordx4 v10, s[8:11], s29 offen lds
    s_mov_b64 exec, -1
    v_add_u32 v18, s63, v15
    ds_read_b64_tr_b16 v[60:61], v18 offset:0
    ds_read_b64_tr_b16 v[62:63], v18 offset:4608
    s_waitcnt lgkmcnt(8)
    v_mfma_f32_16x16x32_bf16 v[132:135], v[68:71], v[104:107], v[132:135]
    v_mfma_f32_16x16x32_bf16 v[204:207], v[68:71], v[108:111], v[204:207]
    s_add_u32 m0, s30, 768
    s_mov_b64 exec, s[50:51]
    buffer_load_dwordx4 v11, s[8:11], s29 offen lds
    s_mov_b64 exec, -1
    ds_read_b64_tr_b16 v[64:65], v15 offset:224
    ds_read_b64_tr_b16 v[66:67], v15 offset:4832
    s_waitcnt lgkmcnt(8)
    v_mfma_f32_16x16x32_bf16 v[168:171], v[48:51], v[104:107], v[168:171]
    v_mfma_f32_16x16x32_bf16 v[240:243], v[48:51], v[108:111], v[240:243]
    s_add_u32 m0, s30, 1536
    s_mov_b64 exec, s[50:51]
    buffer_load_dwordx4 v12, s[8:11], s29 offen lds
    s_mov_b64 exec, -1
    ds_read_b64_tr_b16 v[68:69], v15 offset:9440
    ds_read_b64_tr_b16 v[70:71], v15 offset:14048
    s_waitcnt lgkmcnt(8)
    v_mfma_f32_16x16x32_bf16 v[136:139], v[52:55], v[104:107], v[136:139]
    v_mfma_f32_16x16x32_bf16 v[208:211], v[52:55], v[108:111], v[208:211]
    ds_read_b64_tr_b16 v[48:49], v15 offset:256
    ds_read_b64_tr_b16 v[50:51], v15 offset:4864
    s_waitcnt lgkmcnt(8)
    v_mfma_f32_16x16x32_bf16 v[172:175], v[56:59], v[104:107], v[172:175]
    v_mfma_f32_16x16x32_bf16 v[244:247], v[56:59], v[108:111], v[244:247]
    ds_read_b64_tr_b16 v[52:53], v15 offset:9472
    ds_read_b64_tr_b16 v[54:55], v15 offset:14080
    s_waitcnt lgkmcnt(8)
    v_mfma_f32_16x16x32_bf16 v[40:43], v[60:63], v[20:23], v[40:43]
    v_add_u32 v17, s64, v15
    ds_read_b64_tr_b16 v[56:57], v17 offset:0
    ds_read_b64_tr_b16 v[58:59], v17 offset:4608
    s_waitcnt lgkmcnt(8)
    v_mfma_f32_16x16x32_bf16 v[140:143], v[64:67], v[104:107], v[140:143]
    v_mfma_f32_16x16x32_bf16 v[212:215], v[64:67], v[108:111], v[212:215]
    ds_read_b64_tr_b16 v[60:61], v15 offset:18432
    ds_read_b64_tr_b16 v[62:63], v15 offset:23040
    s_waitcnt lgkmcnt(8)
    v_mfma_f32_16x16x32_bf16 v[176:179], v[68:71], v[104:107], v[176:179]
    v_mfma_f32_16x16x32_bf16 v[248:251], v[68:71], v[108:111], v[248:251]
    ds_read_b64_tr_b16 v[64:65], v15 offset:27648
    ds_read_b64_tr_b16 v[66:67], v15 offset:32256
    s_waitcnt lgkmcnt(8)
    v_mfma_f32_16x16x32_bf16 v[144:147], v[48:51], v[104:107], v[144:147]
    v_mfma_f32_16x16x32_bf16 v[216:219], v[48:51], v[108:111], v[216:219]
    v_add_u32 v17, s60, v15
    ds_read_b64_tr_b16 v[68:69], v17 offset:18432
    ds_read_b64_tr_b16 v[70:71], v17 offset:23040
    s_waitcnt lgkmcnt(8)
    v_mfma_f32_16x16x32_bf16 v[180:183], v[52:55], v[104:107], v[180:183]
    v_mfma_f32_16x16x32_bf16 v[252:255], v[52:55], v[108:111], v[252:255]
    ds_read_b64_tr_b16 v[48:49], v15 offset:18464
    ds_read_b64_tr_b16 v[50:51], v15 offset:23072
    s_waitcnt lgkmcnt(8)
    v_mfma_f32_16x16x32_bf16 v[44:47], v[56:59], v[20:23], v[44:47]
    v_min_u32 v5, 161, v0
    s_mul_i32 s31, s2, 20736
    v_lshl_add_u32 v5, v5, 7, s31
    global_load_dword v2, v5, s[56:57]
    ds_read_b64_tr_b16 v[52:53], v15 offset:27680
    ds_read_b64_tr_b16 v[54:55], v15 offset:32288
    s_waitcnt lgkmcnt(8)
    v_mfma_f32_16x16x32_bf16 v[112:115], v[60:63], v[72:75], v[112:115]
    v_mfma_f32_16x16x32_bf16 v[184:187], v[60:63], v[76:79], v[184:187]
    ds_read_b64_tr_b16 v[56:57], v15 offset:18496
    ds_read_b64_tr_b16 v[58:59], v15 offset:23104
    s_waitcnt lgkmcnt(8)
    v_mfma_f32_16x16x32_bf16 v[148:151], v[64:67], v[72:75], v[148:151]
    v_mfma_f32_16x16x32_bf16 v[220:223], v[64:67], v[76:79], v[220:223]
    v_add_u32 v16, v16, v19
    ds_read_b128 v[20:23], v16
    ds_read_b64_tr_b16 v[60:61], v15 offset:27712
    ds_read_b64_tr_b16 v[62:63], v15 offset:32320
    s_waitcnt lgkmcnt(8)
    v_mfma_f32_16x16x32_bf16 v[28:31], v[68:71], v[24:27], v[28:31]
    v_add_u32 v18, s61, v15
    ds_read_b64_tr_b16 v[64:65], v18 offset:18432
    ds_read_b64_tr_b16 v[66:67], v18 offset:23040
    s_waitcnt lgkmcnt(8)
    v_mfma_f32_16x16x32_bf16 v[116:119], v[48:51], v[72:75], v[116:119]
    v_mfma_f32_16x16x32_bf16 v[188:191], v[48:51], v[76:79], v[188:191]
    ds_read_b64_tr_b16 v[68:69], v15 offset:18528
    ds_read_b64_tr_b16 v[70:71], v15 offset:23136
    s_waitcnt lgkmcnt(8)
    v_mfma_f32_16x16x32_bf16 v[152:155], v[52:55], v[72:75], v[152:155]
    v_mfma_f32_16x16x32_bf16 v[224:227], v[52:55], v[76:79], v[224:227]
    ds_read_b64_tr_b16 v[48:49], v15 offset:27744
    ds_read_b64_tr_b16 v[50:51], v15 offset:32352
    s_waitcnt lgkmcnt(8)
    v_mfma_f32_16x16x32_bf16 v[120:123], v[56:59], v[72:75], v[120:123]
    v_mfma_f32_16x16x32_bf16 v[192:195], v[56:59], v[76:79], v[192:195]
    ds_read_b64_tr_b16 v[52:53], v15 offset:18560
    ds_read_b64_tr_b16 v[54:55], v15 offset:23168
    s_waitcnt lgkmcnt(8)
    v_mfma_f32_16x16x32_bf16 v[156:159], v[60:63], v[72:75], v[156:159]
    v_mfma_f32_16x16x32_bf16 v[228:231], v[60:63], v[76:79], v[228:231]
    ds_read_b64_tr_b16 v[56:57], v15 offset:27776
    ds_read_b64_tr_b16 v[58:59], v15 offset:32384
    s_waitcnt lgkmcnt(8)
    v_mfma_f32_16x16x32_bf16 v[32:35], v[64:67], v[24:27], v[32:35]
    s_waitcnt vmcnt(6)
    s_barrier
    v_add_u32 v17, s62, v15
    ds_read_b64_tr_b16 v[60:61], v17 offset:18432
    ds_read_b64_tr_b16 v[62:63], v17 offset:23040
    s_waitcnt lgkmcnt(8)
    v_mfma_f32_16x16x32_bf16 v[124:127], v[68:71], v[72:75], v[124:127]
    v_mfma_f32_16x16x32_bf16 v[196:199], v[68:71], v[76:79], v[196:199]
    ds_read_b64_tr_b16 v[64:65], v15 offset:18592
    ds_read_b64_tr_b16 v[66:67], v15 offset:23200
    s_waitcnt lgkmcnt(8)
    v_mfma_f32_16x16x32_bf16 v[160:163], v[48:51], v[72:75], v[160:163]
    v_mfma_f32_16x16x32_bf16 v[232:235], v[48:51], v[76:79], v[232:235]
    ds_read_b64_tr_b16 v[68:69], v15 offset:27808
    ds_read_b64_tr_b16 v[70:71], v15 offset:32416
    s_waitcnt lgkmcnt(8)
    v_mfma_f32_16x16x32_bf16 v[128:131], v[52:55], v[72:75], v[128:131]
    v_mfma_f32_16x16x32_bf16 v[200:203], v[52:55], v[76:79], v[200:203]
    ds_read_b64_tr_b16 v[48:49], v15 offset:18624
    ds_read_b64_tr_b16 v[50:51], v15 offset:23232
    s_waitcnt lgkmcnt(8)
    v_mfma_f32_16x16x32_bf16 v[164:167], v[56:59], v[72:75], v[164:167]
    v_mfma_f32_16x16x32_bf16 v[236:239], v[56:59], v[76:79], v[236:239]
    ds_read_b64_tr_b16 v[52:53], v15 offset:27840
    ds_read_b64_tr_b16 v[54:55], v15 offset:32448
    s_waitcnt lgkmcnt(8)
    v_mfma_f32_16x16x32_bf16 v[36:39], v[60:63], v[24:27], v[36:39]
    v_add_u32 v18, s63, v15
    ds_read_b64_tr_b16 v[56:57], v18 offset:18432
    ds_read_b64_tr_b16 v[58:59], v18 offset:23040
    s_waitcnt lgkmcnt(8)
    v_mfma_f32_16x16x32_bf16 v[132:135], v[64:67], v[72:75], v[132:135]
    v_mfma_f32_16x16x32_bf16 v[204:207], v[64:67], v[76:79], v[204:207]
    ds_read_b64_tr_b16 v[60:61], v15 offset:18656
    ds_read_b64_tr_b16 v[62:63], v15 offset:23264
    s_waitcnt lgkmcnt(8)
    v_mfma_f32_16x16x32_bf16 v[168:171], v[68:71], v[72:75], v[168:171]
    v_mfma_f32_16x16x32_bf16 v[240:243], v[68:71], v[76:79], v[240:243]
    ds_read_b64_tr_b16 v[64:65], v15 offset:27872
    ds_read_b64_tr_b16 v[66:67], v15 offset:32480
    s_waitcnt lgkmcnt(8)
    v_mfma_f32_16x16x32_bf16 v[136:139], v[48:51], v[72:75], v[136:139]
    v_mfma_f32_16x16x32_bf16 v[208:211], v[48:51], v[76:79], v[208:211]
    ds_read_b64_tr_b16 v[68:69], v15 offset:18688
    ds_read_b64_tr_b16 v[70:71], v15 offset:23296
    s_waitcnt lgkmcnt(8)
    v_mfma_f32_16x16x32_bf16 v[172:175], v[52:55], v[72:75], v[172:175]
    v_mfma_f32_16x16x32_bf16 v[244:247], v[52:55], v[76:79], v[244:247]
    ds_read_b64_tr_b16 v[48:49], v15 offset:27904
    ds_read_b64_tr_b16 v[50:51], v15 offset:32512
    s_waitcnt lgkmcnt(8)
    v_mfma_f32_16x16x32_bf16 v[40:43], v[56:59], v[24:27], v[40:43]
    v_add_u32 v17, s64, v15
    ds_read_b64_tr_b16 v[52:53], v17 offset:18432
    ds_read_b64_tr_b16 v[54:55], v17 offset:23040
    s_waitcnt lgkmcnt(8)
    v_mfma_f32_16x16x32_bf16 v[140:143], v[60:63], v[72:75], v[140:143]
    v_mfma_f32_16x16x32_bf16 v[212:215], v[60:63], v[76:79], v[212:215]
    ds_read_b64_tr_b16 v[56:57], v13 offset:0
    ds_read_b64_tr_b16 v[58:59], v13 offset:4608
    s_waitcnt lgkmcnt(8)
    v_mfma_f32_16x16x32_bf16 v[176:179], v[64:67], v[72:75], v[176:179]
    v_mfma_f32_16x16x32_bf16 v[248:251], v[64:67], v[76:79], v[248:251]
    ds_read_b64_tr_b16 v[60:61], v13 offset:9216
    ds_read_b64_tr_b16 v[62:63], v13 offset:13824
    s_waitcnt lgkmcnt(8)
    v_mfma_f32_16x16x32_bf16 v[144:147], v[68:71], v[72:75], v[144:147]
    v_mfma_f32_16x16x32_bf16 v[216:219], v[68:71], v[76:79], v[216:219]
    v_add_u32 v17, s60, v13
    ds_read_b64_tr_b16 v[64:65], v17 offset:0
    ds_read_b64_tr_b16 v[66:67], v17 offset:4608
    s_waitcnt lgkmcnt(8)
    v_mfma_f32_16x16x32_bf16 v[180:183], v[48:51], v[72:75], v[180:183]
    v_mfma_f32_16x16x32_bf16 v[252:255], v[48:51], v[76:79], v[252:255]
    ds_read_b64_tr_b16 v[68:69], v13 offset:32
    ds_read_b64_tr_b16 v[70:71], v13 offset:4640
    s_waitcnt lgkmcnt(8)
    v_mfma_f32_16x16x32_bf16 v[44:47], v[52:55], v[24:27], v[44:47]
    ds_read_b64_tr_b16 v[48:49], v13 offset:9248
    ds_read_b64_tr_b16 v[50:51], v13 offset:13856
    s_waitcnt lgkmcnt(8)
    v_mfma_f32_16x16x32_bf16 v[112:115], v[56:59], v[80:83], v[112:115]
    v_mfma_f32_16x16x32_bf16 v[184:187], v[56:59], v[84:87], v[184:187]
    ds_read_b64_tr_b16 v[52:53], v13 offset:64
    ds_read_b64_tr_b16 v[54:55], v13 offset:4672
    s_waitcnt lgkmcnt(8)
    v_mfma_f32_16x16x32_bf16 v[148:151], v[60:63], v[80:83], v[148:151]
    v_mfma_f32_16x16x32_bf16 v[220:223], v[60:63], v[84:87], v[220:223]
    v_add_u32 v16, v16, v19
    ds_read_b128 v[24:27], v16
    ds_read_b64_tr_b16 v[56:57], v13 offset:9280
    ds_read_b64_tr_b16 v[58:59], v13 offset:13888
    s_waitcnt lgkmcnt(8)
    v_mfma_f32_16x16x32_bf16 v[28:31], v[64:67], v[20:23], v[28:31]
    v_add_u32 v18, s61, v13
    ds_read_b64_tr_b16 v[60:61], v18 offset:0
    ds_read_b64_tr_b16 v[62:63], v18 offset:4608
    s_waitcnt lgkmcnt(8)
    v_mfma_f32_16x16x32_bf16 v[116:119], v[68:71], v[80:83], v[116:119]
    v_mfma_f32_16x16x32_bf16 v[188:191], v[68:71], v[84:87], v[188:191]
    ds_read_b64_tr_b16 v[64:65], v13 offset:96
    ds_read_b64_tr_b16 v[66:67], v13 offset:4704
    s_waitcnt lgkmcnt(8)
    v_mfma_f32_16x16x32_bf16 v[152:155], v[48:51], v[80:83], v[152:155]
    v_mfma_f32_16x16x32_bf16 v[224:227], v[48:51], v[84:87], v[224:227]
    ds_read_b64_tr_b16 v[68:69], v13 offset:9312
    ds_read_b64_tr_b16 v[70:71], v13 offset:13920
    s_waitcnt lgkmcnt(8)
    v_mfma_f32_16x16x32_bf16 v[120:123], v[52:55], v[80:83], v[120:123]
    v_mfma_f32_16x16x32_bf16 v[192:195], v[52:55], v[84:87], v[192:195]
    ds_read_b64_tr_b16 v[48:49], v13 offset:128
    ds_read_b64_tr_b16 v[50:51], v13 offset:4736
    s_waitcnt lgkmcnt(8)
    v_mfma_f32_16x16x32_bf16 v[156:159], v[56:59], v[80:83], v[156:159]
    v_mfma_f32_16x16x32_bf16 v[228:231], v[56:59], v[84:87], v[228:231]
    ds_read_b64_tr_b16 v[52:53], v13 offset:9344
    ds_read_b64_tr_b16 v[54:55], v13 offset:13952
    s_waitcnt lgkmcnt(8)
    v_mfma_f32_16x16x32_bf16 v[32:35], v[60:63], v[20:23], v[32:35]
    s_waitcnt vmcnt(1)
    s_barrier
    v_add_u32 v17, s62, v13
    ds_read_b64_tr_b16 v[56:57], v17 offset:0
    ds_read_b64_tr_b16 v[58:59], v17 offset:4608
    s_waitcnt lgkmcnt(8)
    v_mfma_f32_16x16x32_bf16 v[124:127], v[64:67], v[80:83], v[124:127]
    v_mfma_f32_16x16x32_bf16 v[196:199], v[64:67], v[84:87], v[196:199]
    ds_read_b64_tr_b16 v[60:61], v13 offset:160
    ds_read_b64_tr_b16 v[62:63], v13 offset:4768
    s_waitcnt lgkmcnt(8)
    v_mfma_f32_16x16x32_bf16 v[160:163], v[68:71], v[80:83], v[160:163]
    v_mfma_f32_16x16x32_bf16 v[232:235], v[68:71], v[84:87], v[232:235]
    ds_read_b64_tr_b16 v[64:65], v13 offset:9376
    ds_read_b64_tr_b16 v[66:67], v13 offset:13984
    s_waitcnt lgkmcnt(8)
    v_mfma_f32_16x16x32_bf16 v[128:131], v[48:51], v[80:83], v[128:131]
    v_mfma_f32_16x16x32_bf16 v[200:203], v[48:51], v[84:87], v[200:203]
    ds_read_b64_tr_b16 v[68:69], v13 offset:192
    ds_read_b64_tr_b16 v[70:71], v13 offset:4800
    s_waitcnt lgkmcnt(8)
    v_mfma_f32_16x16x32_bf16 v[164:167], v[52:55], v[80:83], v[164:167]
    v_mfma_f32_16x16x32_bf16 v[236:239], v[52:55], v[84:87], v[236:239]
    ds_read_b64_tr_b16 v[48:49], v13 offset:9408
    ds_read_b64_tr_b16 v[50:51], v13 offset:14016
    s_waitcnt lgkmcnt(8)
    v_mfma_f32_16x16x32_bf16 v[36:39], v[56:59], v[20:23], v[36:39]
    v_add_u32 v18, s63, v13
    ds_read_b64_tr_b16 v[52:53], v18 offset:0
    ds_read_b64_tr_b16 v[54:55], v18 offset:4608
    s_waitcnt lgkmcnt(8)
    v_mfma_f32_16x16x32_bf16 v[132:135], v[60:63], v[80:83], v[132:135]
    v_mfma_f32_16x16x32_bf16 v[204:207], v[60:63], v[84:87], v[204:207]
    ds_read_b64_tr_b16 v[56:57], v13 offset:224
    ds_read_b64_tr_b16 v[58:59], v13 offset:4832
    s_waitcnt lgkmcnt(8)
    v_mfma_f32_16x16x32_bf16 v[168:171], v[64:67], v[80:83], v[168:171]
    v_mfma_f32_16x16x32_bf16 v[240:243], v[64:67], v[84:87], v[240:243]
    ds_read_b64_tr_b16 v[60:61], v13 offset:9440
    ds_read_b64_tr_b16 v[62:63], v13 offset:14048
    s_waitcnt lgkmcnt(8)
    v_mfma_f32_16x16x32_bf16 v[136:139], v[68:71], v[80:83], v[136:139]
    v_mfma_f32_16x16x32_bf16 v[208:211], v[68:71], v[84:87], v[208:211]
    ds_read_b64_tr_b16 v[64:65], v13 offset:256
    ds_read_b64_tr_b16 v[66:67], v13 offset:4864
    s_waitcnt lgkmcnt(8)
    v_mfma_f32_16x16x32_bf16 v[172:175], v[48:51], v[80:83], v[172:175]
    v_mfma_f32_16x16x32_bf16 v[244:247], v[48:51], v[84:87], v[244:247]
    ds_read_b64_tr_b16 v[68:69], v13 offset:9472
    ds_read_b64_tr_b16 v[70:71], v13 offset:14080
    s_waitcnt lgkmcnt(8)
    v_mfma_f32_16x16x32_bf16 v[40:43], v[52:55], v[20:23], v[40:43]
    v_add_u32 v17, s64, v13
    ds_read_b64_tr_b16 v[48:49], v17 offset:0
    ds_read_b64_tr_b16 v[50:51], v17 offset:4608
    s_waitcnt lgkmcnt(8)
    v_mfma_f32_16x16x32_bf16 v[140:143], v[56:59], v[80:83], v[140:143]
    v_mfma_f32_16x16x32_bf16 v[212:215], v[56:59], v[84:87], v[212:215]
    ds_read_b64_tr_b16 v[52:53], v13 offset:18432
    ds_read_b64_tr_b16 v[54:55], v13 offset:23040
    s_waitcnt lgkmcnt(8)
    v_mfma_f32_16x16x32_bf16 v[176:179], v[60:63], v[80:83], v[176:179]
    v_mfma_f32_16x16x32_bf16 v[248:251], v[60:63], v[84:87], v[248:251]
    ds_read_b64_tr_b16 v[56:57], v13 offset:27648
    ds_read_b64_tr_b16 v[58:59], v13 offset:32256
    s_waitcnt lgkmcnt(8)
    v_mfma_f32_16x16x32_bf16 v[144:147], v[64:67], v[80:83], v[144:147]
    v_mfma_f32_16x16x32_bf16 v[216:219], v[64:67], v[84:87], v[216:219]
    v_add_u32 v17, s60, v13
    ds_read_b64_tr_b16 v[60:61], v17 offset:18432
    ds_read_b64_tr_b16 v[62:63], v17 offset:23040
    s_waitcnt lgkmcnt(8)
    v_mfma_f32_16x16x32_bf16 v[180:183], v[68:71], v[80:83], v[180:183]
    v_mfma_f32_16x16x32_bf16 v[252:255], v[68:71], v[84:87], v[252:255]
    ds_read_b64_tr_b16 v[64:65], v13 offset:18464
    ds_read_b64_tr_b16 v[66:67], v13 offset:23072
    s_waitcnt lgkmcnt(8)
    v_mfma_f32_16x16x32_bf16 v[44:47], v[48:51], v[20:23], v[44:47]
    ds_read_b64_tr_b16 v[68:69], v13 offset:27680
    ds_read_b64_tr_b16 v[70:71], v13 offset:32288
    s_waitcnt lgkmcnt(8)
    v_mfma_f32_16x16x32_bf16 v[112:115], v[52:55], v[88:91], v[112:115]
    v_mfma_f32_16x16x32_bf16 v[184:187], v[52:55], v[92:95], v[184:187]
    ds_read_b64_tr_b16 v[48:49], v13 offset:18496
    ds_read_b64_tr_b16 v[50:51], v13 offset:23104
    s_waitcnt lgkmcnt(8)
    v_mfma_f32_16x16x32_bf16 v[148:151], v[56:59], v[88:91], v[148:151]
    v_mfma_f32_16x16x32_bf16 v[220:223], v[56:59], v[92:95], v[220:223]
    ds_read_b64_tr_b16 v[52:53], v13 offset:27712
    ds_read_b64_tr_b16 v[54:55], v13 offset:32320
    s_waitcnt lgkmcnt(8)
    v_mfma_f32_16x16x32_bf16 v[28:31], v[60:63], v[24:27], v[28:31]
    v_add_u32 v18, s61, v13
    ds_read_b64_tr_b16 v[56:57], v18 offset:18432
    ds_read_b64_tr_b16 v[58:59], v18 offset:23040
    s_waitcnt lgkmcnt(8)
    v_mfma_f32_16x16x32_bf16 v[116:119], v[64:67], v[88:91], v[116:119]
    v_mfma_f32_16x16x32_bf16 v[188:191], v[64:67], v[92:95], v[188:191]
    ds_read_b64_tr_b16 v[60:61], v13 offset:18528
    ds_read_b64_tr_b16 v[62:63], v13 offset:23136
    s_waitcnt lgkmcnt(8)
    v_mfma_f32_16x16x32_bf16 v[152:155], v[68:71], v[88:91], v[152:155]
    v_mfma_f32_16x16x32_bf16 v[224:227], v[68:71], v[92:95], v[224:227]
    ds_read_b64_tr_b16 v[64:65], v13 offset:27744
    ds_read_b64_tr_b16 v[66:67], v13 offset:32352
    s_waitcnt lgkmcnt(8)
    v_mfma_f32_16x16x32_bf16 v[120:123], v[48:51], v[88:91], v[120:123]
    v_mfma_f32_16x16x32_bf16 v[192:195], v[48:51], v[92:95], v[192:195]
    ds_read_b64_tr_b16 v[68:69], v13 offset:18560
    ds_read_b64_tr_b16 v[70:71], v13 offset:23168
    s_waitcnt lgkmcnt(8)
    v_mfma_f32_16x16x32_bf16 v[156:159], v[52:55], v[88:91], v[156:159]
    v_mfma_f32_16x16x32_bf16 v[228:231], v[52:55], v[92:95], v[228:231]
    ds_read_b64_tr_b16 v[48:49], v13 offset:27776
    ds_read_b64_tr_b16 v[50:51], v13 offset:32384
    s_waitcnt lgkmcnt(8)
    v_mfma_f32_16x16x32_bf16 v[32:35], v[56:59], v[24:27], v[32:35]
    v_add_u32 v17, s62, v13
    ds_read_b64_tr_b16 v[52:53], v17 offset:18432
    ds_read_b64_tr_b16 v[54:55], v17 offset:23040
    s_waitcnt lgkmcnt(8)
    v_mfma_f32_16x16x32_bf16 v[124:127], v[60:63], v[88:91], v[124:127]
    v_mfma_f32_16x16x32_bf16 v[196:199], v[60:63], v[92:95], v[196:199]
    ds_read_b64_tr_b16 v[56:57], v13 offset:18592
    ds_read_b64_tr_b16 v[58:59], v13 offset:23200
    s_waitcnt lgkmcnt(8)
    v_mfma_f32_16x16x32_bf16 v[160:163], v[64:67], v[88:91], v[160:163]
    v_mfma_f32_16x16x32_bf16 v[232:235], v[64:67], v[92:95], v[232:235]
    ds_read_b64_tr_b16 v[60:61], v13 offset:27808
    ds_read_b64_tr_b16 v[62:63], v13 offset:32416
    s_waitcnt lgkmcnt(8)
    v_mfma_f32_16x16x32_bf16 v[128:131], v[68:71], v[88:91], v[128:131]
    v_mfma_f32_16x16x32_bf16 v[200:203], v[68:71], v[92:95], v[200:203]
    ds_read_b64_tr_b16 v[64:65], v13 offset:18624
    ds_read_b64_tr_b16 v[66:67], v13 offset:23232
    s_waitcnt lgkmcnt(8)
    v_mfma_f32_16x16x32_bf16 v[164:167], v[48:51], v[88:91], v[164:167]
    v_mfma_f32_16x16x32_bf16 v[236:239], v[48:51], v[92:95], v[236:239]
    ds_read_b64_tr_b16 v[68:69], v13 offset:27840
    ds_read_b64_tr_b16 v[70:71], v13 offset:32448
    s_waitcnt lgkmcnt(8)
    v_mfma_f32_16x16x32_bf16 v[36:39], v[52:55], v[24:27], v[36:39]
    v_add_u32 v18, s63, v13
    ds_read_b64_tr_b16 v[48:49], v18 offset:18432
    ds_read_b64_tr_b16 v[50:51], v18 offset:23040
    s_waitcnt lgkmcnt(8)
    v_mfma_f32_16x16x32_bf16 v[132:135], v[56:59], v[88:91], v[132:135]
    v_mfma_f32_16x16x32_bf16 v[204:207], v[56:59], v[92:95], v[204:207]
    ds_read_b64_tr_b16 v[52:53], v13 offset:18656
    ds_read_b64_tr_b16 v[54:55], v13 offset:23264
    s_waitcnt lgkmcnt(8)
    v_mfma_f32_16x16x32_bf16 v[168:171], v[60:63], v[88:91], v[168:171]
    v_mfma_f32_16x16x32_bf16 v[240:243], v[60:63], v[92:95], v[240:243]
    ds_read_b64_tr_b16 v[56:57], v13 offset:27872
    ds_read_b64_tr_b16 v[58:59], v13 offset:32480
    s_waitcnt lgkmcnt(8)
    v_mfma_f32_16x16x32_bf16 v[136:139], v[64:67], v[88:91], v[136:139]
    v_mfma_f32_16x16x32_bf16 v[208:211], v[64:67], v[92:95], v[208:211]
    ds_read_b64_tr_b16 v[60:61], v13 offset:18688
    ds_read_b64_tr_b16 v[62:63], v13 offset:23296
    s_waitcnt lgkmcnt(8)
    v_mfma_f32_16x16x32_bf16 v[172:175], v[68:71], v[88:91], v[172:175]
    v_mfma_f32_16x16x32_bf16 v[244:247], v[68:71], v[92:95], v[244:247]
    ds_read_b64_tr_b16 v[64:65], v13 offset:27904
    ds_read_b64_tr_b16 v[66:67], v13 offset:32512
    s_waitcnt lgkmcnt(8)
    v_mfma_f32_16x16x32_bf16 v[40:43], v[48:51], v[24:27], v[40:43]
    v_add_u32 v17, s64, v13
    ds_read_b64_tr_b16 v[68:69], v17 offset:18432
    ds_read_b64_tr_b16 v[70:71], v17 offset:23040
    s_waitcnt lgkmcnt(8)
    v_mfma_f32_16x16x32_bf16 v[140:143], v[52:55], v[88:91], v[140:143]
    v_mfma_f32_16x16x32_bf16 v[212:215], v[52:55], v[92:95], v[212:215]
    s_waitcnt lgkmcnt(6)
    v_mfma_f32_16x16x32_bf16 v[176:179], v[56:59], v[88:91], v[176:179]
    v_mfma_f32_16x16x32_bf16 v[248:251], v[56:59], v[92:95], v[248:251]
    s_waitcnt lgkmcnt(4)
    v_mfma_f32_16x16x32_bf16 v[144:147], v[60:63], v[88:91], v[144:147]
    v_mfma_f32_16x16x32_bf16 v[216:219], v[60:63], v[92:95], v[216:219]
    s_waitcnt lgkmcnt(2)
    v_mfma_f32_16x16x32_bf16 v[180:183], v[64:67], v[88:91], v[180:183]
    v_mfma_f32_16x16x32_bf16 v[252:255], v[64:67], v[92:95], v[252:255]
    s_waitcnt lgkmcnt(0)
    v_mfma_f32_16x16x32_bf16 v[44:47], v[68:71], v[24:27], v[44:47]
    v_and_b32 v5, 15, v1
    v_mul_u32_u24 v5, 576, v5
    v_lshl_add_u32 v5, v4, 4, v5
    s_and_b32 s31, s3, 1
    s_mul_i32 s31, s31, 1152
    s_lshr_b32 s32, s3, 1
    s_lshl_b32 s32, s32, 6
    s_add_u32 s31, s31, s32
    s_add_u32 s31, s31, 147456
    v_add_u32 v5, s31, v5
    s_mov_b32 exec_lo, 0x00030003
    s_mov_b32 exec_hi, 0x00030003
    ds_write_b128 v5, v[28:31]
    ds_write_b128 v5, v[32:35] offset:128
    ds_write_b128 v5, v[36:39] offset:256
    ds_write_b128 v5, v[40:43] offset:384
    s_cmp_ge_u32 s3, 2
    s_cbranch_scc1 k3_gs_w
    ds_write_b128 v5, v[44:47] offset:512
k3_gs_w:
    s_mov_b64 exec, -1
    s_waitcnt lgkmcnt(0)
    s_barrier
    s_branch k3_epi
k3_grp1:
    s_waitcnt vmcnt(8) lgkmcnt(0)
    s_barrier
    s_waitcnt vmcnt(13)
    s_barrier
    s_add_u32 s30, s22, 55296
    s_add_u32 s29, s54, 884736
    s_add_u32 m0, s30, 0
    s_mov_b64 exec, s[50:51]
    buffer_load_dwordx4 v10, s[8:11], s29 offen lds
    s_mov_b64 exec, -1
    s_add_u32 m0, s30, 768
    s_mov_b64 exec, s[50:51]
    buffer_load_dwordx4 v11, s[8:11], s29 offen lds
    s_mov_b64 exec, -1
    s_add_u32 m0, s30, 1536
    s_mov_b64 exec, s[50:51]
    buffer_load_dwordx4 v12, s[8:11], s29 offen lds
    s_mov_b64 exec, -1
    s_waitcnt vmcnt(13)
    s_barrier
    s_add_u32 s30, s22, 73728
    s_add_u32 s29, s54, 1327104
    s_add_u32 m0, s30, 0
    s_mov_b64 exec, s[50:51]
    buffer_load_dwordx4 v10, s[8:11], s29 offen lds
    s_mov_b64 exec, -1
    s_add_u32 m0, s30, 768
    s_mov_b64 exec, s[50:51]
    buffer_load_dwordx4 v11, s[8:11], s29 offen lds
    s_mov_b64 exec, -1
    s_add_u32 m0, s30, 1536
    s_mov_b64 exec, s[50:51]
    buffer_load_dwordx4 v12, s[8:11], s29 offen lds
    s_mov_b64 exec, -1
    s_waitcnt vmcnt(3)
    s_barrier
    s_add_u32 s30, s22, 92160
    s_add_u32 s29, s54, 1622016
    s_add_u32 m0, s30, 0
    s_mov_b64 exec, s[50:51]
    buffer_load_dwordx4 v10, s[8:11], s29 offen lds
    s_mov_b64 exec, -1
    s_add_u32 m0, s30, 768
    s_mov_b64 exec, s[50:51]
    buffer_load_dwordx4 v11, s[8:11], s29 offen lds
    s_mov_b64 exec, -1
    s_add_u32 m0, s30, 1536
    s_mov_b64 exec, s[50:51]
    buffer_load_dwordx4 v12, s[8:11], s29 offen lds
    s_mov_b64 exec, -1
    s_waitcnt vmcnt(3)
    s_barrier
    s_add_u32 s30, s22, 110592
    s_add_u32 s29, s54, 1916928
    s_add_u32 m0, s30, 0
    s_mov_b64 exec, s[50:51]
    buffer_load_dwordx4 v10, s[8:11], s29 offen lds
    s_mov_b64 exec, -1
    s_add_u32 m0, s30, 768
    s_mov_b64 exec, s[50:51]
    buffer_load_dwordx4 v11, s[8:11], s29 offen lds
    s_mov_b64 exec, -1
    s_add_u32 m0, s30, 1536
    s_mov_b64 exec, s[50:51]
    buffer_load_dwordx4 v12, s[8:11], s29 offen lds
    s_mov_b64 exec, -1
    s_waitcnt vmcnt(20)
    ds_read_b64_tr_b16 v[48:49], v13 offset:0
    ds_read_b64_tr_b16 v[50:51], v13 offset:4608
    ds_read_b64_tr_b16 v[52:53], v13 offset:9216
    ds_read_b64_tr_b16 v[54:55], v13 offset:13824
    ds_read_b64_tr_b16 v[56:57], v13 offset:32
    ds_read_b64_tr_b16 v[58:59], v13 offset:4640
    ds_read_b64_tr_b16 v[60:61], v13 offset:9248
    ds_read_b64_tr_b16 v[62:63], v13 offset:13856
    ds_read_b64_tr_b16 v[64:65], v13 offset:64
    ds_read_b64_tr_b16 v[66:67], v13 offset:4672
    s_waitcnt lgkmcnt(8)
    v_mfma_f32_16x16x32_bf16 v[112:115], v[48:51], v[72:75], 0
    v_mfma_f32_16x16x32_bf16 v[184:187], v[48:51], v[76:79], 0
    ds_read_b64_tr_b16 v[68:69], v13 offset:9280
    ds_read_b64_tr_b16 v[70:71], v13 offset:13888
    s_waitcnt lgkmcnt(8)
    v_mfma_f32_16x16x32_bf16 v[148:151], v[52:55], v[72:75], 0
    v_mfma_f32_16x16x32_bf16 v[220:223], v[52:55], v[76:79], 0
    s_waitcnt vmcnt(3)
    s_barrier
    ds_read_b64_tr_b16 v[48:49], v13 offset:96
    ds_read_b64_tr_b16 v[50:51], v13 offset:4704
    s_waitcnt lgkmcnt(8)
    v_mfma_f32_16x16x32_bf16 v[116:119], v[56:59], v[72:75], 0
    v_mfma_f32_16x16x32_bf16 v[188:191], v[56:59], v[76:79], 0
    s_add_u32 s30, s22, 129024
    s_add_u32 s29, s54, 2211840
    s_add_u32 m0, s30, 0
    s_mov_b64 exec, s[50:51]
    buffer_load_dwordx4 v10, s[8:11], s29 offen lds
    s_mov_b64 exec, -1
    s_add_u32 m0, s30, 768
    s_mov_b64 exec, s[50:51]
    buffer_load_dwordx4 v11, s[8:11], s29 offen lds
    s_mov_b64 exec, -1
    s_add_u32 m0, s30, 1536
    s_mov_b64 exec, s[50:51]
    buffer_load_dwordx4 v12, s[8:11], s29 offen lds
    s_mov_b64 exec, -1
    s_add_u32 s25, s25, 4096
    s_add_u32 s26, s26, 4096
    buffer_load_dwordx4 v[104:107], v3, s[12:15], s25 offen offset:0 sc1
    buffer_load_dwordx4 v[108:111], v3, s[12:15], s26 offen offset:0 sc1
    ds_read_b64_tr_b16 v[52:53], v13 offset:9312
    ds_read_b64_tr_b16 v[54:55], v13 offset:13920
    s_waitcnt lgkmcnt(8)
    v_mfma_f32_16x16x32_bf16 v[152:155], v[60:63], v[72:75], 0
    v_mfma_f32_16x16x32_bf16 v[224:227], v[60:63], v[76:79], 0
    ds_read_b64_tr_b16 v[56:57], v13 offset:128
    ds_read_b64_tr_b16 v[58:59], v13 offset:4736
    s_waitcnt lgkmcnt(8)
    v_mfma_f32_16x16x32_bf16 v[120:123], v[64:67], v[72:75], 0
    v_mfma_f32_16x16x32_bf16 v[192:195], v[64:67], v[76:79], 0
    ds_read_b64_tr_b16 v[60:61], v13 offset:9344
    ds_read_b64_tr_b16 v[62:63], v13 offset:13952
    s_waitcnt lgkmcnt(8)
    v_mfma_f32_16x16x32_bf16 v[156:159], v[68:71], v[72:75], 0
    v_mfma_f32_16x16x32_bf16 v[228:231], v[68:71], v[76:79], 0
    ds_read_b64_tr_b16 v[64:65], v13 offset:160
    ds_read_b64_tr_b16 v[66:67], v13 offset:4768
    s_waitcnt lgkmcnt(8)
    v_mfma_f32_16x16x32_bf16 v[124:127], v[48:51], v[72:75], 0
    v_mfma_f32_16x16x32_bf16 v[196:199], v[48:51], v[76:79], 0
    ds_read_b64_tr_b16 v[68:69], v13 offset:9376
    ds_read_b64_tr_b16 v[70:71], v13 offset:13984
    s_waitcnt lgkmcnt(8)
    v_mfma_f32_16x16x32_bf16 v[160:163], v[52:55], v[72:75], 0
    v_mfma_f32_16x16x32_bf16 v[232:235], v[52:55], v[76:79], 0
    ds_read_b64_tr_b16 v[48:49], v13 offset:192
    ds_read_b64_tr_b16 v[50:51], v13 offset:4800
    s_waitcnt lgkmcnt(8)
    v_mfma_f32_16x16x32_bf16 v[128:131], v[56:59], v[72:75], 0
    v_mfma_f32_16x16x32_bf16 v[200:203], v[56:59], v[76:79], 0
    ds_read_b64_tr_b16 v[52:53], v13 offset:9408
    ds_read_b64_tr_b16 v[54:55], v13 offset:14016
    s_waitcnt lgkmcnt(8)
    v_mfma_f32_16x16x32_bf16 v[164:167], v[60:63], v[72:75], 0
    v_mfma_f32_16x16x32_bf16 v[236:239], v[60:63], v[76:79], 0
    ds_read_b64_tr_b16 v[56:57], v13 offset:224
    ds_read_b64_tr_b16 v[58:59], v13 offset:4832
    s_waitcnt lgkmcnt(8)
    v_mfma_f32_16x16x32_bf16 v[132:135], v[64:67], v[72:75], 0
    v_mfma_f32_16x16x32_bf16 v[204:207], v[64:67], v[76:79], 0
    ds_read_b64_tr_b16 v[60:61], v13 offset:9440
    ds_read_b64_tr_b16 v[62:63], v13 offset:14048
    s_waitcnt lgkmcnt(8)
    v_mfma_f32_16x16x32_bf16 v[168:171], v[68:71], v[72:75], 0
    v_mfma_f32_16x16x32_bf16 v[240:243], v[68:71], v[76:79], 0
    ds_read_b64_tr_b16 v[64:65], v13 offset:256
    ds_read_b64_tr_b16 v[66:67], v13 offset:4864
    s_waitcnt lgkmcnt(8)
    v_mfma_f32_16x16x32_bf16 v[136:139], v[48:51], v[72:75], 0
    v_mfma_f32_16x16x32_bf16 v[208:211], v[48:51], v[76:79], 0
    ds_read_b64_tr_b16 v[68:69], v13 offset:9472
    ds_read_b64_tr_b16 v[70:71], v13 offset:14080
    s_waitcnt lgkmcnt(8)
    v_mfma_f32_16x16x32_bf16 v[172:175], v[52:55], v[72:75], 0
    v_mfma_f32_16x16x32_bf16 v[244:247], v[52:55], v[76:79], 0
    ds_read_b64_tr_b16 v[48:49], v13 offset:18432
    ds_read_b64_tr_b16 v[50:51], v13 offset:23040
    s_waitcnt lgkmcnt(8)
    v_mfma_f32_16x16x32_bf16 v[140:143], v[56:59], v[72:75], 0
    v_mfma_f32_16x16x32_bf16 v[212:215], v[56:59], v[76:79], 0
    ds_read_b64_tr_b16 v[52:53], v13 offset:27648
    ds_read_b64_tr_b16 v[54:55], v13 offset:32256
    s_waitcnt lgkmcnt(8)
    v_mfma_f32_16x16x32_bf16 v[176:179], v[60:63], v[72:75], 0
    v_mfma_f32_16x16x32_bf16 v[248:251], v[60:63], v[76:79], 0
    ds_read_b64_tr_b16 v[56:57], v13 offset:18464
    ds_read_b64_tr_b16 v[58:59], v13 offset:23072
    s_waitcnt lgkmcnt(8)
    v_mfma_f32_16x16x32_bf16 v[144:147], v[64:67], v[72:75], 0
    v_mfma_f32_16x16x32_bf16 v[216:219], v[64:67], v[76:79], 0
    ds_read_b64_tr_b16 v[60:61], v13 offset:27680
    ds_read_b64_tr_b16 v[62:63], v13 offset:32288
    s_waitcnt lgkmcnt(8)
    v_mfma_f32_16x16x32_bf16 v[180:183], v[68:71], v[72:75], 0
    v_mfma_f32_16x16x32_bf16 v[252:255], v[68:71], v[76:79], 0
    ds_read_b64_tr_b16 v[64:65], v13 offset:18496
    ds_read_b64_tr_b16 v[66:67], v13 offset:23104
    s_waitcnt lgkmcnt(8)
    v_mfma_f32_16x16x32_bf16 v[112:115], v[48:51], v[80:83], v[112:115]
    v_mfma_f32_16x16x32_bf16 v[184:187], v[48:51], v[84:87], v[184:187]
    ds_read_b64_tr_b16 v[68:69], v13 offset:27712
    ds_read_b64_tr_b16 v[70:71], v13 offset:32320
    s_waitcnt lgkmcnt(8)
    v_mfma_f32_16x16x32_bf16 v[148:151], v[52:55], v[80:83], v[148:151]
    v_mfma_f32_16x16x32_bf16 v[220:223], v[52:55], v[84:87], v[220:223]
    s_waitcnt vmcnt(5)
    s_barrier
    ds_read_b64_tr_b16 v[48:49], v13 offset:18528
    ds_read_b64_tr_b16 v[50:51], v13 offset:23136
    s_waitcnt lgkmcnt(8)
    v_mfma_f32_16x16x32_bf16 v[116:119], v[56:59], v[80:83], v[116:119]
    v_mfma_f32_16x16x32_bf16 v[188:191], v[56:59], v[84:87], v[188:191]
    s_add_u32 s30, s22, 0
    s_add_u32 s29, s55, 1179648
    s_add_u32 m0, s30, 0
    s_mov_b64 exec, s[50:51]
    buffer_load_dwordx4 v10, s[8:11], s29 offen lds
    s_mov_b64 exec, -1
    s_add_u32 m0, s30, 768
    s_mov_b64 exec, s[50:51]
    buffer_load_dwordx4 v11, s[8:11], s29 offen lds
    s_mov_b64 exec, -1
    s_add_u32 m0, s30, 1536
    s_mov_b64 exec, s[50:51]
    buffer_load_dwordx4 v12, s[8:11], s29 offen lds
    s_mov_b64 exec, -1
    buffer_load_dwordx4 v[72:75], v3, s[12:15], s25 offen offset:1024 sc1
    buffer_load_dwordx4 v[76:79], v3, s[12:15], s26 offen offset:1024 sc1
    ds_read_b64_tr_b16 v[52:53], v13 offset:27744
    ds_read_b64_tr_b16 v[54:55], v13 offset:32352
    s_waitcnt lgkmcnt(8)
    v_mfma_f32_16x16x32_bf16 v[152:155], v[60:63], v[80:83], v[152:155]
    v_mfma_f32_16x16x32_bf16 v[224:227], v[60:63], v[84:87], v[224:227]
    ds_read_b64_tr_b16 v[56:57], v13 offset:18560
    ds_read_b64_tr_b16 v[58:59], v13 offset:23168
    s_waitcnt lgkmcnt(8)
    v_mfma_f32_16x16x32_bf16 v[120:123], v[64:67], v[80:83], v[120:123]
    v_mfma_f32_16x16x32_bf16 v[192:195], v[64:67], v[84:87], v[192:195]
    ds_read_b64_tr_b16 v[60:61], v13 offset:27776
    ds_read_b64_tr_b16 v[62:63], v13 offset:32384
    s_waitcnt lgkmcnt(8)
    v_mfma_f32_16x16x32_bf16 v[156:159], v[68:71], v[80:83], v[156:159]
    v_mfma_f32_16x16x32_bf16 v[228:231], v[68:71], v[84:87], v[228:231]
    ds_read_b64_tr_b16 v[64:65], v13 offset:18592
    ds_read_b64_tr_b16 v[66:67], v13 offset:23200
    s_waitcnt lgkmcnt(8)
    v_mfma_f32_16x16x32_bf16 v[124:127], v[48:51], v[80:83], v[124:127]
    v_mfma_f32_16x16x32_bf16 v[196:199], v[48:51], v[84:87], v[196:199]
    ds_read_b64_tr_b16 v[68:69], v13 offset:27808
    ds_read_b64_tr_b16 v[70:71], v13 offset:32416
    s_waitcnt lgkmcnt(8)
    v_mfma_f32_16x16x32_bf16 v[160:163], v[52:55], v[80:83], v[160:163]
    v_mfma_f32_16x16x32_bf16 v[232:235], v[52:55], v[84:87], v[232:235]
    ds_read_b64_tr_b16 v[48:49], v13 offset:18624
    ds_read_b64_tr_b16 v[50:51], v13 offset:23232
    s_waitcnt lgkmcnt(8)
    v_mfma_f32_16x16x32_bf16 v[128:131], v[56:59], v[80:83], v[128:131]
    v_mfma_f32_16x16x32_bf16 v[200:203], v[56:59], v[84:87], v[200:203]
    ds_read_b64_tr_b16 v[52:53], v13 offset:27840
    ds_read_b64_tr_b16 v[54:55], v13 offset:32448
    s_waitcnt lgkmcnt(8)
    v_mfma_f32_16x16x32_bf16 v[164:167], v[60:63], v[80:83], v[164:167]
    v_mfma_f32_16x16x32_bf16 v[236:239], v[60:63], v[84:87], v[236:239]
    ds_read_b64_tr_b16 v[56:57], v13 offset:18656
    ds_read_b64_tr_b16 v[58:59], v13 offset:23264
    s_waitcnt lgkmcnt(8)
    v_mfma_f32_16x16x32_bf16 v[132:135], v[64:67], v[80:83], v[132:135]
    v_mfma_f32_16x16x32_bf16 v[204:207], v[64:67], v[84:87], v[204:207]
    ds_read_b64_tr_b16 v[60:61], v13 offset:27872
    ds_read_b64_tr_b16 v[62:63], v13 offset:32480
    s_waitcnt lgkmcnt(8)
    v_mfma_f32_16x16x32_bf16 v[168:171], v[68:71], v[80:83], v[168:171]
    v_mfma_f32_16x16x32_bf16 v[240:243], v[68:71], v[84:87], v[240:243]
    ds_read_b64_tr_b16 v[64:65], v13 offset:18688
    ds_read_b64_tr_b16 v[66:67], v13 offset:23296
    s_waitcnt lgkmcnt(8)
    v_mfma_f32_16x16x32_bf16 v[136:139], v[48:51], v[80:83], v[136:139]
    v_mfma_f32_16x16x32_bf16 v[208:211], v[48:51], v[84:87], v[208:211]
    ds_read_b64_tr_b16 v[68:69], v13 offset:27904
    ds_read_b64_tr_b16 v[70:71], v13 offset:32512
    s_waitcnt lgkmcnt(8)
    v_mfma_f32_16x16x32_bf16 v[172:175], v[52:55], v[80:83], v[172:175]
    v_mfma_f32_16x16x32_bf16 v[244:247], v[52:55], v[84:87], v[244:247]
    ds_read_b64_tr_b16 v[48:49], v13 offset:36864
    ds_read_b64_tr_b16 v[50:51], v13 offset:41472
    s_waitcnt lgkmcnt(8)
    v_mfma_f32_16x16x32_bf16 v[140:143], v[56:59], v[80:83], v[140:143]
    v_mfma_f32_16x16x32_bf16 v[212:215], v[56:59], v[84:87], v[212:215]
    ds_read_b64_tr_b16 v[52:53], v13 offset:46080
    ds_read_b64_tr_b16 v[54:55], v13 offset:50688
    s_waitcnt lgkmcnt(8)
    v_mfma_f32_16x16x32_bf16 v[176:179], v[60:63], v[80:83], v[176:179]
    v_mfma_f32_16x16x32_bf16 v[248:251], v[60:63], v[84:87], v[248:251]
    ds_read_b64_tr_b16 v[56:57], v13 offset:36896
    ds_read_b64_tr_b16 v[58:59], v13 offset:41504
    s_waitcnt lgkmcnt(8)
    v_mfma_f32_16x16x32_bf16 v[144:147], v[64:67], v[80:83], v[144:147]
    v_mfma_f32_16x16x32_bf16 v[216:219], v[64:67], v[84:87], v[216:219]
    ds_read_b64_tr_b16 v[60:61], v13 offset:46112
    ds_read_b64_tr_b16 v[62:63], v13 offset:50720
    s_waitcnt lgkmcnt(8)
    v_mfma_f32_16x16x32_bf16 v[180:183], v[68:71], v[80:83], v[180:183]
    v_mfma_f32_16x16x32_bf16 v[252:255], v[68:71], v[84:87], v[252:255]
    ds_read_b64_tr_b16 v[64:65], v13 offset:36928
    ds_read_b64_tr_b16 v[66:67], v13 offset:41536
    s_waitcnt lgkmcnt(8)
    v_mfma_f32_16x16x32_bf16 v[112:115], v[48:51], v[88:91], v[112:115]
    v_mfma_f32_16x16x32_bf16 v[184:187], v[48:51], v[92:95], v[184:187]
    ds_read_b64_tr_b16 v[68:69], v13 offset:46144
    ds_read_b64_tr_b16 v[70:71], v13 offset:50752
    s_waitcnt lgkmcnt(8)
    v_mfma_f32_16x16x32_bf16 v[148:151], v[52:55], v[88:91], v[148:151]
    v_mfma_f32_16x16x32_bf16 v[220:223], v[52:55], v[92:95], v[220:223]
    s_waitcnt vmcnt(7)
    s_barrier
    ds_read_b64_tr_b16 v[48:49], v13 offset:36960
    ds_read_b64_tr_b16 v[50:51], v13 offset:41568
    s_waitcnt lgkmcnt(8)
    v_mfma_f32_16x16x32_bf16 v[116:119], v[56:59], v[88:91], v[116:119]
    v_mfma_f32_16x16x32_bf16 v[188:191], v[56:59], v[92:95], v[188:191]
    s_add_u32 s30, s22, 18432
    s_add_u32 s29, s54, 2654208
    s_add_u32 m0, s30, 0
    s_mov_b64 exec, s[50:51]
    buffer_load_dwordx4 v10, s[8:11], s29 offen lds
    s_mov_b64 exec, -1
    s_add_u32 m0, s30, 768
    s_mov_b64 exec, s[50:51]
    buffer_load_dwordx4 v11, s[8:11], s29 offen lds
    s_mov_b64 exec, -1
    s_add_u32 m0, s30, 1536
    s_mov_b64 exec, s[50:51]
    buffer_load_dwordx4 v12, s[8:11], s29 offen lds
    s_mov_b64 exec, -1
    buffer_load_dwordx4 v[80:83], v3, s[12:15], s25 offen offset:2048 sc1
    buffer_load_dwordx4 v[84:87], v3, s[12:15], s26 offen offset:2048 sc1
    ds_read_b64_tr_b16 v[52:53], v13 offset:46176
    ds_read_b64_tr_b16 v[54:55], v13 offset:50784
    s_waitcnt lgkmcnt(8)
    v_mfma_f32_16x16x32_bf16 v[152:155], v[60:63], v[88:91], v[152:155]
    v_mfma_f32_16x16x32_bf16 v[224:227], v[60:63], v[92:95], v[224:227]
    ds_read_b64_tr_b16 v[56:57], v13 offset:36992
    ds_read_b64_tr_b16 v[58:59], v13 offset:41600
    s_waitcnt lgkmcnt(8)
    v_mfma_f32_16x16x32_bf16 v[120:123], v[64:67], v[88:91], v[120:123]
    v_mfma_f32_16x16x32_bf16 v[192:195], v[64:67], v[92:95], v[192:195]
    ds_read_b64_tr_b16 v[60:61], v13 offset:46208
    ds_read_b64_tr_b16 v[62:63], v13 offset:50816
    s_waitcnt lgkmcnt(8)
    v_mfma_f32_16x16x32_bf16 v[156:159], v[68:71], v[88:91], v[156:159]
    v_mfma_f32_16x16x32_bf16 v[228:231], v[68:71], v[92:95], v[228:231]
    ds_read_b64_tr_b16 v[64:65], v13 offset:37024
    ds_read_b64_tr_b16 v[66:67], v13 offset:41632
    s_waitcnt lgkmcnt(8)
    v_mfma_f32_16x16x32_bf16 v[124:127], v[48:51], v[88:91], v[124:127]
    v_mfma_f32_16x16x32_bf16 v[196:199], v[48:51], v[92:95], v[196:199]
    ds_read_b64_tr_b16 v[68:69], v13 offset:46240
    ds_read_b64_tr_b16 v[70:71], v13 offset:50848
    s_waitcnt lgkmcnt(8)
    v_mfma_f32_16x16x32_bf16 v[160:163], v[52:55], v[88:91], v[160:163]
    v_mfma_f32_16x16x32_bf16 v[232:235], v[52:55], v[92:95], v[232:235]
    ds_read_b64_tr_b16 v[48:49], v13 offset:37056
    ds_read_b64_tr_b16 v[50:51], v13 offset:41664
    s_waitcnt lgkmcnt(8)
    v_mfma_f32_16x16x32_bf16 v[128:131], v[56:59], v[88:91], v[128:131]
    v_mfma_f32_16x16x32_bf16 v[200:203], v[56:59], v[92:95], v[200:203]
    ds_read_b64_tr_b16 v[52:53], v13 offset:46272
    ds_read_b64_tr_b16 v[54:55], v13 offset:50880
    s_waitcnt lgkmcnt(8)
    v_mfma_f32_16x16x32_bf16 v[164:167], v[60:63], v[88:91], v[164:167]
    v_mfma_f32_16x16x32_bf16 v[236:239], v[60:63], v[92:95], v[236:239]
    ds_read_b64_tr_b16 v[56:57], v13 offset:37088
    ds_read_b64_tr_b16 v[58:59], v13 offset:41696
    s_waitcnt lgkmcnt(8)
    v_mfma_f32_16x16x32_bf16 v[132:135], v[64:67], v[88:91], v[132:135]
    v_mfma_f32_16x16x32_bf16 v[204:207], v[64:67], v[92:95], v[204:207]
    ds_read_b64_tr_b16 v[60:61], v13 offset:46304
    ds_read_b64_tr_b16 v[62:63], v13 offset:50912
    s_waitcnt lgkmcnt(8)
    v_mfma_f32_16x16x32_bf16 v[168:171], v[68:71], v[88:91], v[168:171]
    v_mfma_f32_16x16x32_bf16 v[240:243], v[68:71], v[92:95], v[240:243]
    ds_read_b64_tr_b16 v[64:65], v13 offset:37120
    ds_read_b64_tr_b16 v[66:67], v13 offset:41728
    s_waitcnt lgkmcnt(8)
    v_mfma_f32_16x16x32_bf16 v[136:139], v[48:51], v[88:91], v[136:139]
    v_mfma_f32_16x16x32_bf16 v[208:211], v[48:51], v[92:95], v[208:211]
    ds_read_b64_tr_b16 v[68:69], v13 offset:46336
    ds_read_b64_tr_b16 v[70:71], v13 offset:50944
    s_waitcnt lgkmcnt(8)
    v_mfma_f32_16x16x32_bf16 v[172:175], v[52:55], v[88:91], v[172:175]
    v_mfma_f32_16x16x32_bf16 v[244:247], v[52:55], v[92:95], v[244:247]
    ds_read_b64_tr_b16 v[48:49], v14 offset:0
    ds_read_b64_tr_b16 v[50:51], v14 offset:4608
    s_waitcnt lgkmcnt(8)
    v_mfma_f32_16x16x32_bf16 v[140:143], v[56:59], v[88:91], v[140:143]
    v_mfma_f32_16x16x32_bf16 v[212:215], v[56:59], v[92:95], v[212:215]
    ds_read_b64_tr_b16 v[52:53], v14 offset:9216
    ds_read_b64_tr_b16 v[54:55], v14 offset:13824
    s_waitcnt lgkmcnt(8)
    v_mfma_f32_16x16x32_bf16 v[176:179], v[60:63], v[88:91], v[176:179]
    v_mfma_f32_16x16x32_bf16 v[248:251], v[60:63], v[92:95], v[248:251]
    ds_read_b64_tr_b16 v[56:57], v14 offset:32
    ds_read_b64_tr_b16 v[58:59], v14 offset:4640
    s_waitcnt lgkmcnt(8)
    v_mfma_f32_16x16x32_bf16 v[144:147], v[64:67], v[88:91], v[144:147]
    v_mfma_f32_16x16x32_bf16 v[216:219], v[64:67], v[92:95], v[216:219]
    ds_read_b64_tr_b16 v[60:61], v14 offset:9248
    ds_read_b64_tr_b16 v[62:63], v14 offset:13856
    s_waitcnt lgkmcnt(8)
    v_mfma_f32_16x16x32_bf16 v[180:183], v[68:71], v[88:91], v[180:183]
    v_mfma_f32_16x16x32_bf16 v[252:255], v[68:71], v[92:95], v[252:255]
    ds_read_b64_tr_b16 v[64:65], v14 offset:64
    ds_read_b64_tr_b16 v[66:67], v14 offset:4672
    s_waitcnt lgkmcnt(8)
    v_mfma_f32_16x16x32_bf16 v[112:115], v[48:51], v[96:99], v[112:115]
    v_mfma_f32_16x16x32_bf16 v[184:187], v[48:51], v[100:103], v[184:187]
    ds_read_b64_tr_b16 v[68:69], v14 offset:9280
    ds_read_b64_tr_b16 v[70:71], v14 offset:13888
    s_waitcnt lgkmcnt(8)
    v_mfma_f32_16x16x32_bf16 v[148:151], v[52:55], v[96:99], v[148:151]
    v_mfma_f32_16x16x32_bf16 v[220:223], v[52:55], v[100:103], v[220:223]
    s_waitcnt vmcnt(7)
    s_barrier
    ds_read_b64_tr_b16 v[48:49], v14 offset:96
    ds_read_b64_tr_b16 v[50:51], v14 offset:4704
    s_waitcnt lgkmcnt(8)
    v_mfma_f32_16x16x32_bf16 v[116:119], v[56:59], v[96:99], v[116:119]
    v_mfma_f32_16x16x32_bf16 v[188:191], v[56:59], v[100:103], v[188:191]
    s_add_u32 s30, s22, 36864
    s_add_u32 s29, s54, 2949120
    s_add_u32 m0, s30, 0
    s_mov_b64 exec, s[50:51]
    buffer_load_dwordx4 v10, s[8:11], s29 offen lds
    s_mov_b64 exec, -1
    s_add_u32 m0, s30, 768
    s_mov_b64 exec, s[50:51]
    buffer_load_dwordx4 v11, s[8:11], s29 offen lds
    s_mov_b64 exec, -1
    s_add_u32 m0, s30, 1536
    s_mov_b64 exec, s[50:51]
    buffer_load_dwordx4 v12, s[8:11], s29 offen lds
    s_mov_b64 exec, -1
    buffer_load_dwordx4 v[88:91], v3, s[12:15], s25 offen offset:3072 sc1
    buffer_load_dwordx4 v[92:95], v3, s[12:15], s26 offen offset:3072 sc1
    ds_read_b64_tr_b16 v[52:53], v14 offset:9312
    ds_read_b64_tr_b16 v[54:55], v14 offset:13920
    s_waitcnt lgkmcnt(8)
    v_mfma_f32_16x16x32_bf16 v[152:155], v[60:63], v[96:99], v[152:155]
    v_mfma_f32_16x16x32_bf16 v[224:227], v[60:63], v[100:103], v[224:227]
    ds_read_b64_tr_b16 v[56:57], v14 offset:128
    ds_read_b64_tr_b16 v[58:59], v14 offset:4736
    s_waitcnt lgkmcnt(8)
    v_mfma_f32_16x16x32_bf16 v[120:123], v[64:67], v[96:99], v[120:123]
    v_mfma_f32_16x16x32_bf16 v[192:195], v[64:67], v[100:103], v[192:195]
    ds_read_b64_tr_b16 v[60:61], v14 offset:9344
    ds_read_b64_tr_b16 v[62:63], v14 offset:13952
    s_waitcnt lgkmcnt(8)
    v_mfma_f32_16x16x32_bf16 v[156:159], v[68:71], v[96:99], v[156:159]
    v_mfma_f32_16x16x32_bf16 v[228:231], v[68:71], v[100:103], v[228:231]
    ds_read_b64_tr_b16 v[64:65], v14 offset:160
    ds_read_b64_tr_b16 v[66:67], v14 offset:4768
    s_waitcnt lgkmcnt(8)
    v_mfma_f32_16x16x32_bf16 v[124:127], v[48:51], v[96:99], v[124:127]
    v_mfma_f32_16x16x32_bf16 v[196:199], v[48:51], v[100:103], v[196:199]
    ds_read_b64_tr_b16 v[68:69], v14 offset:9376
    ds_read_b64_tr_b16 v[70:71], v14 offset:13984
    s_waitcnt lgkmcnt(8)
    v_mfma_f32_16x16x32_bf16 v[160:163], v[52:55], v[96:99], v[160:163]
    v_mfma_f32_16x16x32_bf16 v[232:235], v[52:55], v[100:103], v[232:235]
    ds_read_b64_tr_b16 v[48:49], v14 offset:192
    ds_read_b64_tr_b16 v[50:51], v14 offset:4800
    s_waitcnt lgkmcnt(8)
    v_mfma_f32_16x16x32_bf16 v[128:131], v[56:59], v[96:99], v[128:131]
    v_mfma_f32_16x16x32_bf16 v[200:203], v[56:59], v[100:103], v[200:203]
    ds_read_b64_tr_b16 v[52:53], v14 offset:9408
    ds_read_b64_tr_b16 v[54:55], v14 offset:14016
    s_waitcnt lgkmcnt(8)
    v_mfma_f32_16x16x32_bf16 v[164:167], v[60:63], v[96:99], v[164:167]
    v_mfma_f32_16x16x32_bf16 v[236:239], v[60:63], v[100:103], v[236:239]
    ds_read_b64_tr_b16 v[56:57], v14 offset:224
    ds_read_b64_tr_b16 v[58:59], v14 offset:4832
    s_waitcnt lgkmcnt(8)
    v_mfma_f32_16x16x32_bf16 v[132:135], v[64:67], v[96:99], v[132:135]
    v_mfma_f32_16x16x32_bf16 v[204:207], v[64:67], v[100:103], v[204:207]
    ds_read_b64_tr_b16 v[60:61], v14 offset:9440
    ds_read_b64_tr_b16 v[62:63], v14 offset:14048
    s_waitcnt lgkmcnt(8)
    v_mfma_f32_16x16x32_bf16 v[168:171], v[68:71], v[96:99], v[168:171]
    v_mfma_f32_16x16x32_bf16 v[240:243], v[68:71], v[100:103], v[240:243]
    ds_read_b64_tr_b16 v[64:65], v14 offset:256
    ds_read_b64_tr_b16 v[66:67], v14 offset:4864
    s_waitcnt lgkmcnt(8)
    v_mfma_f32_16x16x32_bf16 v[136:139], v[48:51], v[96:99], v[136:139]
    v_mfma_f32_16x16x32_bf16 v[208:211], v[48:51], v[100:103], v[208:211]
    ds_read_b64_tr_b16 v[68:69], v14 offset:9472
    ds_read_b64_tr_b16 v[70:71], v14 offset:14080
    s_waitcnt lgkmcnt(8)
    v_mfma_f32_16x16x32_bf16 v[172:175], v[52:55], v[96:99], v[172:175]
    v_mfma_f32_16x16x32_bf16 v[244:247], v[52:55], v[100:103], v[244:247]
    ds_read_b64_tr_b16 v[48:49], v14 offset:18432
    ds_read_b64_tr_b16 v[50:51], v14 offset:23040
    s_waitcnt lgkmcnt(8)
    v_mfma_f32_16x16x32_bf16 v[140:143], v[56:59], v[96:99], v[140:143]
    v_mfma_f32_16x16x32_bf16 v[212:215], v[56:59], v[100:103], v[212:215]
    ds_read_b64_tr_b16 v[52:53], v14 offset:27648
    ds_read_b64_tr_b16 v[54:55], v14 offset:32256
    s_waitcnt lgkmcnt(8)
    v_mfma_f32_16x16x32_bf16 v[176:179], v[60:63], v[96:99], v[176:179]
    v_mfma_f32_16x16x32_bf16 v[248:251], v[60:63], v[100:103], v[248:251]
    ds_read_b64_tr_b16 v[56:57], v14 offset:18464
    ds_read_b64_tr_b16 v[58:59], v14 offset:23072
    s_waitcnt lgkmcnt(8)
    v_mfma_f32_16x16x32_bf16 v[144:147], v[64:67], v[96:99], v[144:147]
    v_mfma_f32_16x16x32_bf16 v[216:219], v[64:67], v[100:103], v[216:219]
    ds_read_b64_tr_b16 v[60:61], v14 offset:27680
    ds_read_b64_tr_b16 v[62:63], v14 offset:32288
    s_waitcnt lgkmcnt(8)
    v_mfma_f32_16x16x32_bf16 v[180:183], v[68:71], v[96:99], v[180:183]
    v_mfma_f32_16x16x32_bf16 v[252:255], v[68:71], v[100:103], v[252:255]
    ds_read_b64_tr_b16 v[64:65], v14 offset:18496
    ds_read_b64_tr_b16 v[66:67], v14 offset:23104
    s_waitcnt lgkmcnt(8)
    v_mfma_f32_16x16x32_bf16 v[112:115], v[48:51], v[104:107], v[112:115]
    v_mfma_f32_16x16x32_bf16 v[184:187], v[48:51], v[108:111], v[184:187]
    ds_read_b64_tr_b16 v[68:69], v14 offset:27712
    ds_read_b64_tr_b16 v[70:71], v14 offset:32320
    s_waitcnt lgkmcnt(8)
    v_mfma_f32_16x16x32_bf16 v[148:151], v[52:55], v[104:107], v[148:151]
    v_mfma_f32_16x16x32_bf16 v[220:223], v[52:55], v[108:111], v[220:223]
    s_waitcnt vmcnt(7)
    s_barrier
    ds_read_b64_tr_b16 v[48:49], v14 offset:18528
    ds_read_b64_tr_b16 v[50:51], v14 offset:23136
    s_waitcnt lgkmcnt(8)
    v_mfma_f32_16x16x32_bf16 v[116:119], v[56:59], v[104:107], v[116:119]
    v_mfma_f32_16x16x32_bf16 v[188:191], v[56:59], v[108:111], v[188:191]
    s_add_u32 s30, s22, 55296
    s_add_u32 s29, s54, 3244032
    s_add_u32 m0, s30, 0
    s_mov_b64 exec, s[50:51]
    buffer_load_dwordx4 v10, s[8:11], s29 offen lds
    s_mov_b64 exec, -1
    s_add_u32 m0, s30, 768
    s_mov_b64 exec, s[50:51]
    buffer_load_dwordx4 v11, s[8:11], s29 offen lds
    s_mov_b64 exec, -1
    s_add_u32 m0, s30, 1536
    s_mov_b64 exec, s[50:51]
    buffer_load_dwordx4 v12, s[8:11], s29 offen lds
    s_mov_b64 exec, -1
    s_add_u32 s25, s25, 4096
    s_add_u32 s26, s26, 4096
    buffer_load_dwordx4 v[96:99], v3, s[12:15], s25 offen offset:0 sc1
    buffer_load_dwordx4 v[100:103], v3, s[12:15], s26 offen offset:0 sc1
    ds_read_b64_tr_b16 v[52:53], v14 offset:27744
    ds_read_b64_tr_b16 v[54:55], v14 offset:32352
    s_waitcnt lgkmcnt(8)
    v_mfma_f32_16x16x32_bf16 v[152:155], v[60:63], v[104:107], v[152:155]
    v_mfma_f32_16x16x32_bf16 v[224:227], v[60:63], v[108:111], v[224:227]
    ds_read_b64_tr_b16 v[56:57], v14 offset:18560
    ds_read_b64_tr_b16 v[58:59], v14 offset:23168
    s_waitcnt lgkmcnt(8)
    v_mfma_f32_16x16x32_bf16 v[120:123], v[64:67], v[104:107], v[120:123]
    v_mfma_f32_16x16x32_bf16 v[192:195], v[64:67], v[108:111], v[192:195]
    ds_read_b64_tr_b16 v[60:61], v14 offset:27776
    ds_read_b64_tr_b16 v[62:63], v14 offset:32384
    s_waitcnt lgkmcnt(8)
    v_mfma_f32_16x16x32_bf16 v[156:159], v[68:71], v[104:107], v[156:159]
    v_mfma_f32_16x16x32_bf16 v[228:231], v[68:71], v[108:111], v[228:231]
    ds_read_b64_tr_b16 v[64:65], v14 offset:18592
    ds_read_b64_tr_b16 v[66:67], v14 offset:23200
    s_waitcnt lgkmcnt(8)
    v_mfma_f32_16x16x32_bf16 v[124:127], v[48:51], v[104:107], v[124:127]
    v_mfma_f32_16x16x32_bf16 v[196:199], v[48:51], v[108:111], v[196:199]
    ds_read_b64_tr_b16 v[68:69], v14 offset:27808
    ds_read_b64_tr_b16 v[70:71], v14 offset:32416
    s_waitcnt lgkmcnt(8)
    v_mfma_f32_16x16x32_bf16 v[160:163], v[52:55], v[104:107], v[160:163]
    v_mfma_f32_16x16x32_bf16 v[232:235], v[52:55], v[108:111], v[232:235]
    ds_read_b64_tr_b16 v[48:49], v14 offset:18624
    ds_read_b64_tr_b16 v[50:51], v14 offset:23232
    s_waitcnt lgkmcnt(8)
    v_mfma_f32_16x16x32_bf16 v[128:131], v[56:59], v[104:107], v[128:131]
    v_mfma_f32_16x16x32_bf16 v[200:203], v[56:59], v[108:111], v[200:203]
    ds_read_b64_tr_b16 v[52:53], v14 offset:27840
    ds_read_b64_tr_b16 v[54:55], v14 offset:32448
    s_waitcnt lgkmcnt(8)
    v_mfma_f32_16x16x32_bf16 v[164:167], v[60:63], v[104:107], v[164:167]
    v_mfma_f32_16x16x32_bf16 v[236:239], v[60:63], v[108:111], v[236:239]
    ds_read_b64_tr_b16 v[56:57], v14 offset:18656
    ds_read_b64_tr_b16 v[58:59], v14 offset:23264
    s_waitcnt lgkmcnt(8)
    v_mfma_f32_16x16x32_bf16 v[132:135], v[64:67], v[104:107], v[132:135]
    v_mfma_f32_16x16x32_bf16 v[204:207], v[64:67], v[108:111], v[204:207]
    ds_read_b64_tr_b16 v[60:61], v14 offset:27872
    ds_read_b64_tr_b16 v[62:63], v14 offset:32480
    s_waitcnt lgkmcnt(8)
    v_mfma_f32_16x16x32_bf16 v[168:171], v[68:71], v[104:107], v[168:171]
    v_mfma_f32_16x16x32_bf16 v[240:243], v[68:71], v[108:111], v[240:243]
    ds_read_b64_tr_b16 v[64:65], v14 offset:18688
    ds_read_b64_tr_b16 v[66:67], v14 offset:23296
    s_waitcnt lgkmcnt(8)
    v_mfma_f32_16x16x32_bf16 v[136:139], v[48:51], v[104:107], v[136:139]
    v_mfma_f32_16x16x32_bf16 v[208:211], v[48:51], v[108:111], v[208:211]
    ds_read_b64_tr_b16 v[68:69], v14 offset:27904
    ds_read_b64_tr_b16 v[70:71], v14 offset:32512
    s_waitcnt lgkmcnt(8)
    v_mfma_f32_16x16x32_bf16 v[172:175], v[52:55], v[104:107], v[172:175]
    v_mfma_f32_16x16x32_bf16 v[244:247], v[52:55], v[108:111], v[244:247]
    ds_read_b64_tr_b16 v[48:49], v14 offset:36864
    ds_read_b64_tr_b16 v[50:51], v14 offset:41472
    s_waitcnt lgkmcnt(8)
    v_mfma_f32_16x16x32_bf16 v[140:143], v[56:59], v[104:107], v[140:143]
    v_mfma_f32_16x16x32_bf16 v[212:215], v[56:59], v[108:111], v[212:215]
    ds_read_b64_tr_b16 v[52:53], v14 offset:46080
    ds_read_b64_tr_b16 v[54:55], v14 offset:50688
    s_waitcnt lgkmcnt(8)
    v_mfma_f32_16x16x32_bf16 v[176:179], v[60:63], v[104:107], v[176:179]
    v_mfma_f32_16x16x32_bf16 v[248:251], v[60:63], v[108:111], v[248:251]
    ds_read_b64_tr_b16 v[56:57], v14 offset:36896
    ds_read_b64_tr_b16 v[58:59], v14 offset:41504
    s_waitcnt lgkmcnt(8)
    v_mfma_f32_16x16x32_bf16 v[144:147], v[64:67], v[104:107], v[144:147]
    v_mfma_f32_16x16x32_bf16 v[216:219], v[64:67], v[108:111], v[216:219]
    ds_read_b64_tr_b16 v[60:61], v14 offset:46112
    ds_read_b64_tr_b16 v[62:63], v14 offset:50720
    s_waitcnt lgkmcnt(8)
    v_mfma_f32_16x16x32_bf16 v[180:183], v[68:71], v[104:107], v[180:183]
    v_mfma_f32_16x16x32_bf16 v[252:255], v[68:71], v[108:111], v[252:255]
    ds_read_b64_tr_b16 v[64:65], v14 offset:36928
    ds_read_b64_tr_b16 v[66:67], v14 offset:41536
    s_waitcnt lgkmcnt(8)
    v_mfma_f32_16x16x32_bf16 v[112:115], v[48:51], v[72:75], v[112:115]
    v_mfma_f32_16x16x32_bf16 v[184:187], v[48:51], v[76:79], v[184:187]
    ds_read_b64_tr_b16 v[68:69], v14 offset:46144
    ds_read_b64_tr_b16 v[70:71], v14 offset:50752
    s_waitcnt lgkmcnt(8)
    v_mfma_f32_16x16x32_bf16 v[148:151], v[52:55], v[72:75], v[148:151]
    v_mfma_f32_16x16x32_bf16 v[220:223], v[52:55], v[76:79], v[220:223]
    s_waitcnt vmcnt(7)
    s_barrier
    ds_read_b64_tr_b16 v[48:49], v14 offset:36960
    ds_read_b64_tr_b16 v[50:51], v14 offset:41568
    s_waitcnt lgkmcnt(8)
    v_mfma_f32_16x16x32_bf16 v[116:119], v[56:59], v[72:75], v[116:119]
    v_mfma_f32_16x16x32_bf16 v[188:191], v[56:59], v[76:79], v[188:191]
    s_add_u32 s30, s22, 73728
    s_add_u32 s29, s54, 3538944
    s_add_u32 m0, s30, 0
    s_mov_b64 exec, s[50:51]
    buffer_load_dwordx4 v10, s[8:11], s29 offen lds
    s_mov_b64 exec, -1
    s_add_u32 m0, s30, 768
    s_mov_b64 exec, s[50:51]
    buffer_load_dwordx4 v11, s[8:11], s29 offen lds
    s_mov_b64 exec, -1
    s_add_u32 m0, s30, 1536
    s_mov_b64 exec, s[50:51]
    buffer_load_dwordx4 v12, s[8:11], s29 offen lds
    s_mov_b64 exec, -1
    buffer_load_dwordx4 v[104:107], v3, s[12:15], s25 offen offset:1024 sc1
    buffer_load_dwordx4 v[108:111], v3, s[12:15], s26 offen offset:1024 sc1
    ds_read_b64_tr_b16 v[52:53], v14 offset:46176
    ds_read_b64_tr_b16 v[54:55], v14 offset:50784
    s_waitcnt lgkmcnt(8)
    v_mfma_f32_16x16x32_bf16 v[152:155], v[60:63], v[72:75], v[152:155]
    v_mfma_f32_16x16x32_bf16 v[224:227], v[60:63], v[76:79], v[224:227]
    ds_read_b64_tr_b16 v[56:57], v14 offset:36992
    ds_read_b64_tr_b16 v[58:59], v14 offset:41600
    s_waitcnt lgkmcnt(8)
    v_mfma_f32_16x16x32_bf16 v[120:123], v[64:67], v[72:75], v[120:123]
    v_mfma_f32_16x16x32_bf16 v[192:195], v[64:67], v[76:79], v[192:195]
    ds_read_b64_tr_b16 v[60:61], v14 offset:46208
    ds_read_b64_tr_b16 v[62:63], v14 offset:50816
    s_waitcnt lgkmcnt(8)
    v_mfma_f32_16x16x32_bf16 v[156:159], v[68:71], v[72:75], v[156:159]
    v_mfma_f32_16x16x32_bf16 v[228:231], v[68:71], v[76:79], v[228:231]
    ds_read_b64_tr_b16 v[64:65], v14 offset:37024
    ds_read_b64_tr_b16 v[66:67], v14 offset:41632
    s_waitcnt lgkmcnt(8)
    v_mfma_f32_16x16x32_bf16 v[124:127], v[48:51], v[72:75], v[124:127]
    v_mfma_f32_16x16x32_bf16 v[196:199], v[48:51], v[76:79], v[196:199]
    ds_read_b64_tr_b16 v[68:69], v14 offset:46240
    ds_read_b64_tr_b16 v[70:71], v14 offset:50848
    s_waitcnt lgkmcnt(8)
    v_mfma_f32_16x16x32_bf16 v[160:163], v[52:55], v[72:75], v[160:163]
    v_mfma_f32_16x16x32_bf16 v[232:235], v[52:55], v[76:79], v[232:235]
    ds_read_b64_tr_b16 v[48:49], v14 offset:37056
    ds_read_b64_tr_b16 v[50:51], v14 offset:41664
    s_waitcnt lgkmcnt(8)
    v_mfma_f32_16x16x32_bf16 v[128:131], v[56:59], v[72:75], v[128:131]
    v_mfma_f32_16x16x32_bf16 v[200:203], v[56:59], v[76:79], v[200:203]
    ds_read_b64_tr_b16 v[52:53], v14 offset:46272
    ds_read_b64_tr_b16 v[54:55], v14 offset:50880
    s_waitcnt lgkmcnt(8)
    v_mfma_f32_16x16x32_bf16 v[164:167], v[60:63], v[72:75], v[164:167]
    v_mfma_f32_16x16x32_bf16 v[236:239], v[60:63], v[76:79], v[236:239]
    ds_read_b64_tr_b16 v[56:57], v14 offset:37088
    ds_read_b64_tr_b16 v[58:59], v14 offset:41696
    s_waitcnt lgkmcnt(8)
    v_mfma_f32_16x16x32_bf16 v[132:135], v[64:67], v[72:75], v[132:135]
    v_mfma_f32_16x16x32_bf16 v[204:207], v[64:67], v[76:79], v[204:207]
    ds_read_b64_tr_b16 v[60:61], v14 offset:46304
    ds_read_b64_tr_b16 v[62:63], v14 offset:50912
    s_waitcnt lgkmcnt(8)
    v_mfma_f32_16x16x32_bf16 v[168:171], v[68:71], v[72:75], v[168:171]
    v_mfma_f32_16x16x32_bf16 v[240:243], v[68:71], v[76:79], v[240:243]
    ds_read_b64_tr_b16 v[64:65], v14 offset:37120
    ds_read_b64_tr_b16 v[66:67], v14 offset:41728
    s_waitcnt lgkmcnt(8)
    v_mfma_f32_16x16x32_bf16 v[136:139], v[48:51], v[72:75], v[136:139]
    v_mfma_f32_16x16x32_bf16 v[208:211], v[48:51], v[76:79], v[208:211]
    ds_read_b64_tr_b16 v[68:69], v14 offset:46336
    ds_read_b64_tr_b16 v[70:71], v14 offset:50944
    s_waitcnt lgkmcnt(8)
    v_mfma_f32_16x16x32_bf16 v[172:175], v[52:55], v[72:75], v[172:175]
    v_mfma_f32_16x16x32_bf16 v[244:247], v[52:55], v[76:79], v[244:247]
    ds_read_b64_tr_b16 v[48:49], v15 offset:0
    ds_read_b64_tr_b16 v[50:51], v15 offset:4608
    s_waitcnt lgkmcnt(8)
    v_mfma_f32_16x16x32_bf16 v[140:143], v[56:59], v[72:75], v[140:143]
    v_mfma_f32_16x16x32_bf16 v[212:215], v[56:59], v[76:79], v[212:215]
    ds_read_b64_tr_b16 v[52:53], v15 offset:9216
    ds_read_b64_tr_b16 v[54:55], v15 offset:13824
    s_waitcnt lgkmcnt(8)
    v_mfma_f32_16x16x32_bf16 v[176:179], v[60:63], v[72:75], v[176:179]
    v_mfma_f32_16x16x32_bf16 v[248:251], v[60:63], v[76:79], v[248:251]
    ds_read_b64_tr_b16 v[56:57], v15 offset:32
    ds_read_b64_tr_b16 v[58:59], v15 offset:4640
    s_waitcnt lgkmcnt(8)
    v_mfma_f32_16x16x32_bf16 v[144:147], v[64:67], v[72:75], v[144:147]
    v_mfma_f32_16x16x32_bf16 v[216:219], v[64:67], v[76:79], v[216:219]
    ds_read_b64_tr_b16 v[60:61], v15 offset:9248
    ds_read_b64_tr_b16 v[62:63], v15 offset:13856
    s_waitcnt lgkmcnt(8)
    v_mfma_f32_16x16x32_bf16 v[180:183], v[68:71], v[72:75], v[180:183]
    v_mfma_f32_16x16x32_bf16 v[252:255], v[68:71], v[76:79], v[252:255]
    ds_read_b64_tr_b16 v[64:65], v15 offset:64
    ds_read_b64_tr_b16 v[66:67], v15 offset:4672
    s_waitcnt lgkmcnt(8)
    v_mfma_f32_16x16x32_bf16 v[112:115], v[48:51], v[80:83], v[112:115]
    v_mfma_f32_16x16x32_bf16 v[184:187], v[48:51], v[84:87], v[184:187]
    ds_read_b64_tr_b16 v[68:69], v15 offset:9280
    ds_read_b64_tr_b16 v[70:71], v15 offset:13888
    s_waitcnt lgkmcnt(8)
    v_mfma_f32_16x16x32_bf16 v[148:151], v[52:55], v[80:83], v[148:151]
    v_mfma_f32_16x16x32_bf16 v[220:223], v[52:55], v[84:87], v[220:223]
    s_waitcnt vmcnt(7)
    s_barrier
    ds_read_b64_tr_b16 v[48:49], v15 offset:96
    ds_read_b64_tr_b16 v[50:51], v15 offset:4704
    s_waitcnt lgkmcnt(8)
    v_mfma_f32_16x16x32_bf16 v[116:119], v[56:59], v[80:83], v[116:119]
    v_mfma_f32_16x16x32_bf16 v[188:191], v[56:59], v[84:87], v[188:191]
    s_add_u32 s30, s22, 92160
    s_add_u32 s29, s54, 3981312
    s_add_u32 m0, s30, 0
    s_mov_b64 exec, s[50:51]
    buffer_load_dwordx4 v10, s[8:11], s29 offen lds
    s_mov_b64 exec, -1
    s_add_u32 m0, s30, 768
    s_mov_b64 exec, s[50:51]
    buffer_load_dwordx4 v11, s[8:11], s29 offen lds
    s_mov_b64 exec, -1
    s_add_u32 m0, s30, 1536
    s_mov_b64 exec, s[50:51]
    buffer_load_dwordx4 v12, s[8:11], s29 offen lds
    s_mov_b64 exec, -1
    buffer_load_dwordx4 v[72:75], v3, s[12:15], s25 offen offset:2048 sc1
    buffer_load_dwordx4 v[76:79], v3, s[12:15], s26 offen offset:2048 sc1
    ds_read_b64_tr_b16 v[52:53], v15 offset:9312
    ds_read_b64_tr_b16 v[54:55], v15 offset:13920
    s_waitcnt lgkmcnt(8)
    v_mfma_f32_16x16x32_bf16 v[152:155], v[60:63], v[80:83], v[152:155]
    v_mfma_f32_16x16x32_bf16 v[224:227], v[60:63], v[84:87], v[224:227]
    ds_read_b64_tr_b16 v[56:57], v15 offset:128
    ds_read_b64_tr_b16 v[58:59], v15 offset:4736
    s_waitcnt lgkmcnt(8)
    v_mfma_f32_16x16x32_bf16 v[120:123], v[64:67], v[80:83], v[120:123]
    v_mfma_f32_16x16x32_bf16 v[192:195], v[64:67], v[84:87], v[192:195]
    ds_read_b64_tr_b16 v[60:61], v15 offset:9344
    ds_read_b64_tr_b16 v[62:63], v15 offset:13952
    s_waitcnt lgkmcnt(8)
    v_mfma_f32_16x16x32_bf16 v[156:159], v[68:71], v[80:83], v[156:159]
    v_mfma_f32_16x16x32_bf16 v[228:231], v[68:71], v[84:87], v[228:231]
    ds_read_b64_tr_b16 v[64:65], v15 offset:160
    ds_read_b64_tr_b16 v[66:67], v15 offset:4768
    s_waitcnt lgkmcnt(8)
    v_mfma_f32_16x16x32_bf16 v[124:127], v[48:51], v[80:83], v[124:127]
    v_mfma_f32_16x16x32_bf16 v[196:199], v[48:51], v[84:87], v[196:199]
    ds_read_b64_tr_b16 v[68:69], v15 offset:9376
    ds_read_b64_tr_b16 v[70:71], v15 offset:13984
    s_waitcnt lgkmcnt(8)
    v_mfma_f32_16x16x32_bf16 v[160:163], v[52:55], v[80:83], v[160:163]
    v_mfma_f32_16x16x32_bf16 v[232:235], v[52:55], v[84:87], v[232:235]
    ds_read_b64_tr_b16 v[48:49], v15 offset:192
    ds_read_b64_tr_b16 v[50:51], v15 offset:4800
    s_waitcnt lgkmcnt(8)
    v_mfma_f32_16x16x32_bf16 v[128:131], v[56:59], v[80:83], v[128:131]
    v_mfma_f32_16x16x32_bf16 v[200:203], v[56:59], v[84:87], v[200:203]
    ds_read_b64_tr_b16 v[52:53], v15 offset:9408
    ds_read_b64_tr_b16 v[54:55], v15 offset:14016
    s_waitcnt lgkmcnt(8)
    v_mfma_f32_16x16x32_bf16 v[164:167], v[60:63], v[80:83], v[164:167]
    v_mfma_f32_16x16x32_bf16 v[236:239], v[60:63], v[84:87], v[236:239]
    ds_read_b64_tr_b16 v[56:57], v15 offset:224
    ds_read_b64_tr_b16 v[58:59], v15 offset:4832
    s_waitcnt lgkmcnt(8)
    v_mfma_f32_16x16x32_bf16 v[132:135], v[64:67], v[80:83], v[132:135]
    v_mfma_f32_16x16x32_bf16 v[204:207], v[64:67], v[84:87], v[204:207]
    ds_read_b64_tr_b16 v[60:61], v15 offset:9440
    ds_read_b64_tr_b16 v[62:63], v15 offset:14048
    s_waitcnt lgkmcnt(8)
    v_mfma_f32_16x16x32_bf16 v[168:171], v[68:71], v[80:83], v[168:171]
    v_mfma_f32_16x16x32_bf16 v[240:243], v[68:71], v[84:87], v[240:243]
    ds_read_b64_tr_b16 v[64:65], v15 offset:256
    ds_read_b64_tr_b16 v[66:67], v15 offset:4864
    s_waitcnt lgkmcnt(8)
    v_mfma_f32_16x16x32_bf16 v[136:139], v[48:51], v[80:83], v[136:139]
    v_mfma_f32_16x16x32_bf16 v[208:211], v[48:51], v[84:87], v[208:211]
    ds_read_b64_tr_b16 v[68:69], v15 offset:9472
    ds_read_b64_tr_b16 v[70:71], v15 offset:14080
    s_waitcnt lgkmcnt(8)
    v_mfma_f32_16x16x32_bf16 v[172:175], v[52:55], v[80:83], v[172:175]
    v_mfma_f32_16x16x32_bf16 v[244:247], v[52:55], v[84:87], v[244:247]
    ds_read_b64_tr_b16 v[48:49], v15 offset:18432
    ds_read_b64_tr_b16 v[50:51], v15 offset:23040
    s_waitcnt lgkmcnt(8)
    v_mfma_f32_16x16x32_bf16 v[140:143], v[56:59], v[80:83], v[140:143]
    v_mfma_f32_16x16x32_bf16 v[212:215], v[56:59], v[84:87], v[212:215]
    ds_read_b64_tr_b16 v[52:53], v15 offset:27648
    ds_read_b64_tr_b16 v[54:55], v15 offset:32256
    s_waitcnt lgkmcnt(8)
    v_mfma_f32_16x16x32_bf16 v[176:179], v[60:63], v[80:83], v[176:179]
    v_mfma_f32_16x16x32_bf16 v[248:251], v[60:63], v[84:87], v[248:251]
    ds_read_b64_tr_b16 v[56:57], v15 offset:18464
    ds_read_b64_tr_b16 v[58:59], v15 offset:23072
    s_waitcnt lgkmcnt(8)
    v_mfma_f32_16x16x32_bf16 v[144:147], v[64:67], v[80:83], v[144:147]
    v_mfma_f32_16x16x32_bf16 v[216:219], v[64:67], v[84:87], v[216:219]
    ds_read_b64_tr_b16 v[60:61], v15 offset:27680
    ds_read_b64_tr_b16 v[62:63], v15 offset:32288
    s_waitcnt lgkmcnt(8)
    v_mfma_f32_16x16x32_bf16 v[180:183], v[68:71], v[80:83], v[180:183]
    v_mfma_f32_16x16x32_bf16 v[252:255], v[68:71], v[84:87], v[252:255]
    ds_read_b64_tr_b16 v[64:65], v15 offset:18496
    ds_read_b64_tr_b16 v[66:67], v15 offset:23104
    s_waitcnt lgkmcnt(8)
    v_mfma_f32_16x16x32_bf16 v[112:115], v[48:51], v[88:91], v[112:115]
    v_mfma_f32_16x16x32_bf16 v[184:187], v[48:51], v[92:95], v[184:187]
    ds_read_b64_tr_b16 v[68:69], v15 offset:27712
    ds_read_b64_tr_b16 v[70:71], v15 offset:32320
    s_waitcnt lgkmcnt(8)
    v_mfma_f32_16x16x32_bf16 v[148:151], v[52:55], v[88:91], v[148:151]
    v_mfma_f32_16x16x32_bf16 v[220:223], v[52:55], v[92:95], v[220:223]
    s_waitcnt vmcnt(7)
    s_barrier
    ds_read_b64_tr_b16 v[48:49], v15 offset:18528
    ds_read_b64_tr_b16 v[50:51], v15 offset:23136
    s_waitcnt lgkmcnt(8)
    v_mfma_f32_16x16x32_bf16 v[116:119], v[56:59], v[88:91], v[116:119]
    v_mfma_f32_16x16x32_bf16 v[188:191], v[56:59], v[92:95], v[188:191]
    s_add_u32 s30, s22, 110592
    s_add_u32 s29, s54, 4276224
    s_add_u32 m0, s30, 0
    s_mov_b64 exec, s[50:51]
    buffer_load_dwordx4 v10, s[8:11], s29 offen lds
    s_mov_b64 exec, -1
    s_add_u32 m0, s30, 768
    s_mov_b64 exec, s[50:51]
    buffer_load_dwordx4 v11, s[8:11], s29 offen lds
    s_mov_b64 exec, -1
    s_add_u32 m0, s30, 1536
    s_mov_b64 exec, s[50:51]
    buffer_load_dwordx4 v12, s[8:11], s29 offen lds
    s_mov_b64 exec, -1
    buffer_load_dwordx4 v[80:83], v3, s[12:15], s25 offen offset:3072 sc1
    buffer_load_dwordx4 v[84:87], v3, s[12:15], s26 offen offset:3072 sc1
    ds_read_b64_tr_b16 v[52:53], v15 offset:27744
    ds_read_b64_tr_b16 v[54:55], v15 offset:32352
    s_waitcnt lgkmcnt(8)
    v_mfma_f32_16x16x32_bf16 v[152:155], v[60:63], v[88:91], v[152:155]
    v_mfma_f32_16x16x32_bf16 v[224:227], v[60:63], v[92:95], v[224:227]
    ds_read_b64_tr_b16 v[56:57], v15 offset:18560
    ds_read_b64_tr_b16 v[58:59], v15 offset:23168
    s_waitcnt lgkmcnt(8)
    v_mfma_f32_16x16x32_bf16 v[120:123], v[64:67], v[88:91], v[120:123]
    v_mfma_f32_16x16x32_bf16 v[192:195], v[64:67], v[92:95], v[192:195]
    ds_read_b64_tr_b16 v[60:61], v15 offset:27776
    ds_read_b64_tr_b16 v[62:63], v15 offset:32384
    s_waitcnt lgkmcnt(8)
    v_mfma_f32_16x16x32_bf16 v[156:159], v[68:71], v[88:91], v[156:159]
    v_mfma_f32_16x16x32_bf16 v[228:231], v[68:71], v[92:95], v[228:231]
    ds_read_b64_tr_b16 v[64:65], v15 offset:18592
    ds_read_b64_tr_b16 v[66:67], v15 offset:23200
    s_waitcnt lgkmcnt(8)
    v_mfma_f32_16x16x32_bf16 v[124:127], v[48:51], v[88:91], v[124:127]
    v_mfma_f32_16x16x32_bf16 v[196:199], v[48:51], v[92:95], v[196:199]
    ds_read_b64_tr_b16 v[68:69], v15 offset:27808
    ds_read_b64_tr_b16 v[70:71], v15 offset:32416
    s_waitcnt lgkmcnt(8)
    v_mfma_f32_16x16x32_bf16 v[160:163], v[52:55], v[88:91], v[160:163]
    v_mfma_f32_16x16x32_bf16 v[232:235], v[52:55], v[92:95], v[232:235]
    ds_read_b64_tr_b16 v[48:49], v15 offset:18624
    ds_read_b64_tr_b16 v[50:51], v15 offset:23232
    s_waitcnt lgkmcnt(8)
    v_mfma_f32_16x16x32_bf16 v[128:131], v[56:59], v[88:91], v[128:131]
    v_mfma_f32_16x16x32_bf16 v[200:203], v[56:59], v[92:95], v[200:203]
    ds_read_b64_tr_b16 v[52:53], v15 offset:27840
    ds_read_b64_tr_b16 v[54:55], v15 offset:32448
    s_waitcnt lgkmcnt(8)
    v_mfma_f32_16x16x32_bf16 v[164:167], v[60:63], v[88:91], v[164:167]
    v_mfma_f32_16x16x32_bf16 v[236:239], v[60:63], v[92:95], v[236:239]
    ds_read_b64_tr_b16 v[56:57], v15 offset:18656
    ds_read_b64_tr_b16 v[58:59], v15 offset:23264
    s_waitcnt lgkmcnt(8)
    v_mfma_f32_16x16x32_bf16 v[132:135], v[64:67], v[88:91], v[132:135]
    v_mfma_f32_16x16x32_bf16 v[204:207], v[64:67], v[92:95], v[204:207]
    ds_read_b64_tr_b16 v[60:61], v15 offset:27872
    ds_read_b64_tr_b16 v[62:63], v15 offset:32480
    s_waitcnt lgkmcnt(8)
    v_mfma_f32_16x16x32_bf16 v[168:171], v[68:71], v[88:91], v[168:171]
    v_mfma_f32_16x16x32_bf16 v[240:243], v[68:71], v[92:95], v[240:243]
    ds_read_b64_tr_b16 v[64:65], v15 offset:18688
    ds_read_b64_tr_b16 v[66:67], v15 offset:23296
    s_waitcnt lgkmcnt(8)
    v_mfma_f32_16x16x32_bf16 v[136:139], v[48:51], v[88:91], v[136:139]
    v_mfma_f32_16x16x32_bf16 v[208:211], v[48:51], v[92:95], v[208:211]
    ds_read_b64_tr_b16 v[68:69], v15 offset:27904
    ds_read_b64_tr_b16 v[70:71], v15 offset:32512
    s_waitcnt lgkmcnt(8)
    v_mfma_f32_16x16x32_bf16 v[172:175], v[52:55], v[88:91], v[172:175]
    v_mfma_f32_16x16x32_bf16 v[244:247], v[52:55], v[92:95], v[244:247]
    ds_read_b64_tr_b16 v[48:49], v13 offset:0
    ds_read_b64_tr_b16 v[50:51], v13 offset:4608
    s_waitcnt lgkmcnt(8)
    v_mfma_f32_16x16x32_bf16 v[140:143], v[56:59], v[88:91], v[140:143]
    v_mfma_f32_16x16x32_bf16 v[212:215], v[56:59], v[92:95], v[212:215]
    ds_read_b64_tr_b16 v[52:53], v13 offset:9216
    ds_read_b64_tr_b16 v[54:55], v13 offset:13824
    s_waitcnt lgkmcnt(8)
    v_mfma_f32_16x16x32_bf16 v[176:179], v[60:63], v[88:91], v[176:179]
    v_mfma_f32_16x16x32_bf16 v[248:251], v[60:63], v[92:95], v[248:251]
    ds_read_b64_tr_b16 v[56:57], v13 offset:32
    ds_read_b64_tr_b16 v[58:59], v13 offset:4640
    s_waitcnt lgkmcnt(8)
    v_mfma_f32_16x16x32_bf16 v[144:147], v[64:67], v[88:91], v[144:147]
    v_mfma_f32_16x16x32_bf16 v[216:219], v[64:67], v[92:95], v[216:219]
    ds_read_b64_tr_b16 v[60:61], v13 offset:9248
    ds_read_b64_tr_b16 v[62:63], v13 offset:13856
    s_waitcnt lgkmcnt(8)
    v_mfma_f32_16x16x32_bf16 v[180:183], v[68:71], v[88:91], v[180:183]
    v_mfma_f32_16x16x32_bf16 v[252:255], v[68:71], v[92:95], v[252:255]
    ds_read_b64_tr_b16 v[64:65], v13 offset:64
    ds_read_b64_tr_b16 v[66:67], v13 offset:4672
    s_waitcnt lgkmcnt(8)
    v_mfma_f32_16x16x32_bf16 v[112:115], v[48:51], v[96:99], v[112:115]
    v_mfma_f32_16x16x32_bf16 v[184:187], v[48:51], v[100:103], v[184:187]
    ds_read_b64_tr_b16 v[68:69], v13 offset:9280
    ds_read_b64_tr_b16 v[70:71], v13 offset:13888
    s_waitcnt lgkmcnt(8)
    v_mfma_f32_16x16x32_bf16 v[148:151], v[52:55], v[96:99], v[148:151]
    v_mfma_f32_16x16x32_bf16 v[220:223], v[52:55], v[100:103], v[220:223]
    s_waitcnt vmcnt(7)
    s_barrier
    ds_read_b64_tr_b16 v[48:49], v13 offset:96
    ds_read_b64_tr_b16 v[50:51], v13 offset:4704
    s_waitcnt lgkmcnt(8)
    v_mfma_f32_16x16x32_bf16 v[116:119], v[56:59], v[96:99], v[116:119]
    v_mfma_f32_16x16x32_bf16 v[188:191], v[56:59], v[100:103], v[188:191]
    s_add_u32 s30, s22, 129024
    s_add_u32 s29, s54, 4571136
    s_add_u32 m0, s30, 0
    s_mov_b64 exec, s[50:51]
    buffer_load_dwordx4 v10, s[8:11], s29 offen lds
    s_mov_b64 exec, -1
    s_add_u32 m0, s30, 768
    s_mov_b64 exec, s[50:51]
    buffer_load_dwordx4 v11, s[8:11], s29 offen lds
    s_mov_b64 exec, -1
    s_add_u32 m0, s30, 1536
    s_mov_b64 exec, s[50:51]
    buffer_load_dwordx4 v12, s[8:11], s29 offen lds
    s_mov_b64 exec, -1
    s_add_u32 s25, s25, 4096
    s_add_u32 s26, s26, 4096
    buffer_load_dwordx4 v[88:91], v3, s[12:15], s25 offen offset:0 sc1
    buffer_load_dwordx4 v[92:95], v3, s[12:15], s26 offen offset:0 sc1
    ds_read_b64_tr_b16 v[52:53], v13 offset:9312
    ds_read_b64_tr_b16 v[54:55], v13 offset:13920
    s_waitcnt lgkmcnt(8)
    v_mfma_f32_16x16x32_bf16 v[152:155], v[60:63], v[96:99], v[152:155]
    v_mfma_f32_16x16x32_bf16 v[224:227], v[60:63], v[100:103], v[224:227]
    ds_read_b64_tr_b16 v[56:57], v13 offset:128
    ds_read_b64_tr_b16 v[58:59], v13 offset:4736
    s_waitcnt lgkmcnt(8)
    v_mfma_f32_16x16x32_bf16 v[120:123], v[64:67], v[96:99], v[120:123]
    v_mfma_f32_16x16x32_bf16 v[192:195], v[64:67], v[100:103], v[192:195]
    ds_read_b64_tr_b16 v[60:61], v13 offset:9344
    ds_read_b64_tr_b16 v[62:63], v13 offset:13952
    s_waitcnt lgkmcnt(8)
    v_mfma_f32_16x16x32_bf16 v[156:159], v[68:71], v[96:99], v[156:159]
    v_mfma_f32_16x16x32_bf16 v[228:231], v[68:71], v[100:103], v[228:231]
    ds_read_b64_tr_b16 v[64:65], v13 offset:160
    ds_read_b64_tr_b16 v[66:67], v13 offset:4768
    s_waitcnt lgkmcnt(8)
    v_mfma_f32_16x16x32_bf16 v[124:127], v[48:51], v[96:99], v[124:127]
    v_mfma_f32_16x16x32_bf16 v[196:199], v[48:51], v[100:103], v[196:199]
    ds_read_b64_tr_b16 v[68:69], v13 offset:9376
    ds_read_b64_tr_b16 v[70:71], v13 offset:13984
    s_waitcnt lgkmcnt(8)
    v_mfma_f32_16x16x32_bf16 v[160:163], v[52:55], v[96:99], v[160:163]
    v_mfma_f32_16x16x32_bf16 v[232:235], v[52:55], v[100:103], v[232:235]
    ds_read_b64_tr_b16 v[48:49], v13 offset:192
    ds_read_b64_tr_b16 v[50:51], v13 offset:4800
    s_waitcnt lgkmcnt(8)
    v_mfma_f32_16x16x32_bf16 v[128:131], v[56:59], v[96:99], v[128:131]
    v_mfma_f32_16x16x32_bf16 v[200:203], v[56:59], v[100:103], v[200:203]
    ds_read_b64_tr_b16 v[52:53], v13 offset:9408
    ds_read_b64_tr_b16 v[54:55], v13 offset:14016
    s_waitcnt lgkmcnt(8)
    v_mfma_f32_16x16x32_bf16 v[164:167], v[60:63], v[96:99], v[164:167]
    v_mfma_f32_16x16x32_bf16 v[236:239], v[60:63], v[100:103], v[236:239]
    ds_read_b64_tr_b16 v[56:57], v13 offset:224
    ds_read_b64_tr_b16 v[58:59], v13 offset:4832
    s_waitcnt lgkmcnt(8)
    v_mfma_f32_16x16x32_bf16 v[132:135], v[64:67], v[96:99], v[132:135]
    v_mfma_f32_16x16x32_bf16 v[204:207], v[64:67], v[100:103], v[204:207]
    ds_read_b64_tr_b16 v[60:61], v13 offset:9440
    ds_read_b64_tr_b16 v[62:63], v13 offset:14048
    s_waitcnt lgkmcnt(8)
    v_mfma_f32_16x16x32_bf16 v[168:171], v[68:71], v[96:99], v[168:171]
    v_mfma_f32_16x16x32_bf16 v[240:243], v[68:71], v[100:103], v[240:243]
    ds_read_b64_tr_b16 v[64:65], v13 offset:256
    ds_read_b64_tr_b16 v[66:67], v13 offset:4864
    s_waitcnt lgkmcnt(8)
    v_mfma_f32_16x16x32_bf16 v[136:139], v[48:51], v[96:99], v[136:139]
    v_mfma_f32_16x16x32_bf16 v[208:211], v[48:51], v[100:103], v[208:211]
    ds_read_b64_tr_b16 v[68:69], v13 offset:9472
    ds_read_b64_tr_b16 v[70:71], v13 offset:14080
    s_waitcnt lgkmcnt(8)
    v_mfma_f32_16x16x32_bf16 v[172:175], v[52:55], v[96:99], v[172:175]
    v_mfma_f32_16x16x32_bf16 v[244:247], v[52:55], v[100:103], v[244:247]
    ds_read_b64_tr_b16 v[48:49], v13 offset:18432
    ds_read_b64_tr_b16 v[50:51], v13 offset:23040
    s_waitcnt lgkmcnt(8)
    v_mfma_f32_16x16x32_bf16 v[140:143], v[56:59], v[96:99], v[140:143]
    v_mfma_f32_16x16x32_bf16 v[212:215], v[56:59], v[100:103], v[212:215]
    ds_read_b64_tr_b16 v[52:53], v13 offset:27648
    ds_read_b64_tr_b16 v[54:55], v13 offset:32256
    s_waitcnt lgkmcnt(8)
    v_mfma_f32_16x16x32_bf16 v[176:179], v[60:63], v[96:99], v[176:179]
    v_mfma_f32_16x16x32_bf16 v[248:251], v[60:63], v[100:103], v[248:251]
    ds_read_b64_tr_b16 v[56:57], v13 offset:18464
    ds_read_b64_tr_b16 v[58:59], v13 offset:23072
    s_waitcnt lgkmcnt(8)
    v_mfma_f32_16x16x32_bf16 v[144:147], v[64:67], v[96:99], v[144:147]
    v_mfma_f32_16x16x32_bf16 v[216:219], v[64:67], v[100:103], v[216:219]
    ds_read_b64_tr_b16 v[60:61], v13 offset:27680
    ds_read_b64_tr_b16 v[62:63], v13 offset:32288
    s_waitcnt lgkmcnt(8)
    v_mfma_f32_16x16x32_bf16 v[180:183], v[68:71], v[96:99], v[180:183]
    v_mfma_f32_16x16x32_bf16 v[252:255], v[68:71], v[100:103], v[252:255]
    ds_read_b64_tr_b16 v[64:65], v13 offset:18496
    ds_read_b64_tr_b16 v[66:67], v13 offset:23104
    s_waitcnt lgkmcnt(8)
    v_mfma_f32_16x16x32_bf16 v[112:115], v[48:51], v[104:107], v[112:115]
    v_mfma_f32_16x16x32_bf16 v[184:187], v[48:51], v[108:111], v[184:187]
    ds_read_b64_tr_b16 v[68:69], v13 offset:27712
    ds_read_b64_tr_b16 v[70:71], v13 offset:32320
    s_waitcnt lgkmcnt(8)
    v_mfma_f32_16x16x32_bf16 v[148:151], v[52:55], v[104:107], v[148:151]
    v_mfma_f32_16x16x32_bf16 v[220:223], v[52:55], v[108:111], v[220:223]
    s_waitcnt vmcnt(7)
    s_barrier
    ds_read_b64_tr_b16 v[48:49], v13 offset:18528
    ds_read_b64_tr_b16 v[50:51], v13 offset:23136
    s_waitcnt lgkmcnt(8)
    v_mfma_f32_16x16x32_bf16 v[116:119], v[56:59], v[104:107], v[116:119]
    v_mfma_f32_16x16x32_bf16 v[188:191], v[56:59], v[108:111], v[188:191]
    s_add_u32 s30, s22, 0
    s_add_u32 s29, s54, 4866048
    s_add_u32 m0, s30, 0
    s_mov_b64 exec, s[50:51]
    buffer_load_dwordx4 v10, s[8:11], s29 offen lds
    s_mov_b64 exec, -1
    s_add_u32 m0, s30, 768
    s_mov_b64 exec, s[50:51]
    buffer_load_dwordx4 v11, s[8:11], s29 offen lds
    s_mov_b64 exec, -1
    s_add_u32 m0, s30, 1536
    s_mov_b64 exec, s[50:51]
    buffer_load_dwordx4 v12, s[8:11], s29 offen lds
    s_mov_b64 exec, -1
    buffer_load_dwordx4 v[96:99], v3, s[12:15], s25 offen offset:1024 sc1
    buffer_load_dwordx4 v[100:103], v3, s[12:15], s26 offen offset:1024 sc1
    ds_read_b64_tr_b16 v[52:53], v13 offset:27744
    ds_read_b64_tr_b16 v[54:55], v13 offset:32352
    s_waitcnt lgkmcnt(8)
    v_mfma_f32_16x16x32_bf16 v[152:155], v[60:63], v[104:107], v[152:155]
    v_mfma_f32_16x16x32_bf16 v[224:227], v[60:63], v[108:111], v[224:227]
    ds_read_b64_tr_b16 v[56:57], v13 offset:18560
    ds_read_b64_tr_b16 v[58:59], v13 offset:23168
    s_waitcnt lgkmcnt(8)
    v_mfma_f32_16x16x32_bf16 v[120:123], v[64:67], v[104:107], v[120:123]
    v_mfma_f32_16x16x32_bf16 v[192:195], v[64:67], v[108:111], v[192:195]
    ds_read_b64_tr_b16 v[60:61], v13 offset:27776
    ds_read_b64_tr_b16 v[62:63], v13 offset:32384
    s_waitcnt lgkmcnt(8)
    v_mfma_f32_16x16x32_bf16 v[156:159], v[68:71], v[104:107], v[156:159]
    v_mfma_f32_16x16x32_bf16 v[228:231], v[68:71], v[108:111], v[228:231]
    ds_read_b64_tr_b16 v[64:65], v13 offset:18592
    ds_read_b64_tr_b16 v[66:67], v13 offset:23200
    s_waitcnt lgkmcnt(8)
    v_mfma_f32_16x16x32_bf16 v[124:127], v[48:51], v[104:107], v[124:127]
    v_mfma_f32_16x16x32_bf16 v[196:199], v[48:51], v[108:111], v[196:199]
    ds_read_b64_tr_b16 v[68:69], v13 offset:27808
    ds_read_b64_tr_b16 v[70:71], v13 offset:32416
    s_waitcnt lgkmcnt(8)
    v_mfma_f32_16x16x32_bf16 v[160:163], v[52:55], v[104:107], v[160:163]
    v_mfma_f32_16x16x32_bf16 v[232:235], v[52:55], v[108:111], v[232:235]
    ds_read_b64_tr_b16 v[48:49], v13 offset:18624
    ds_read_b64_tr_b16 v[50:51], v13 offset:23232
    s_waitcnt lgkmcnt(8)
    v_mfma_f32_16x16x32_bf16 v[128:131], v[56:59], v[104:107], v[128:131]
    v_mfma_f32_16x16x32_bf16 v[200:203], v[56:59], v[108:111], v[200:203]
    ds_read_b64_tr_b16 v[52:53], v13 offset:27840
    ds_read_b64_tr_b16 v[54:55], v13 offset:32448
    s_waitcnt lgkmcnt(8)
    v_mfma_f32_16x16x32_bf16 v[164:167], v[60:63], v[104:107], v[164:167]
    v_mfma_f32_16x16x32_bf16 v[236:239], v[60:63], v[108:111], v[236:239]
    ds_read_b64_tr_b16 v[56:57], v13 offset:18656
    ds_read_b64_tr_b16 v[58:59], v13 offset:23264
    s_waitcnt lgkmcnt(8)
    v_mfma_f32_16x16x32_bf16 v[132:135], v[64:67], v[104:107], v[132:135]
    v_mfma_f32_16x16x32_bf16 v[204:207], v[64:67], v[108:111], v[204:207]
    ds_read_b64_tr_b16 v[60:61], v13 offset:27872
    ds_read_b64_tr_b16 v[62:63], v13 offset:32480
    s_waitcnt lgkmcnt(8)
    v_mfma_f32_16x16x32_bf16 v[168:171], v[68:71], v[104:107], v[168:171]
    v_mfma_f32_16x16x32_bf16 v[240:243], v[68:71], v[108:111], v[240:243]
    ds_read_b64_tr_b16 v[64:65], v13 offset:18688
    ds_read_b64_tr_b16 v[66:67], v13 offset:23296
    s_waitcnt lgkmcnt(8)
    v_mfma_f32_16x16x32_bf16 v[136:139], v[48:51], v[104:107], v[136:139]
    v_mfma_f32_16x16x32_bf16 v[208:211], v[48:51], v[108:111], v[208:211]
    ds_read_b64_tr_b16 v[68:69], v13 offset:27904
    ds_read_b64_tr_b16 v[70:71], v13 offset:32512
    s_waitcnt lgkmcnt(8)
    v_mfma_f32_16x16x32_bf16 v[172:175], v[52:55], v[104:107], v[172:175]
    v_mfma_f32_16x16x32_bf16 v[244:247], v[52:55], v[108:111], v[244:247]
    ds_read_b64_tr_b16 v[48:49], v13 offset:36864
    ds_read_b64_tr_b16 v[50:51], v13 offset:41472
    s_waitcnt lgkmcnt(8)
    v_mfma_f32_16x16x32_bf16 v[140:143], v[56:59], v[104:107], v[140:143]
    v_mfma_f32_16x16x32_bf16 v[212:215], v[56:59], v[108:111], v[212:215]
    ds_read_b64_tr_b16 v[52:53], v13 offset:46080
    ds_read_b64_tr_b16 v[54:55], v13 offset:50688
    s_waitcnt lgkmcnt(8)
    v_mfma_f32_16x16x32_bf16 v[176:179], v[60:63], v[104:107], v[176:179]
    v_mfma_f32_16x16x32_bf16 v[248:251], v[60:63], v[108:111], v[248:251]
    ds_read_b64_tr_b16 v[56:57], v13 offset:36896
    ds_read_b64_tr_b16 v[58:59], v13 offset:41504
    s_waitcnt lgkmcnt(8)
    v_mfma_f32_16x16x32_bf16 v[144:147], v[64:67], v[104:107], v[144:147]
    v_mfma_f32_16x16x32_bf16 v[216:219], v[64:67], v[108:111], v[216:219]
    ds_read_b64_tr_b16 v[60:61], v13 offset:46112
    ds_read_b64_tr_b16 v[62:63], v13 offset:50720
    s_waitcnt lgkmcnt(8)
    v_mfma_f32_16x16x32_bf16 v[180:183], v[68:71], v[104:107], v[180:183]
    v_mfma_f32_16x16x32_bf16 v[252:255], v[68:71], v[108:111], v[252:255]
    ds_read_b64_tr_b16 v[64:65], v13 offset:36928
    ds_read_b64_tr_b16 v[66:67], v13 offset:41536
    s_waitcnt lgkmcnt(8)
    v_mfma_f32_16x16x32_bf16 v[112:115], v[48:51], v[72:75], v[112:115]
    v_mfma_f32_16x16x32_bf16 v[184:187], v[48:51], v[76:79], v[184:187]
    ds_read_b64_tr_b16 v[68:69], v13 offset:46144
    ds_read_b64_tr_b16 v[70:71], v13 offset:50752
    s_waitcnt lgkmcnt(8)
    v_mfma_f32_16x16x32_bf16 v[148:151], v[52:55], v[72:75], v[148:151]
    v_mfma_f32_16x16x32_bf16 v[220:223], v[52:55], v[76:79], v[220:223]
    s_waitcnt vmcnt(7)
    s_barrier
    ds_read_b64_tr_b16 v[48:49], v13 offset:36960
    ds_read_b64_tr_b16 v[50:51], v13 offset:41568
    s_waitcnt lgkmcnt(8)
    v_mfma_f32_16x16x32_bf16 v[116:119], v[56:59], v[72:75], v[116:119]
    v_mfma_f32_16x16x32_bf16 v[188:191], v[56:59], v[76:79], v[188:191]
    s_add_u32 s30, s22, 18432
    s_add_u32 s29, s55, 3833856
    s_add_u32 m0, s30, 0
    s_mov_b64 exec, s[50:51]
    buffer_load_dwordx4 v10, s[8:11], s29 offen lds
    s_mov_b64 exec, -1
    s_add_u32 m0, s30, 768
    s_mov_b64 exec, s[50:51]
    buffer_load_dwordx4 v11, s[8:11], s29 offen lds
    s_mov_b64 exec, -1
    s_add_u32 m0, s30, 1536
    s_mov_b64 exec, s[50:51]
    buffer_load_dwordx4 v12, s[8:11], s29 offen lds
    s_mov_b64 exec, -1
    buffer_load_dwordx4 v[104:107], v3, s[12:15], s25 offen offset:2048 sc1
    buffer_load_dwordx4 v[108:111], v3, s[12:15], s26 offen offset:2048 sc1
    ds_read_b64_tr_b16 v[52:53], v13 offset:46176
    ds_read_b64_tr_b16 v[54:55], v13 offset:50784
    s_waitcnt lgkmcnt(8)
    v_mfma_f32_16x16x32_bf16 v[152:155], v[60:63], v[72:75], v[152:155]
    v_mfma_f32_16x16x32_bf16 v[224:227], v[60:63], v[76:79], v[224:227]
    ds_read_b64_tr_b16 v[56:57], v13 offset:36992
    ds_read_b64_tr_b16 v[58:59], v13 offset:41600
    s_waitcnt lgkmcnt(8)
    v_mfma_f32_16x16x32_bf16 v[120:123], v[64:67], v[72:75], v[120:123]
    v_mfma_f32_16x16x32_bf16 v[192:195], v[64:67], v[76:79], v[192:195]
    ds_read_b64_tr_b16 v[60:61], v13 offset:46208
    ds_read_b64_tr_b16 v[62:63], v13 offset:50816
    s_waitcnt lgkmcnt(8)
    v_mfma_f32_16x16x32_bf16 v[156:159], v[68:71], v[72:75], v[156:159]
    v_mfma_f32_16x16x32_bf16 v[228:231], v[68:71], v[76:79], v[228:231]
    ds_read_b64_tr_b16 v[64:65], v13 offset:37024
    ds_read_b64_tr_b16 v[66:67], v13 offset:41632
    s_waitcnt lgkmcnt(8)
    v_mfma_f32_16x16x32_bf16 v[124:127], v[48:51], v[72:75], v[124:127]
    v_mfma_f32_16x16x32_bf16 v[196:199], v[48:51], v[76:79], v[196:199]
    ds_read_b64_tr_b16 v[68:69], v13 offset:46240
    ds_read_b64_tr_b16 v[70:71], v13 offset:50848
    s_waitcnt lgkmcnt(8)
    v_mfma_f32_16x16x32_bf16 v[160:163], v[52:55], v[72:75], v[160:163]
    v_mfma_f32_16x16x32_bf16 v[232:235], v[52:55], v[76:79], v[232:235]
    ds_read_b64_tr_b16 v[48:49], v13 offset:37056
    ds_read_b64_tr_b16 v[50:51], v13 offset:41664
    s_waitcnt lgkmcnt(8)
    v_mfma_f32_16x16x32_bf16 v[128:131], v[56:59], v[72:75], v[128:131]
    v_mfma_f32_16x16x32_bf16 v[200:203], v[56:59], v[76:79], v[200:203]
    ds_read_b64_tr_b16 v[52:53], v13 offset:46272
    ds_read_b64_tr_b16 v[54:55], v13 offset:50880
    s_waitcnt lgkmcnt(8)
    v_mfma_f32_16x16x32_bf16 v[164:167], v[60:63], v[72:75], v[164:167]
    v_mfma_f32_16x16x32_bf16 v[236:239], v[60:63], v[76:79], v[236:239]
    ds_read_b64_tr_b16 v[56:57], v13 offset:37088
    ds_read_b64_tr_b16 v[58:59], v13 offset:41696
    s_waitcnt lgkmcnt(8)
    v_mfma_f32_16x16x32_bf16 v[132:135], v[64:67], v[72:75], v[132:135]
    v_mfma_f32_16x16x32_bf16 v[204:207], v[64:67], v[76:79], v[204:207]
    ds_read_b64_tr_b16 v[60:61], v13 offset:46304
    ds_read_b64_tr_b16 v[62:63], v13 offset:50912
    s_waitcnt lgkmcnt(8)
    v_mfma_f32_16x16x32_bf16 v[168:171], v[68:71], v[72:75], v[168:171]
    v_mfma_f32_16x16x32_bf16 v[240:243], v[68:71], v[76:79], v[240:243]
    ds_read_b64_tr_b16 v[64:65], v13 offset:37120
    ds_read_b64_tr_b16 v[66:67], v13 offset:41728
    s_waitcnt lgkmcnt(8)
    v_mfma_f32_16x16x32_bf16 v[136:139], v[48:51], v[72:75], v[136:139]
    v_mfma_f32_16x16x32_bf16 v[208:211], v[48:51], v[76:79], v[208:211]
    ds_read_b64_tr_b16 v[68:69], v13 offset:46336
    ds_read_b64_tr_b16 v[70:71], v13 offset:50944
    s_waitcnt lgkmcnt(8)
    v_mfma_f32_16x16x32_bf16 v[172:175], v[52:55], v[72:75], v[172:175]
    v_mfma_f32_16x16x32_bf16 v[244:247], v[52:55], v[76:79], v[244:247]
    ds_read_b64_tr_b16 v[48:49], v14 offset:0
    ds_read_b64_tr_b16 v[50:51], v14 offset:4608
    s_waitcnt lgkmcnt(8)
    v_mfma_f32_16x16x32_bf16 v[140:143], v[56:59], v[72:75], v[140:143]
    v_mfma_f32_16x16x32_bf16 v[212:215], v[56:59], v[76:79], v[212:215]
    ds_read_b64_tr_b16 v[52:53], v14 offset:9216
    ds_read_b64_tr_b16 v[54:55], v14 offset:13824
    s_waitcnt lgkmcnt(8)
    v_mfma_f32_16x16x32_bf16 v[176:179], v[60:63], v[72:75], v[176:179]
    v_mfma_f32_16x16x32_bf16 v[248:251], v[60:63], v[76:79], v[248:251]
    ds_read_b64_tr_b16 v[56:57], v14 offset:32
    ds_read_b64_tr_b16 v[58:59], v14 offset:4640
    s_waitcnt lgkmcnt(8)
    v_mfma_f32_16x16x32_bf16 v[144:147], v[64:67], v[72:75], v[144:147]
    v_mfma_f32_16x16x32_bf16 v[216:219], v[64:67], v[76:79], v[216:219]
    ds_read_b64_tr_b16 v[60:61], v14 offset:9248
    ds_read_b64_tr_b16 v[62:63], v14 offset:13856
    s_waitcnt lgkmcnt(8)
    v_mfma_f32_16x16x32_bf16 v[180:183], v[68:71], v[72:75], v[180:183]
    v_mfma_f32_16x16x32_bf16 v[252:255], v[68:71], v[76:79], v[252:255]
    v_min_u32 v5, 161, v0
    s_mul_i32 s31, s2, 20736
    v_lshl_add_u32 v5, v5, 7, s31
    global_load_dword v2, v5, s[56:57]
    ds_read_b64_tr_b16 v[64:65], v14 offset:64
    ds_read_b64_tr_b16 v[66:67], v14 offset:4672
    s_waitcnt lgkmcnt(8)
    v_mfma_f32_16x16x32_bf16 v[112:115], v[48:51], v[80:83], v[112:115]
    v_mfma_f32_16x16x32_bf16 v[184:187], v[48:51], v[84:87], v[184:187]
    ds_read_b64_tr_b16 v[68:69], v14 offset:9280
    ds_read_b64_tr_b16 v[70:71], v14 offset:13888
    s_waitcnt lgkmcnt(8)
    v_mfma_f32_16x16x32_bf16 v[148:151], v[52:55], v[80:83], v[148:151]
    v_mfma_f32_16x16x32_bf16 v[220:223], v[52:55], v[84:87], v[220:223]
    s_waitcnt vmcnt(8)
    s_barrier
    ds_read_b64_tr_b16 v[48:49], v14 offset:96
    ds_read_b64_tr_b16 v[50:51], v14 offset:4704
    s_waitcnt lgkmcnt(8)
    v_mfma_f32_16x16x32_bf16 v[116:119], v[56:59], v[80:83], v[116:119]
    v_mfma_f32_16x16x32_bf16 v[188:191], v[56:59], v[84:87], v[188:191]
    buffer_load_dwordx4 v[72:75], v3, s[12:15], s25 offen offset:3072 sc1
    buffer_load_dwordx4 v[76:79], v3, s[12:15], s26 offen offset:3072 sc1
    ds_read_b64_tr_b16 v[52:53], v14 offset:9312
    ds_read_b64_tr_b16 v[54:55], v14 offset:13920
    s_waitcnt lgkmcnt(8)
    v_mfma_f32_16x16x32_bf16 v[152:155], v[60:63], v[80:83], v[152:155]
    v_mfma_f32_16x16x32_bf16 v[224:227], v[60:63], v[84:87], v[224:227]
    ds_read_b64_tr_b16 v[56:57], v14 offset:128
    ds_read_b64_tr_b16 v[58:59], v14 offset:4736
    s_waitcnt lgkmcnt(8)
    v_mfma_f32_16x16x32_bf16 v[120:123], v[64:67], v[80:83], v[120:123]
    v_mfma_f32_16x16x32_bf16 v[192:195], v[64:67], v[84:87], v[192:195]
    ds_read_b64_tr_b16 v[60:61], v14 offset:9344
    ds_read_b64_tr_b16 v[62:63], v14 offset:13952
    s_waitcnt lgkmcnt(8)
    v_mfma_f32_16x16x32_bf16 v[156:159], v[68:71], v[80:83], v[156:159]
    v_mfma_f32_16x16x32_bf16 v[228:231], v[68:71], v[84:87], v[228:231]
    ds_read_b64_tr_b16 v[64:65], v14 offset:160
    ds_read_b64_tr_b16 v[66:67], v14 offset:4768
    s_waitcnt lgkmcnt(8)
    v_mfma_f32_16x16x32_bf16 v[124:127], v[48:51], v[80:83], v[124:127]
    v_mfma_f32_16x16x32_bf16 v[196:199], v[48:51], v[84:87], v[196:199]
    ds_read_b64_tr_b16 v[68:69], v14 offset:9376
    ds_read_b64_tr_b16 v[70:71], v14 offset:13984
    s_waitcnt lgkmcnt(8)
    v_mfma_f32_16x16x32_bf16 v[160:163], v[52:55], v[80:83], v[160:163]
    v_mfma_f32_16x16x32_bf16 v[232:235], v[52:55], v[84:87], v[232:235]
    ds_read_b64_tr_b16 v[48:49], v14 offset:192
    ds_read_b64_tr_b16 v[50:51], v14 offset:4800
    s_waitcnt lgkmcnt(8)
    v_mfma_f32_16x16x32_bf16 v[128:131], v[56:59], v[80:83], v[128:131]
    v_mfma_f32_16x16x32_bf16 v[200:203], v[56:59], v[84:87], v[200:203]
    ds_read_b64_tr_b16 v[52:53], v14 offset:9408
    ds_read_b64_tr_b16 v[54:55], v14 offset:14016
    s_waitcnt lgkmcnt(8)
    v_mfma_f32_16x16x32_bf16 v[164:167], v[60:63], v[80:83], v[164:167]
    v_mfma_f32_16x16x32_bf16 v[236:239], v[60:63], v[84:87], v[236:239]
    ds_read_b64_tr_b16 v[56:57], v14 offset:224
    ds_read_b64_tr_b16 v[58:59], v14 offset:4832
    s_waitcnt lgkmcnt(8)
    v_mfma_f32_16x16x32_bf16 v[132:135], v[64:67], v[80:83], v[132:135]
    v_mfma_f32_16x16x32_bf16 v[204:207], v[64:67], v[84:87], v[204:207]
    ds_read_b64_tr_b16 v[60:61], v14 offset:9440
    ds_read_b64_tr_b16 v[62:63], v14 offset:14048
    s_waitcnt lgkmcnt(8)
    v_mfma_f32_16x16x32_bf16 v[168:171], v[68:71], v[80:83], v[168:171]
    v_mfma_f32_16x16x32_bf16 v[240:243], v[68:71], v[84:87], v[240:243]
    ds_read_b64_tr_b16 v[64:65], v14 offset:256
    ds_read_b64_tr_b16 v[66:67], v14 offset:4864
    s_waitcnt lgkmcnt(8)
    v_mfma_f32_16x16x32_bf16 v[136:139], v[48:51], v[80:83], v[136:139]
    v_mfma_f32_16x16x32_bf16 v[208:211], v[48:51], v[84:87], v[208:211]
    ds_read_b64_tr_b16 v[68:69], v14 offset:9472
    ds_read_b64_tr_b16 v[70:71], v14 offset:14080
    s_waitcnt lgkmcnt(8)
    v_mfma_f32_16x16x32_bf16 v[172:175], v[52:55], v[80:83], v[172:175]
    v_mfma_f32_16x16x32_bf16 v[244:247], v[52:55], v[84:87], v[244:247]
    ds_read_b64_tr_b16 v[48:49], v14 offset:18432
    ds_read_b64_tr_b16 v[50:51], v14 offset:23040
    s_waitcnt lgkmcnt(8)
    v_mfma_f32_16x16x32_bf16 v[140:143], v[56:59], v[80:83], v[140:143]
    v_mfma_f32_16x16x32_bf16 v[212:215], v[56:59], v[84:87], v[212:215]
    ds_read_b64_tr_b16 v[52:53], v14 offset:27648
    ds_read_b64_tr_b16 v[54:55], v14 offset:32256
    s_waitcnt lgkmcnt(8)
    v_mfma_f32_16x16x32_bf16 v[176:179], v[60:63], v[80:83], v[176:179]
    v_mfma_f32_16x16x32_bf16 v[248:251], v[60:63], v[84:87], v[248:251]
    ds_read_b64_tr_b16 v[56:57], v14 offset:18464
    ds_read_b64_tr_b16 v[58:59], v14 offset:23072
    s_waitcnt lgkmcnt(8)
    v_mfma_f32_16x16x32_bf16 v[144:147], v[64:67], v[80:83], v[144:147]
    v_mfma_f32_16x16x32_bf16 v[216:219], v[64:67], v[84:87], v[216:219]
    ds_read_b64_tr_b16 v[60:61], v14 offset:27680
    ds_read_b64_tr_b16 v[62:63], v14 offset:32288
    s_waitcnt lgkmcnt(8)
    v_mfma_f32_16x16x32_bf16 v[180:183], v[68:71], v[80:83], v[180:183]
    v_mfma_f32_16x16x32_bf16 v[252:255], v[68:71], v[84:87], v[252:255]
    ds_read_b64_tr_b16 v[64:65], v14 offset:18496
    ds_read_b64_tr_b16 v[66:67], v14 offset:23104
    s_waitcnt lgkmcnt(8)
    v_mfma_f32_16x16x32_bf16 v[112:115], v[48:51], v[88:91], v[112:115]
    v_mfma_f32_16x16x32_bf16 v[184:187], v[48:51], v[92:95], v[184:187]
    ds_read_b64_tr_b16 v[68:69], v14 offset:27712
    ds_read_b64_tr_b16 v[70:71], v14 offset:32320
    s_waitcnt lgkmcnt(8)
    v_mfma_f32_16x16x32_bf16 v[148:151], v[52:55], v[88:91], v[148:151]
    v_mfma_f32_16x16x32_bf16 v[220:223], v[52:55], v[92:95], v[220:223]
    s_waitcnt vmcnt(5)
    s_barrier
    ds_read_b64_tr_b16 v[48:49], v14 offset:18528
    ds_read_b64_tr_b16 v[50:51], v14 offset:23136
    s_waitcnt lgkmcnt(8)
    v_mfma_f32_16x16x32_bf16 v[116:119], v[56:59], v[88:91], v[116:119]
    v_mfma_f32_16x16x32_bf16 v[188:191], v[56:59], v[92:95], v[188:191]
    s_add_u32 s25, s25, 4096
    s_add_u32 s26, s26, 4096
    buffer_load_dwordx4 v[80:83], v3, s[12:15], s25 offen offset:0 sc1
    buffer_load_dwordx4 v[84:87], v3, s[12:15], s26 offen offset:0 sc1
    ds_read_b64_tr_b16 v[52:53], v14 offset:27744
    ds_read_b64_tr_b16 v[54:55], v14 offset:32352
    s_waitcnt lgkmcnt(8)
    v_mfma_f32_16x16x32_bf16 v[152:155], v[60:63], v[88:91], v[152:155]
    v_mfma_f32_16x16x32_bf16 v[224:227], v[60:63], v[92:95], v[224:227]
    ds_read_b64_tr_b16 v[56:57], v14 offset:18560
    ds_read_b64_tr_b16 v[58:59], v14 offset:23168
    s_waitcnt lgkmcnt(8)
    v_mfma_f32_16x16x32_bf16 v[120:123], v[64:67], v[88:91], v[120:123]
    v_mfma_f32_16x16x32_bf16 v[192:195], v[64:67], v[92:95], v[192:195]
    ds_read_b64_tr_b16 v[60:61], v14 offset:27776
    ds_read_b64_tr_b16 v[62:63], v14 offset:32384
    s_waitcnt lgkmcnt(8)
    v_mfma_f32_16x16x32_bf16 v[156:159], v[68:71], v[88:91], v[156:159]
    v_mfma_f32_16x16x32_bf16 v[228:231], v[68:71], v[92:95], v[228:231]
    ds_read_b64_tr_b16 v[64:65], v14 offset:18592
    ds_read_b64_tr_b16 v[66:67], v14 offset:23200
    s_waitcnt lgkmcnt(8)
    v_mfma_f32_16x16x32_bf16 v[124:127], v[48:51], v[88:91], v[124:127]
    v_mfma_f32_16x16x32_bf16 v[196:199], v[48:51], v[92:95], v[196:199]
    ds_read_b64_tr_b16 v[68:69], v14 offset:27808
    ds_read_b64_tr_b16 v[70:71], v14 offset:32416
    s_waitcnt lgkmcnt(8)
    v_mfma_f32_16x16x32_bf16 v[160:163], v[52:55], v[88:91], v[160:163]
    v_mfma_f32_16x16x32_bf16 v[232:235], v[52:55], v[92:95], v[232:235]
    ds_read_b64_tr_b16 v[48:49], v14 offset:18624
    ds_read_b64_tr_b16 v[50:51], v14 offset:23232
    s_waitcnt lgkmcnt(8)
    v_mfma_f32_16x16x32_bf16 v[128:131], v[56:59], v[88:91], v[128:131]
    v_mfma_f32_16x16x32_bf16 v[200:203], v[56:59], v[92:95], v[200:203]
    ds_read_b64_tr_b16 v[52:53], v14 offset:27840
    ds_read_b64_tr_b16 v[54:55], v14 offset:32448
    s_waitcnt lgkmcnt(8)
    v_mfma_f32_16x16x32_bf16 v[164:167], v[60:63], v[88:91], v[164:167]
    v_mfma_f32_16x16x32_bf16 v[236:239], v[60:63], v[92:95], v[236:239]
    ds_read_b64_tr_b16 v[56:57], v14 offset:18656
    ds_read_b64_tr_b16 v[58:59], v14 offset:23264
    s_waitcnt lgkmcnt(8)
    v_mfma_f32_16x16x32_bf16 v[132:135], v[64:67], v[88:91], v[132:135]
    v_mfma_f32_16x16x32_bf16 v[204:207], v[64:67], v[92:95], v[204:207]
    ds_read_b64_tr_b16 v[60:61], v14 offset:27872
    ds_read_b64_tr_b16 v[62:63], v14 offset:32480
    s_waitcnt lgkmcnt(8)
    v_mfma_f32_16x16x32_bf16 v[168:171], v[68:71], v[88:91], v[168:171]
    v_mfma_f32_16x16x32_bf16 v[240:243], v[68:71], v[92:95], v[240:243]
    ds_read_b64_tr_b16 v[64:65], v14 offset:18688
    ds_read_b64_tr_b16 v[66:67], v14 offset:23296
    s_waitcnt lgkmcnt(8)
    v_mfma_f32_16x16x32_bf16 v[136:139], v[48:51], v[88:91], v[136:139]
    v_mfma_f32_16x16x32_bf16 v[208:211], v[48:51], v[92:95], v[208:211]
    ds_read_b64_tr_b16 v[68:69], v14 offset:27904
    ds_read_b64_tr_b16 v[70:71], v14 offset:32512
    s_waitcnt lgkmcnt(8)
    v_mfma_f32_16x16x32_bf16 v[172:175], v[52:55], v[88:91], v[172:175]
    v_mfma_f32_16x16x32_bf16 v[244:247], v[52:55], v[92:95], v[244:247]
    ds_read_b64_tr_b16 v[48:49], v14 offset:36864
    ds_read_b64_tr_b16 v[50:51], v14 offset:41472
    s_waitcnt lgkmcnt(8)
    v_mfma_f32_16x16x32_bf16 v[140:143], v[56:59], v[88:91], v[140:143]
    v_mfma_f32_16x16x32_bf16 v[212:215], v[56:59], v[92:95], v[212:215]
    ds_read_b64_tr_b16 v[52:53], v14 offset:46080
    ds_read_b64_tr_b16 v[54:55], v14 offset:50688
    s_waitcnt lgkmcnt(8)
    v_mfma_f32_16x16x32_bf16 v[176:179], v[60:63], v[88:91], v[176:179]
    v_mfma_f32_16x16x32_bf16 v[248:251], v[60:63], v[92:95], v[248:251]
    ds_read_b64_tr_b16 v[56:57], v14 offset:36896
    ds_read_b64_tr_b16 v[58:59], v14 offset:41504
    s_waitcnt lgkmcnt(8)
    v_mfma_f32_16x16x32_bf16 v[144:147], v[64:67], v[88:91], v[144:147]
    v_mfma_f32_16x16x32_bf16 v[216:219], v[64:67], v[92:95], v[216:219]
    ds_read_b64_tr_b16 v[60:61], v14 offset:46112
    ds_read_b64_tr_b16 v[62:63], v14 offset:50720
    s_waitcnt lgkmcnt(8)
    v_mfma_f32_16x16x32_bf16 v[180:183], v[68:71], v[88:91], v[180:183]
    v_mfma_f32_16x16x32_bf16 v[252:255], v[68:71], v[92:95], v[252:255]
    ds_read_b64_tr_b16 v[64:65], v14 offset:36928
    ds_read_b64_tr_b16 v[66:67], v14 offset:41536
    s_waitcnt lgkmcnt(8)
    v_mfma_f32_16x16x32_bf16 v[112:115], v[48:51], v[96:99], v[112:115]
    v_mfma_f32_16x16x32_bf16 v[184:187], v[48:51], v[100:103], v[184:187]
    ds_read_b64_tr_b16 v[68:69], v14 offset:46144
    ds_read_b64_tr_b16 v[70:71], v14 offset:50752
    s_waitcnt lgkmcnt(8)
    v_mfma_f32_16x16x32_bf16 v[148:151], v[52:55], v[96:99], v[148:151]
    v_mfma_f32_16x16x32_bf16 v[220:223], v[52:55], v[100:103], v[220:223]
    s_waitcnt vmcnt(5)
    ds_read_b64_tr_b16 v[48:49], v14 offset:36960
    ds_read_b64_tr_b16 v[50:51], v14 offset:41568
    s_waitcnt lgkmcnt(8)
    v_mfma_f32_16x16x32_bf16 v[116:119], v[56:59], v[96:99], v[116:119]
    v_mfma_f32_16x16x32_bf16 v[188:191], v[56:59], v[100:103], v[188:191]
    buffer_load_dwordx4 v[88:91], v3, s[12:15], s25 offen offset:1024 sc1
    buffer_load_dwordx4 v[92:95], v3, s[12:15], s26 offen offset:1024 sc1
    ds_read_b64_tr_b16 v[52:53], v14 offset:46176
    ds_read_b64_tr_b16 v[54:55], v14 offset:50784
    s_waitcnt lgkmcnt(8)
    v_mfma_f32_16x16x32_bf16 v[152:155], v[60:63], v[96:99], v[152:155]
    v_mfma_f32_16x16x32_bf16 v[224:227], v[60:63], v[100:103], v[224:227]
    ds_read_b64_tr_b16 v[56:57], v14 offset:36992
    ds_read_b64_tr_b16 v[58:59], v14 offset:41600
    s_waitcnt lgkmcnt(8)
    v_mfma_f32_16x16x32_bf16 v[120:123], v[64:67], v[96:99], v[120:123]
    v_mfma_f32_16x16x32_bf16 v[192:195], v[64:67], v[100:103], v[192:195]
    ds_read_b64_tr_b16 v[60:61], v14 offset:46208
    ds_read_b64_tr_b16 v[62:63], v14 offset:50816
    s_waitcnt lgkmcnt(8)
    v_mfma_f32_16x16x32_bf16 v[156:159], v[68:71], v[96:99], v[156:159]
    v_mfma_f32_16x16x32_bf16 v[228:231], v[68:71], v[100:103], v[228:231]
    ds_read_b64_tr_b16 v[64:65], v14 offset:37024
    ds_read_b64_tr_b16 v[66:67], v14 offset:41632
    s_waitcnt lgkmcnt(8)
    v_mfma_f32_16x16x32_bf16 v[124:127], v[48:51], v[96:99], v[124:127]
    v_mfma_f32_16x16x32_bf16 v[196:199], v[48:51], v[100:103], v[196:199]
    ds_read_b64_tr_b16 v[68:69], v14 offset:46240
    ds_read_b64_tr_b16 v[70:71], v14 offset:50848
    s_waitcnt lgkmcnt(8)
    v_mfma_f32_16x16x32_bf16 v[160:163], v[52:55], v[96:99], v[160:163]
    v_mfma_f32_16x16x32_bf16 v[232:235], v[52:55], v[100:103], v[232:235]
    ds_read_b64_tr_b16 v[48:49], v14 offset:37056
    ds_read_b64_tr_b16 v[50:51], v14 offset:41664
    s_waitcnt lgkmcnt(8)
    v_mfma_f32_16x16x32_bf16 v[128:131], v[56:59], v[96:99], v[128:131]
    v_mfma_f32_16x16x32_bf16 v[200:203], v[56:59], v[100:103], v[200:203]
    ds_read_b64_tr_b16 v[52:53], v14 offset:46272
    ds_read_b64_tr_b16 v[54:55], v14 offset:50880
    s_waitcnt lgkmcnt(8)
    v_mfma_f32_16x16x32_bf16 v[164:167], v[60:63], v[96:99], v[164:167]
    v_mfma_f32_16x16x32_bf16 v[236:239], v[60:63], v[100:103], v[236:239]
    ds_read_b64_tr_b16 v[56:57], v14 offset:37088
    ds_read_b64_tr_b16 v[58:59], v14 offset:41696
    s_waitcnt lgkmcnt(8)
    v_mfma_f32_16x16x32_bf16 v[132:135], v[64:67], v[96:99], v[132:135]
    v_mfma_f32_16x16x32_bf16 v[204:207], v[64:67], v[100:103], v[204:207]
    ds_read_b64_tr_b16 v[60:61], v14 offset:46304
    ds_read_b64_tr_b16 v[62:63], v14 offset:50912
    s_waitcnt lgkmcnt(8)
    v_mfma_f32_16x16x32_bf16 v[168:171], v[68:71], v[96:99], v[168:171]
    v_mfma_f32_16x16x32_bf16 v[240:243], v[68:71], v[100:103], v[240:243]
    ds_read_b64_tr_b16 v[64:65], v14 offset:37120
    ds_read_b64_tr_b16 v[66:67], v14 offset:41728
    s_waitcnt lgkmcnt(8)
    v_mfma_f32_16x16x32_bf16 v[136:139], v[48:51], v[96:99], v[136:139]
    v_mfma_f32_16x16x32_bf16 v[208:211], v[48:51], v[100:103], v[208:211]
    ds_read_b64_tr_b16 v[68:69], v14 offset:46336
    ds_read_b64_tr_b16 v[70:71], v14 offset:50944
    s_waitcnt lgkmcnt(8)
    v_mfma_f32_16x16x32_bf16 v[172:175], v[52:55], v[96:99], v[172:175]
    v_mfma_f32_16x16x32_bf16 v[244:247], v[52:55], v[100:103], v[244:247]
    ds_read_b64_tr_b16 v[48:49], v15 offset:0
    ds_read_b64_tr_b16 v[50:51], v15 offset:4608
    s_waitcnt lgkmcnt(8)
    v_mfma_f32_16x16x32_bf16 v[140:143], v[56:59], v[96:99], v[140:143]
    v_mfma_f32_16x16x32_bf16 v[212:215], v[56:59], v[100:103], v[212:215]
    ds_read_b64_tr_b16 v[52:53], v15 offset:9216
    ds_read_b64_tr_b16 v[54:55], v15 offset:13824
    s_waitcnt lgkmcnt(8)
    v_mfma_f32_16x16x32_bf16 v[176:179], v[60:63], v[96:99], v[176:179]
    v_mfma_f32_16x16x32_bf16 v[248:251], v[60:63], v[100:103], v[248:251]
    ds_read_b64_tr_b16 v[56:57], v15 offset:32
    ds_read_b64_tr_b16 v[58:59], v15 offset:4640
    s_waitcnt lgkmcnt(8)
    v_mfma_f32_16x16x32_bf16 v[144:147], v[64:67], v[96:99], v[144:147]
    v_mfma_f32_16x16x32_bf16 v[216:219], v[64:67], v[100:103], v[216:219]
    ds_read_b64_tr_b16 v[60:61], v15 offset:9248
    ds_read_b64_tr_b16 v[62:63], v15 offset:13856
    s_waitcnt lgkmcnt(8)
    v_mfma_f32_16x16x32_bf16 v[180:183], v[68:71], v[96:99], v[180:183]
    v_mfma_f32_16x16x32_bf16 v[252:255], v[68:71], v[100:103], v[252:255]
    ds_read_b64_tr_b16 v[64:65], v15 offset:64
    ds_read_b64_tr_b16 v[66:67], v15 offset:4672
    s_waitcnt lgkmcnt(8)
    v_mfma_f32_16x16x32_bf16 v[112:115], v[48:51], v[104:107], v[112:115]
    v_mfma_f32_16x16x32_bf16 v[184:187], v[48:51], v[108:111], v[184:187]
    ds_read_b64_tr_b16 v[68:69], v15 offset:9280
    ds_read_b64_tr_b16 v[70:71], v15 offset:13888
    s_waitcnt lgkmcnt(8)
    v_mfma_f32_16x16x32_bf16 v[148:151], v[52:55], v[104:107], v[148:151]
    v_mfma_f32_16x16x32_bf16 v[220:223], v[52:55], v[108:111], v[220:223]
    s_waitcnt vmcnt(4)
    s_barrier
    ds_read_b64_tr_b16 v[48:49], v15 offset:96
    ds_read_b64_tr_b16 v[50:51], v15 offset:4704
    s_waitcnt lgkmcnt(8)
    v_mfma_f32_16x16x32_bf16 v[116:119], v[56:59], v[104:107], v[116:119]
    v_mfma_f32_16x16x32_bf16 v[188:191], v[56:59], v[108:111], v[188:191]
    ds_read_b64_tr_b16 v[52:53], v15 offset:9312
    ds_read_b64_tr_b16 v[54:55], v15 offset:13920
    s_waitcnt lgkmcnt(8)
    v_mfma_f32_16x16x32_bf16 v[152:155], v[60:63], v[104:107], v[152:155]
    v_mfma_f32_16x16x32_bf16 v[224:227], v[60:63], v[108:111], v[224:227]
    ds_read_b64_tr_b16 v[56:57], v15 offset:128
    ds_read_b64_tr_b16 v[58:59], v15 offset:4736
    s_waitcnt lgkmcnt(8)
    v_mfma_f32_16x16x32_bf16 v[120:123], v[64:67], v[104:107], v[120:123]
    v_mfma_f32_16x16x32_bf16 v[192:195], v[64:67], v[108:111], v[192:195]
    ds_read_b64_tr_b16 v[60:61], v15 offset:9344
    ds_read_b64_tr_b16 v[62:63], v15 offset:13952
    s_waitcnt lgkmcnt(8)
    v_mfma_f32_16x16x32_bf16 v[156:159], v[68:71], v[104:107], v[156:159]
    v_mfma_f32_16x16x32_bf16 v[228:231], v[68:71], v[108:111], v[228:231]
    ds_read_b64_tr_b16 v[64:65], v15 offset:160
    ds_read_b64_tr_b16 v[66:67], v15 offset:4768
    s_waitcnt lgkmcnt(8)
    v_mfma_f32_16x16x32_bf16 v[124:127], v[48:51], v[104:107], v[124:127]
    v_mfma_f32_16x16x32_bf16 v[196:199], v[48:51], v[108:111], v[196:199]
    ds_read_b64_tr_b16 v[68:69], v15 offset:9376
    ds_read_b64_tr_b16 v[70:71], v15 offset:13984
    s_waitcnt lgkmcnt(8)
    v_mfma_f32_16x16x32_bf16 v[160:163], v[52:55], v[104:107], v[160:163]
    v_mfma_f32_16x16x32_bf16 v[232:235], v[52:55], v[108:111], v[232:235]
    ds_read_b64_tr_b16 v[48:49], v15 offset:192
    ds_read_b64_tr_b16 v[50:51], v15 offset:4800
    s_waitcnt lgkmcnt(8)
    v_mfma_f32_16x16x32_bf16 v[128:131], v[56:59], v[104:107], v[128:131]
    v_mfma_f32_16x16x32_bf16 v[200:203], v[56:59], v[108:111], v[200:203]
    ds_read_b64_tr_b16 v[52:53], v15 offset:9408
    ds_read_b64_tr_b16 v[54:55], v15 offset:14016
    s_waitcnt lgkmcnt(8)
    v_mfma_f32_16x16x32_bf16 v[164:167], v[60:63], v[104:107], v[164:167]
    v_mfma_f32_16x16x32_bf16 v[236:239], v[60:63], v[108:111], v[236:239]
    ds_read_b64_tr_b16 v[56:57], v15 offset:224
    ds_read_b64_tr_b16 v[58:59], v15 offset:4832
    s_waitcnt lgkmcnt(8)
    v_mfma_f32_16x16x32_bf16 v[132:135], v[64:67], v[104:107], v[132:135]
    v_mfma_f32_16x16x32_bf16 v[204:207], v[64:67], v[108:111], v[204:207]
    ds_read_b64_tr_b16 v[60:61], v15 offset:9440
    ds_read_b64_tr_b16 v[62:63], v15 offset:14048
    s_waitcnt lgkmcnt(8)
    v_mfma_f32_16x16x32_bf16 v[168:171], v[68:71], v[104:107], v[168:171]
    v_mfma_f32_16x16x32_bf16 v[240:243], v[68:71], v[108:111], v[240:243]
    ds_read_b64_tr_b16 v[64:65], v15 offset:256
    ds_read_b64_tr_b16 v[66:67], v15 offset:4864
    s_waitcnt lgkmcnt(8)
    v_mfma_f32_16x16x32_bf16 v[136:139], v[48:51], v[104:107], v[136:139]
    v_mfma_f32_16x16x32_bf16 v[208:211], v[48:51], v[108:111], v[208:211]
    ds_read_b64_tr_b16 v[68:69], v15 offset:9472
    ds_read_b64_tr_b16 v[70:71], v15 offset:14080
    s_waitcnt lgkmcnt(8)
    v_mfma_f32_16x16x32_bf16 v[172:175], v[52:55], v[104:107], v[172:175]
    v_mfma_f32_16x16x32_bf16 v[244:247], v[52:55], v[108:111], v[244:247]
    ds_read_b64_tr_b16 v[48:49], v15 offset:18432
    ds_read_b64_tr_b16 v[50:51], v15 offset:23040
    s_waitcnt lgkmcnt(8)
    v_mfma_f32_16x16x32_bf16 v[140:143], v[56:59], v[104:107], v[140:143]
    v_mfma_f32_16x16x32_bf16 v[212:215], v[56:59], v[108:111], v[212:215]
    ds_read_b64_tr_b16 v[52:53], v15 offset:27648
    ds_read_b64_tr_b16 v[54:55], v15 offset:32256
    s_waitcnt lgkmcnt(8)
    v_mfma_f32_16x16x32_bf16 v[176:179], v[60:63], v[104:107], v[176:179]
    v_mfma_f32_16x16x32_bf16 v[248:251], v[60:63], v[108:111], v[248:251]
    ds_read_b64_tr_b16 v[56:57], v15 offset:18464
    ds_read_b64_tr_b16 v[58:59], v15 offset:23072
    s_waitcnt lgkmcnt(8)
    v_mfma_f32_16x16x32_bf16 v[144:147], v[64:67], v[104:107], v[144:147]
    v_mfma_f32_16x16x32_bf16 v[216:219], v[64:67], v[108:111], v[216:219]
    ds_read_b64_tr_b16 v[60:61], v15 offset:27680
    ds_read_b64_tr_b16 v[62:63], v15 offset:32288
    s_waitcnt lgkmcnt(8)
    v_mfma_f32_16x16x32_bf16 v[180:183], v[68:71], v[104:107], v[180:183]
    v_mfma_f32_16x16x32_bf16 v[252:255], v[68:71], v[108:111], v[252:255]
    ds_read_b64_tr_b16 v[64:65], v15 offset:18496
    ds_read_b64_tr_b16 v[66:67], v15 offset:23104
    s_waitcnt lgkmcnt(8)
    v_mfma_f32_16x16x32_bf16 v[112:115], v[48:51], v[72:75], v[112:115]
    v_mfma_f32_16x16x32_bf16 v[184:187], v[48:51], v[76:79], v[184:187]
    ds_read_b64_tr_b16 v[68:69], v15 offset:27712
    ds_read_b64_tr_b16 v[70:71], v15 offset:32320
    s_waitcnt lgkmcnt(8)
    v_mfma_f32_16x16x32_bf16 v[148:151], v[52:55], v[72:75], v[148:151]
    v_mfma_f32_16x16x32_bf16 v[220:223], v[52:55], v[76:79], v[220:223]
    s_waitcnt vmcnt(2)
    ds_read_b64_tr_b16 v[48:49], v15 offset:18528
    ds_read_b64_tr_b16 v[50:51], v15 offset:23136
    s_waitcnt lgkmcnt(8)
    v_mfma_f32_16x16x32_bf16 v[116:119], v[56:59], v[72:75], v[116:119]
    v_mfma_f32_16x16x32_bf16 v[188:191], v[56:59], v[76:79], v[188:191]
    ds_read_b64_tr_b16 v[52:53], v15 offset:27744
    ds_read_b64_tr_b16 v[54:55], v15 offset:32352
    s_waitcnt lgkmcnt(8)
    v_mfma_f32_16x16x32_bf16 v[152:155], v[60:63], v[72:75], v[152:155]
    v_mfma_f32_16x16x32_bf16 v[224:227], v[60:63], v[76:79], v[224:227]
    ds_read_b64_tr_b16 v[56:57], v15 offset:18560
    ds_read_b64_tr_b16 v[58:59], v15 offset:23168
    s_waitcnt lgkmcnt(8)
    v_mfma_f32_16x16x32_bf16 v[120:123], v[64:67], v[72:75], v[120:123]
    v_mfma_f32_16x16x32_bf16 v[192:195], v[64:67], v[76:79], v[192:195]
    ds_read_b64_tr_b16 v[60:61], v15 offset:27776
    ds_read_b64_tr_b16 v[62:63], v15 offset:32384
    s_waitcnt lgkmcnt(8)
    v_mfma_f32_16x16x32_bf16 v[156:159], v[68:71], v[72:75], v[156:159]
    v_mfma_f32_16x16x32_bf16 v[228:231], v[68:71], v[76:79], v[228:231]
    ds_read_b64_tr_b16 v[64:65], v15 offset:18592
    ds_read_b64_tr_b16 v[66:67], v15 offset:23200
    s_waitcnt lgkmcnt(8)
    v_mfma_f32_16x16x32_bf16 v[124:127], v[48:51], v[72:75], v[124:127]
    v_mfma_f32_16x16x32_bf16 v[196:199], v[48:51], v[76:79], v[196:199]
    ds_read_b64_tr_b16 v[68:69], v15 offset:27808
    ds_read_b64_tr_b16 v[70:71], v15 offset:32416
    s_waitcnt lgkmcnt(8)
    v_mfma_f32_16x16x32_bf16 v[160:163], v[52:55], v[72:75], v[160:163]
    v_mfma_f32_16x16x32_bf16 v[232:235], v[52:55], v[76:79], v[232:235]
    ds_read_b64_tr_b16 v[48:49], v15 offset:18624
    ds_read_b64_tr_b16 v[50:51], v15 offset:23232
    s_waitcnt lgkmcnt(8)
    v_mfma_f32_16x16x32_bf16 v[128:131], v[56:59], v[72:75], v[128:131]
    v_mfma_f32_16x16x32_bf16 v[200:203], v[56:59], v[76:79], v[200:203]
    ds_read_b64_tr_b16 v[52:53], v15 offset:27840
    ds_read_b64_tr_b16 v[54:55], v15 offset:32448
    s_waitcnt lgkmcnt(8)
    v_mfma_f32_16x16x32_bf16 v[164:167], v[60:63], v[72:75], v[164:167]
    v_mfma_f32_16x16x32_bf16 v[236:239], v[60:63], v[76:79], v[236:239]
    ds_read_b64_tr_b16 v[56:57], v15 offset:18656
    ds_read_b64_tr_b16 v[58:59], v15 offset:23264
    s_waitcnt lgkmcnt(8)
    v_mfma_f32_16x16x32_bf16 v[132:135], v[64:67], v[72:75], v[132:135]
    v_mfma_f32_16x16x32_bf16 v[204:207], v[64:67], v[76:79], v[204:207]
    ds_read_b64_tr_b16 v[60:61], v15 offset:27872
    ds_read_b64_tr_b16 v[62:63], v15 offset:32480
    s_waitcnt lgkmcnt(8)
    v_mfma_f32_16x16x32_bf16 v[168:171], v[68:71], v[72:75], v[168:171]
    v_mfma_f32_16x16x32_bf16 v[240:243], v[68:71], v[76:79], v[240:243]
    ds_read_b64_tr_b16 v[64:65], v15 offset:18688
    ds_read_b64_tr_b16 v[66:67], v15 offset:23296
    s_waitcnt lgkmcnt(8)
    v_mfma_f32_16x16x32_bf16 v[136:139], v[48:51], v[72:75], v[136:139]
    v_mfma_f32_16x16x32_bf16 v[208:211], v[48:51], v[76:79], v[208:211]
    ds_read_b64_tr_b16 v[68:69], v15 offset:27904
    ds_read_b64_tr_b16 v[70:71], v15 offset:32512
    s_waitcnt lgkmcnt(8)
    v_mfma_f32_16x16x32_bf16 v[172:175], v[52:55], v[72:75], v[172:175]
    v_mfma_f32_16x16x32_bf16 v[244:247], v[52:55], v[76:79], v[244:247]
    ds_read_b64_tr_b16 v[48:49], v13 offset:0
    ds_read_b64_tr_b16 v[50:51], v13 offset:4608
    s_waitcnt lgkmcnt(8)
    v_mfma_f32_16x16x32_bf16 v[140:143], v[56:59], v[72:75], v[140:143]
    v_mfma_f32_16x16x32_bf16 v[212:215], v[56:59], v[76:79], v[212:215]
    ds_read_b64_tr_b16 v[52:53], v13 offset:9216
    ds_read_b64_tr_b16 v[54:55], v13 offset:13824
    s_waitcnt lgkmcnt(8)
    v_mfma_f32_16x16x32_bf16 v[176:179], v[60:63], v[72:75], v[176:179]
    v_mfma_f32_16x16x32_bf16 v[248:251], v[60:63], v[76:79], v[248:251]
    ds_read_b64_tr_b16 v[56:57], v13 offset:32
    ds_read_b64_tr_b16 v[58:59], v13 offset:4640
    s_waitcnt lgkmcnt(8)
    v_mfma_f32_16x16x32_bf16 v[144:147], v[64:67], v[72:75], v[144:147]
    v_mfma_f32_16x16x32_bf16 v[216:219], v[64:67], v[76:79], v[216:219]
    ds_read_b64_tr_b16 v[60:61], v13 offset:9248
    ds_read_b64_tr_b16 v[62:63], v13 offset:13856
    s_waitcnt lgkmcnt(8)
    v_mfma_f32_16x16x32_bf16 v[180:183], v[68:71], v[72:75], v[180:183]
    v_mfma_f32_16x16x32_bf16 v[252:255], v[68:71], v[76:79], v[252:255]
    ds_read_b64_tr_b16 v[64:65], v13 offset:64
    ds_read_b64_tr_b16 v[66:67], v13 offset:4672
    s_waitcnt lgkmcnt(8)
    v_mfma_f32_16x16x32_bf16 v[112:115], v[48:51], v[80:83], v[112:115]
    v_mfma_f32_16x16x32_bf16 v[184:187], v[48:51], v[84:87], v[184:187]
    ds_read_b64_tr_b16 v[68:69], v13 offset:9280
    ds_read_b64_tr_b16 v[70:71], v13 offset:13888
    s_waitcnt lgkmcnt(8)
    v_mfma_f32_16x16x32_bf16 v[148:151], v[52:55], v[80:83], v[148:151]
    v_mfma_f32_16x16x32_bf16 v[220:223], v[52:55], v[84:87], v[220:223]
    s_waitcnt vmcnt(0)
    ds_read_b64_tr_b16 v[48:49], v13 offset:96
    ds_read_b64_tr_b16 v[50:51], v13 offset:4704
    s_waitcnt lgkmcnt(8)
    v_mfma_f32_16x16x32_bf16 v[116:119], v[56:59], v[80:83], v[116:119]
    v_mfma_f32_16x16x32_bf16 v[188:191], v[56:59], v[84:87], v[188:191]
    ds_read_b64_tr_b16 v[52:53], v13 offset:9312
    ds_read_b64_tr_b16 v[54:55], v13 offset:13920
    s_waitcnt lgkmcnt(8)
    v_mfma_f32_16x16x32_bf16 v[152:155], v[60:63], v[80:83], v[152:155]
    v_mfma_f32_16x16x32_bf16 v[224:227], v[60:63], v[84:87], v[224:227]
    ds_read_b64_tr_b16 v[56:57], v13 offset:128
    ds_read_b64_tr_b16 v[58:59], v13 offset:4736
    s_waitcnt lgkmcnt(8)
    v_mfma_f32_16x16x32_bf16 v[120:123], v[64:67], v[80:83], v[120:123]
    v_mfma_f32_16x16x32_bf16 v[192:195], v[64:67], v[84:87], v[192:195]
    ds_read_b64_tr_b16 v[60:61], v13 offset:9344
    ds_read_b64_tr_b16 v[62:63], v13 offset:13952
    s_waitcnt lgkmcnt(8)
    v_mfma_f32_16x16x32_bf16 v[156:159], v[68:71], v[80:83], v[156:159]
    v_mfma_f32_16x16x32_bf16 v[228:231], v[68:71], v[84:87], v[228:231]
    ds_read_b64_tr_b16 v[64:65], v13 offset:160
    ds_read_b64_tr_b16 v[66:67], v13 offset:4768
    s_waitcnt lgkmcnt(8)
    v_mfma_f32_16x16x32_bf16 v[124:127], v[48:51], v[80:83], v[124:127]
    v_mfma_f32_16x16x32_bf16 v[196:199], v[48:51], v[84:87], v[196:199]
    ds_read_b64_tr_b16 v[68:69], v13 offset:9376
    ds_read_b64_tr_b16 v[70:71], v13 offset:13984
    s_waitcnt lgkmcnt(8)
    v_mfma_f32_16x16x32_bf16 v[160:163], v[52:55], v[80:83], v[160:163]
    v_mfma_f32_16x16x32_bf16 v[232:235], v[52:55], v[84:87], v[232:235]
    ds_read_b64_tr_b16 v[48:49], v13 offset:192
    ds_read_b64_tr_b16 v[50:51], v13 offset:4800
    s_waitcnt lgkmcnt(8)
    v_mfma_f32_16x16x32_bf16 v[128:131], v[56:59], v[80:83], v[128:131]
    v_mfma_f32_16x16x32_bf16 v[200:203], v[56:59], v[84:87], v[200:203]
    ds_read_b64_tr_b16 v[52:53], v13 offset:9408
    ds_read_b64_tr_b16 v[54:55], v13 offset:14016
    s_waitcnt lgkmcnt(8)
    v_mfma_f32_16x16x32_bf16 v[164:167], v[60:63], v[80:83], v[164:167]
    v_mfma_f32_16x16x32_bf16 v[236:239], v[60:63], v[84:87], v[236:239]
    ds_read_b64_tr_b16 v[56:57], v13 offset:224
    ds_read_b64_tr_b16 v[58:59], v13 offset:4832
    s_waitcnt lgkmcnt(8)
    v_mfma_f32_16x16x32_bf16 v[132:135], v[64:67], v[80:83], v[132:135]
    v_mfma_f32_16x16x32_bf16 v[204:207], v[64:67], v[84:87], v[204:207]
    ds_read_b64_tr_b16 v[60:61], v13 offset:9440
    ds_read_b64_tr_b16 v[62:63], v13 offset:14048
    s_waitcnt lgkmcnt(8)
    v_mfma_f32_16x16x32_bf16 v[168:171], v[68:71], v[80:83], v[168:171]
    v_mfma_f32_16x16x32_bf16 v[240:243], v[68:71], v[84:87], v[240:243]
    ds_read_b64_tr_b16 v[64:65], v13 offset:256
    ds_read_b64_tr_b16 v[66:67], v13 offset:4864
    s_waitcnt lgkmcnt(8)
    v_mfma_f32_16x16x32_bf16 v[136:139], v[48:51], v[80:83], v[136:139]
    v_mfma_f32_16x16x32_bf16 v[208:211], v[48:51], v[84:87], v[208:211]
    ds_read_b64_tr_b16 v[68:69], v13 offset:9472
    ds_read_b64_tr_b16 v[70:71], v13 offset:14080
    s_waitcnt lgkmcnt(8)
    v_mfma_f32_16x16x32_bf16 v[172:175], v[52:55], v[80:83], v[172:175]
    v_mfma_f32_16x16x32_bf16 v[244:247], v[52:55], v[84:87], v[244:247]
    ds_read_b64_tr_b16 v[48:49], v13 offset:18432
    ds_read_b64_tr_b16 v[50:51], v13 offset:23040
    s_waitcnt lgkmcnt(8)
    v_mfma_f32_16x16x32_bf16 v[140:143], v[56:59], v[80:83], v[140:143]
    v_mfma_f32_16x16x32_bf16 v[212:215], v[56:59], v[84:87], v[212:215]
    ds_read_b64_tr_b16 v[52:53], v13 offset:27648
    ds_read_b64_tr_b16 v[54:55], v13 offset:32256
    s_waitcnt lgkmcnt(8)
    v_mfma_f32_16x16x32_bf16 v[176:179], v[60:63], v[80:83], v[176:179]
    v_mfma_f32_16x16x32_bf16 v[248:251], v[60:63], v[84:87], v[248:251]
    ds_read_b64_tr_b16 v[56:57], v13 offset:18464
    ds_read_b64_tr_b16 v[58:59], v13 offset:23072
    s_waitcnt lgkmcnt(8)
    v_mfma_f32_16x16x32_bf16 v[144:147], v[64:67], v[80:83], v[144:147]
    v_mfma_f32_16x16x32_bf16 v[216:219], v[64:67], v[84:87], v[216:219]
    ds_read_b64_tr_b16 v[60:61], v13 offset:27680
    ds_read_b64_tr_b16 v[62:63], v13 offset:32288
    s_waitcnt lgkmcnt(8)
    v_mfma_f32_16x16x32_bf16 v[180:183], v[68:71], v[80:83], v[180:183]
    v_mfma_f32_16x16x32_bf16 v[252:255], v[68:71], v[84:87], v[252:255]
    ds_read_b64_tr_b16 v[64:65], v13 offset:18496
    ds_read_b64_tr_b16 v[66:67], v13 offset:23104
    s_waitcnt lgkmcnt(8)
    v_mfma_f32_16x16x32_bf16 v[112:115], v[48:51], v[88:91], v[112:115]
    v_mfma_f32_16x16x32_bf16 v[184:187], v[48:51], v[92:95], v[184:187]
    ds_read_b64_tr_b16 v[68:69], v13 offset:27712
    ds_read_b64_tr_b16 v[70:71], v13 offset:32320
    s_waitcnt lgkmcnt(8)
    v_mfma_f32_16x16x32_bf16 v[148:151], v[52:55], v[88:91], v[148:151]
    v_mfma_f32_16x16x32_bf16 v[220:223], v[52:55], v[92:95], v[220:223]
    ds_read_b64_tr_b16 v[48:49], v13 offset:18528
    ds_read_b64_tr_b16 v[50:51], v13 offset:23136
    s_waitcnt lgkmcnt(8)
    v_mfma_f32_16x16x32_bf16 v[116:119], v[56:59], v[88:91], v[116:119]
    v_mfma_f32_16x16x32_bf16 v[188:191], v[56:59], v[92:95], v[188:191]
    ds_read_b64_tr_b16 v[52:53], v13 offset:27744
    ds_read_b64_tr_b16 v[54:55], v13 offset:32352
    s_waitcnt lgkmcnt(8)
    v_mfma_f32_16x16x32_bf16 v[152:155], v[60:63], v[88:91], v[152:155]
    v_mfma_f32_16x16x32_bf16 v[224:227], v[60:63], v[92:95], v[224:227]
    ds_read_b64_tr_b16 v[56:57], v13 offset:18560
    ds_read_b64_tr_b16 v[58:59], v13 offset:23168
    s_waitcnt lgkmcnt(8)
    v_mfma_f32_16x16x32_bf16 v[120:123], v[64:67], v[88:91], v[120:123]
    v_mfma_f32_16x16x32_bf16 v[192:195], v[64:67], v[92:95], v[192:195]
    ds_read_b64_tr_b16 v[60:61], v13 offset:27776
    ds_read_b64_tr_b16 v[62:63], v13 offset:32384
    s_waitcnt lgkmcnt(8)
    v_mfma_f32_16x16x32_bf16 v[156:159], v[68:71], v[88:91], v[156:159]
    v_mfma_f32_16x16x32_bf16 v[228:231], v[68:71], v[92:95], v[228:231]
    ds_read_b64_tr_b16 v[64:65], v13 offset:18592
    ds_read_b64_tr_b16 v[66:67], v13 offset:23200
    s_waitcnt lgkmcnt(8)
    v_mfma_f32_16x16x32_bf16 v[124:127], v[48:51], v[88:91], v[124:127]
    v_mfma_f32_16x16x32_bf16 v[196:199], v[48:51], v[92:95], v[196:199]
    ds_read_b64_tr_b16 v[68:69], v13 offset:27808
    ds_read_b64_tr_b16 v[70:71], v13 offset:32416
    s_waitcnt lgkmcnt(8)
    v_mfma_f32_16x16x32_bf16 v[160:163], v[52:55], v[88:91], v[160:163]
    v_mfma_f32_16x16x32_bf16 v[232:235], v[52:55], v[92:95], v[232:235]
    ds_read_b64_tr_b16 v[48:49], v13 offset:18624
    ds_read_b64_tr_b16 v[50:51], v13 offset:23232
    s_waitcnt lgkmcnt(8)
    v_mfma_f32_16x16x32_bf16 v[128:131], v[56:59], v[88:91], v[128:131]
    v_mfma_f32_16x16x32_bf16 v[200:203], v[56:59], v[92:95], v[200:203]
    ds_read_b64_tr_b16 v[52:53], v13 offset:27840
    ds_read_b64_tr_b16 v[54:55], v13 offset:32448
    s_waitcnt lgkmcnt(8)
    v_mfma_f32_16x16x32_bf16 v[164:167], v[60:63], v[88:91], v[164:167]
    v_mfma_f32_16x16x32_bf16 v[236:239], v[60:63], v[92:95], v[236:239]
    ds_read_b64_tr_b16 v[56:57], v13 offset:18656
    ds_read_b64_tr_b16 v[58:59], v13 offset:23264
    s_waitcnt lgkmcnt(8)
    v_mfma_f32_16x16x32_bf16 v[132:135], v[64:67], v[88:91], v[132:135]
    v_mfma_f32_16x16x32_bf16 v[204:207], v[64:67], v[92:95], v[204:207]
    ds_read_b64_tr_b16 v[60:61], v13 offset:27872
    ds_read_b64_tr_b16 v[62:63], v13 offset:32480
    s_waitcnt lgkmcnt(8)
    v_mfma_f32_16x16x32_bf16 v[168:171], v[68:71], v[88:91], v[168:171]
    v_mfma_f32_16x16x32_bf16 v[240:243], v[68:71], v[92:95], v[240:243]
    ds_read_b64_tr_b16 v[64:65], v13 offset:18688
    ds_read_b64_tr_b16 v[66:67], v13 offset:23296
    s_waitcnt lgkmcnt(8)
    v_mfma_f32_16x16x32_bf16 v[136:139], v[48:51], v[88:91], v[136:139]
    v_mfma_f32_16x16x32_bf16 v[208:211], v[48:51], v[92:95], v[208:211]
    ds_read_b64_tr_b16 v[68:69], v13 offset:27904
    ds_read_b64_tr_b16 v[70:71], v13 offset:32512
    s_waitcnt lgkmcnt(8)
    v_mfma_f32_16x16x32_bf16 v[172:175], v[52:55], v[88:91], v[172:175]
    v_mfma_f32_16x16x32_bf16 v[244:247], v[52:55], v[92:95], v[244:247]
    s_waitcnt lgkmcnt(6)
    v_mfma_f32_16x16x32_bf16 v[140:143], v[56:59], v[88:91], v[140:143]
    v_mfma_f32_16x16x32_bf16 v[212:215], v[56:59], v[92:95], v[212:215]
    s_waitcnt lgkmcnt(4)
    v_mfma_f32_16x16x32_bf16 v[176:179], v[60:63], v[88:91], v[176:179]
    v_mfma_f32_16x16x32_bf16 v[248:251], v[60:63], v[92:95], v[248:251]
    s_waitcnt lgkmcnt(2)
    v_mfma_f32_16x16x32_bf16 v[144:147], v[64:67], v[88:91], v[144:147]
    v_mfma_f32_16x16x32_bf16 v[216:219], v[64:67], v[92:95], v[216:219]
    s_waitcnt lgkmcnt(0)
    v_mfma_f32_16x16x32_bf16 v[180:183], v[68:71], v[88:91], v[180:183]
    v_mfma_f32_16x16x32_bf16 v[252:255], v[68:71], v[92:95], v[252:255]
k3_epi:
    s_setprio 0
    s_nop 7
    v_add_f32 v20, v6, v8
    v_add_f32 v21, v7, v9
    v_mov_b32 v22, v20
    v_mov_b32 v23, v21
    s_nop 0
    v_permlane32_swap_b32 v20, v22
    v_permlane32_swap_b32 v21, v23
    v_add_f32 v20, v20, v22
    v_add_f32 v21, v21, v23
    v_mul_f32 v20, 0x3ae38e39, v20
    v_mul_f32 v21, 0x3ae38e39, v21
    v_fma_f32 v21, -v20, v20, v21
    v_max_f32 v21, 0, v21
    v_cvt_pk_bf16_f32 v21, v21, v21
    v_lshlrev_b32 v21, 16, v21
    v_add_f32 v21, 0x3727c5ac, v21
    v_cvt_pk_bf16_f32 v21, v21, v21
    v_lshlrev_b32 v21, 16, v21
    v_sqrt_f32 v21, v21
    s_nop 0
    v_cvt_pk_bf16_f32 v21, v21, v21
    v_lshlrev_b32 v21, 16, v21
    v_rcp_f32 v21, v21
    v_cvt_pk_bf16_f32 v20, v20, v20
    v_lshlrev_b32 v20, 16, v20
    v_mul_f32 v20, v20, v21
    v_sub_f32 v20, 0, v20
    v_mov_b32 v24, v21
    v_mov_b32 v26, v21
    v_mov_b32 v28, v20
    v_mov_b32 v30, v20
    v_permlane16_swap_b32 v24, v26
    s_nop 0
    v_permlane16_swap_b32 v28, v30
    v_lshlrev_b32 v5, 4, v4
    v_add_u32 v5, 147456, v5
    s_mul_i32 s27, s24, 147456
    s_add_u32 s27, s27, 17825792
    s_lshr_b32 s28, s20, 1
    s_mul_i32 s28, s28, 9216
    s_add_u32 s27, s27, s28
    s_and_b32 s28, s20, 1
    s_lshl_b32 s42, s28, 3
    s_add_u32 s42, s42, s27
    s_add_u32 s42, s42, 8192
    s_add_u32 s43, s42, 147456
    s_lshl_b32 s28, s28, 12
    s_add_u32 s32, s27, s28
    s_add_u32 s33, s32, 147456
    s_mov_b32 s40, 0xbfb8aa3b
    s_mov_b32 s41, 0xbfb8aa3b
    ds_read_b128 v[48:51], v5 offset:0
    ds_read_b128 v[52:55], v5 offset:576
    ds_read_b128 v[56:59], v5 offset:1152
    ds_read_b128 v[60:63], v5 offset:1728
    ds_read_b128 v[64:67], v5 offset:64
    ds_read_b128 v[68:71], v5 offset:640
    ds_read_b128 v[72:75], v5 offset:1216
    ds_read_b128 v[76:79], v5 offset:1792
    s_waitcnt lgkmcnt(4)
    v_fma_f32 v80, v48, v28, v52
    v_fma_f32 v81, v49, v28, v53
    v_fma_f32 v82, v50, v28, v54
    v_fma_f32 v83, v51, v28, v55
    v_fma_f32 v84, v48, v30, v52
    v_fma_f32 v85, v49, v30, v53
    v_fma_f32 v86, v50, v30, v54
    v_fma_f32 v87, v51, v30, v55
    v_fma_f32 v88, v56, v28, v60
    v_fma_f32 v89, v57, v28, v61
    v_fma_f32 v90, v58, v28, v62
    v_fma_f32 v91, v59, v28, v63
    v_fma_f32 v92, v56, v30, v60
    v_fma_f32 v93, v57, v30, v61
    v_fma_f32 v94, v58, v30, v62
    v_fma_f32 v95, v59, v30, v63
    v_fma_f32 v80, v112, v24, v80
    v_fma_f32 v81, v113, v24, v81
    v_fma_f32 v82, v114, v24, v82
    v_fma_f32 v83, v115, v24, v83
    v_fma_f32 v84, v184, v26, v84
    v_fma_f32 v85, v185, v26, v85
    v_fma_f32 v86, v186, v26, v86
    v_fma_f32 v87, v187, v26, v87
    v_mul_f32 v96, s40, v80
    v_mul_f32 v97, s41, v81
    v_mul_f32 v98, s40, v82
    v_mul_f32 v99, s41, v83
    v_mul_f32 v100, s40, v84
    v_mul_f32 v101, s41, v85
    v_mul_f32 v102, s40, v86
    v_mul_f32 v103, s41, v87
    v_fma_f32 v88, v148, v24, v88
    v_fma_f32 v89, v149, v24, v89
    v_fma_f32 v90, v150, v24, v90
    v_fma_f32 v91, v151, v24, v91
    v_fma_f32 v92, v220, v26, v92
    v_fma_f32 v93, v221, v26, v93
    v_fma_f32 v94, v222, v26, v94
    v_fma_f32 v95, v223, v26, v95
    v_exp_f32 v96, v96
    v_exp_f32 v97, v97
    v_exp_f32 v98, v98
    v_exp_f32 v99, v99
    v_exp_f32 v100, v100
    v_exp_f32 v101, v101
    v_exp_f32 v102, v102
    v_exp_f32 v103, v103
    v_mul_f32 v80, v80, v88
    v_mul_f32 v81, v81, v89
    v_mul_f32 v82, v82, v90
    v_mul_f32 v83, v83, v91
    v_mul_f32 v84, v84, v92
    v_mul_f32 v85, v85, v93
    v_mul_f32 v86, v86, v94
    v_mul_f32 v87, v87, v95
    v_add_f32 v96, 1.0, v96
    v_add_f32 v97, 1.0, v97
    v_add_f32 v98, 1.0, v98
    v_add_f32 v99, 1.0, v99
    v_add_f32 v100, 1.0, v100
    v_add_f32 v101, 1.0, v101
    v_add_f32 v102, 1.0, v102
    v_add_f32 v103, 1.0, v103
    v_rcp_f32 v96, v96
    v_rcp_f32 v97, v97
    v_rcp_f32 v98, v98
    v_rcp_f32 v99, v99
    v_rcp_f32 v100, v100
    v_rcp_f32 v101, v101
    v_rcp_f32 v102, v102
    v_rcp_f32 v103, v103
    v_mul_f32 v80, v80, v96
    v_mul_f32 v81, v81, v97
    v_mul_f32 v82, v82, v98
    v_mul_f32 v83, v83, v99
    v_mul_f32 v84, v84, v100
    v_mul_f32 v85, v85, v101
    v_mul_f32 v86, v86, v102
    v_mul_f32 v87, v87, v103
    v_cvt_pk_bf16_f32 v32, v80, v81
    v_cvt_pk_bf16_f32 v33, v82, v83
    v_cvt_pk_bf16_f32 v36, v84, v85
    v_cvt_pk_bf16_f32 v37, v86, v87
    ds_read_b128 v[48:51], v5 offset:128
    ds_read_b128 v[52:55], v5 offset:704
    ds_read_b128 v[56:59], v5 offset:1280
    ds_read_b128 v[60:63], v5 offset:1856
    s_waitcnt lgkmcnt(4)
    v_fma_f32 v80, v64, v28, v68
    v_fma_f32 v81, v65, v28, v69
    v_fma_f32 v82, v66, v28, v70
    v_fma_f32 v83, v67, v28, v71
    v_fma_f32 v84, v64, v30, v68
    v_fma_f32 v85, v65, v30, v69
    v_fma_f32 v86, v66, v30, v70
    v_fma_f32 v87, v67, v30, v71
    v_fma_f32 v88, v72, v28, v76
    v_fma_f32 v89, v73, v28, v77
    v_fma_f32 v90, v74, v28, v78
    v_fma_f32 v91, v75, v28, v79
    v_fma_f32 v92, v72, v30, v76
    v_fma_f32 v93, v73, v30, v77
    v_fma_f32 v94, v74, v30, v78
    v_fma_f32 v95, v75, v30, v79
    v_fma_f32 v80, v116, v24, v80
    v_fma_f32 v81, v117, v24, v81
    v_fma_f32 v82, v118, v24, v82
    v_fma_f32 v83, v119, v24, v83
    v_fma_f32 v84, v188, v26, v84
    v_fma_f32 v85, v189, v26, v85
    v_fma_f32 v86, v190, v26, v86
    v_fma_f32 v87, v191, v26, v87
    v_mul_f32 v96, s40, v80
    v_mul_f32 v97, s41, v81
    v_mul_f32 v98, s40, v82
    v_mul_f32 v99, s41, v83
    v_mul_f32 v100, s40, v84
    v_mul_f32 v101, s41, v85
    v_mul_f32 v102, s40, v86
    v_mul_f32 v103, s41, v87
    v_fma_f32 v88, v152, v24, v88
    v_fma_f32 v89, v153, v24, v89
    v_fma_f32 v90, v154, v24, v90
    v_fma_f32 v91, v155, v24, v91
    v_fma_f32 v92, v224, v26, v92
    v_fma_f32 v93, v225, v26, v93
    v_fma_f32 v94, v226, v26, v94
    v_fma_f32 v95, v227, v26, v95
    v_exp_f32 v96, v96
    v_exp_f32 v97, v97
    v_exp_f32 v98, v98
    v_exp_f32 v99, v99
    v_exp_f32 v100, v100
    v_exp_f32 v101, v101
    v_exp_f32 v102, v102
    v_exp_f32 v103, v103
    v_mul_f32 v80, v80, v88
    v_mul_f32 v81, v81, v89
    v_mul_f32 v82, v82, v90
    v_mul_f32 v83, v83, v91
    v_mul_f32 v84, v84, v92
    v_mul_f32 v85, v85, v93
    v_mul_f32 v86, v86, v94
    v_mul_f32 v87, v87, v95
    v_add_f32 v96, 1.0, v96
    v_add_f32 v97, 1.0, v97
    v_add_f32 v98, 1.0, v98
    v_add_f32 v99, 1.0, v99
    v_add_f32 v100, 1.0, v100
    v_add_f32 v101, 1.0, v101
    v_add_f32 v102, 1.0, v102
    v_add_f32 v103, 1.0, v103
    v_rcp_f32 v96, v96
    v_rcp_f32 v97, v97
    v_rcp_f32 v98, v98
    v_rcp_f32 v99, v99
    v_rcp_f32 v100, v100
    v_rcp_f32 v101, v101
    v_rcp_f32 v102, v102
    v_rcp_f32 v103, v103
    v_mul_f32 v80, v80, v96
    v_mul_f32 v81, v81, v97
    v_mul_f32 v82, v82, v98
    v_mul_f32 v83, v83, v99
    v_mul_f32 v84, v84, v100
    v_mul_f32 v85, v85, v101
    v_mul_f32 v86, v86, v102
    v_mul_f32 v87, v87, v103
    v_cvt_pk_bf16_f32 v34, v80, v81
    v_cvt_pk_bf16_f32 v35, v82, v83
    v_cvt_pk_bf16_f32 v38, v84, v85
    v_cvt_pk_bf16_f32 v39, v86, v87
    buffer_store_dwordx4 v[32:35], v3, s[12:15], s32 offen offset:0 sc1
    buffer_store_dwordx4 v[36:39], v3, s[12:15], s33 offen offset:0 sc1
    ds_read_b128 v[64:67], v5 offset:192
    ds_read_b128 v[68:71], v5 offset:768
    ds_read_b128 v[72:75], v5 offset:1344
    ds_read_b128 v[76:79], v5 offset:1920
    s_waitcnt lgkmcnt(4)
    v_fma_f32 v80, v48, v28, v52
    v_fma_f32 v81, v49, v28, v53
    v_fma_f32 v82, v50, v28, v54
    v_fma_f32 v83, v51, v28, v55
    v_fma_f32 v84, v48, v30, v52
    v_fma_f32 v85, v49, v30, v53
    v_fma_f32 v86, v50, v30, v54
    v_fma_f32 v87, v51, v30, v55
    v_fma_f32 v88, v56, v28, v60
    v_fma_f32 v89, v57, v28, v61
    v_fma_f32 v90, v58, v28, v62
    v_fma_f32 v91, v59, v28, v63
    v_fma_f32 v92, v56, v30, v60
    v_fma_f32 v93, v57, v30, v61
    v_fma_f32 v94, v58, v30, v62
    v_fma_f32 v95, v59, v30, v63
    v_fma_f32 v80, v120, v24, v80
    v_fma_f32 v81, v121, v24, v81
    v_fma_f32 v82, v122, v24, v82
    v_fma_f32 v83, v123, v24, v83
    v_fma_f32 v84, v192, v26, v84
    v_fma_f32 v85, v193, v26, v85
    v_fma_f32 v86, v194, v26, v86
    v_fma_f32 v87, v195, v26, v87
    v_mul_f32 v96, s40, v80
    v_mul_f32 v97, s41, v81
    v_mul_f32 v98, s40, v82
    v_mul_f32 v99, s41, v83
    v_mul_f32 v100, s40, v84
    v_mul_f32 v101, s41, v85
    v_mul_f32 v102, s40, v86
    v_mul_f32 v103, s41, v87
    v_fma_f32 v88, v156, v24, v88
    v_fma_f32 v89, v157, v24, v89
    v_fma_f32 v90, v158, v24, v90
    v_fma_f32 v91, v159, v24, v91
    v_fma_f32 v92, v228, v26, v92
    v_fma_f32 v93, v229, v26, v93
    v_fma_f32 v94, v230, v26, v94
    v_fma_f32 v95, v231, v26, v95
    v_exp_f32 v96, v96
    v_exp_f32 v97, v97
    v_exp_f32 v98, v98
    v_exp_f32 v99, v99
    v_exp_f32 v100, v100
    v_exp_f32 v101, v101
    v_exp_f32 v102, v102
    v_exp_f32 v103, v103
    v_mul_f32 v80, v80, v88
    v_mul_f32 v81, v81, v89
    v_mul_f32 v82, v82, v90
    v_mul_f32 v83, v83, v91
    v_mul_f32 v84, v84, v92
    v_mul_f32 v85, v85, v93
    v_mul_f32 v86, v86, v94
    v_mul_f32 v87, v87, v95
    v_add_f32 v96, 1.0, v96
    v_add_f32 v97, 1.0, v97
    v_add_f32 v98, 1.0, v98
    v_add_f32 v99, 1.0, v99
    v_add_f32 v100, 1.0, v100
    v_add_f32 v101, 1.0, v101
    v_add_f32 v102, 1.0, v102
    v_add_f32 v103, 1.0, v103
    v_rcp_f32 v96, v96
    v_rcp_f32 v97, v97
    v_rcp_f32 v98, v98
    v_rcp_f32 v99, v99
    v_rcp_f32 v100, v100
    v_rcp_f32 v101, v101
    v_rcp_f32 v102, v102
    v_rcp_f32 v103, v103
    v_mul_f32 v80, v80, v96
    v_mul_f32 v81, v81, v97
    v_mul_f32 v82, v82, v98
    v_mul_f32 v83, v83, v99
    v_mul_f32 v84, v84, v100
    v_mul_f32 v85, v85, v101
    v_mul_f32 v86, v86, v102
    v_mul_f32 v87, v87, v103
    v_cvt_pk_bf16_f32 v40, v80, v81
    v_cvt_pk_bf16_f32 v41, v82, v83
    v_cvt_pk_bf16_f32 v44, v84, v85
    v_cvt_pk_bf16_f32 v45, v86, v87
    ds_read_b128 v[48:51], v5 offset:256
    ds_read_b128 v[52:55], v5 offset:832
    ds_read_b128 v[56:59], v5 offset:1408
    ds_read_b128 v[60:63], v5 offset:1984
    s_waitcnt lgkmcnt(4)
    v_fma_f32 v80, v64, v28, v68
    v_fma_f32 v81, v65, v28, v69
    v_fma_f32 v82, v66, v28, v70
    v_fma_f32 v83, v67, v28, v71
    v_fma_f32 v84, v64, v30, v68
    v_fma_f32 v85, v65, v30, v69
    v_fma_f32 v86, v66, v30, v70
    v_fma_f32 v87, v67, v30, v71
    v_fma_f32 v88, v72, v28, v76
    v_fma_f32 v89, v73, v28, v77
    v_fma_f32 v90, v74, v28, v78
    v_fma_f32 v91, v75, v28, v79
    v_fma_f32 v92, v72, v30, v76
    v_fma_f32 v93, v73, v30, v77
    v_fma_f32 v94, v74, v30, v78
    v_fma_f32 v95, v75, v30, v79
    v_fma_f32 v80, v124, v24, v80
    v_fma_f32 v81, v125, v24, v81
    v_fma_f32 v82, v126, v24, v82
    v_fma_f32 v83, v127, v24, v83
    v_fma_f32 v84, v196, v26, v84
    v_fma_f32 v85, v197, v26, v85
    v_fma_f32 v86, v198, v26, v86
    v_fma_f32 v87, v199, v26, v87
    v_mul_f32 v96, s40, v80
    v_mul_f32 v97, s41, v81
    v_mul_f32 v98, s40, v82
    v_mul_f32 v99, s41, v83
    v_mul_f32 v100, s40, v84
    v_mul_f32 v101, s41, v85
    v_mul_f32 v102, s40, v86
    v_mul_f32 v103, s41, v87
    v_fma_f32 v88, v160, v24, v88
    v_fma_f32 v89, v161, v24, v89
    v_fma_f32 v90, v162, v24, v90
    v_fma_f32 v91, v163, v24, v91
    v_fma_f32 v92, v232, v26, v92
    v_fma_f32 v93, v233, v26, v93
    v_fma_f32 v94, v234, v26, v94
    v_fma_f32 v95, v235, v26, v95
    v_exp_f32 v96, v96
    v_exp_f32 v97, v97
    v_exp_f32 v98, v98
    v_exp_f32 v99, v99
    v_exp_f32 v100, v100
    v_exp_f32 v101, v101
    v_exp_f32 v102, v102
    v_exp_f32 v103, v103
    v_mul_f32 v80, v80, v88
    v_mul_f32 v81, v81, v89
    v_mul_f32 v82, v82, v90
    v_mul_f32 v83, v83, v91
    v_mul_f32 v84, v84, v92
    v_mul_f32 v85, v85, v93
    v_mul_f32 v86, v86, v94
    v_mul_f32 v87, v87, v95
    v_add_f32 v96, 1.0, v96
    v_add_f32 v97, 1.0, v97
    v_add_f32 v98, 1.0, v98
    v_add_f32 v99, 1.0, v99
    v_add_f32 v100, 1.0, v100
    v_add_f32 v101, 1.0, v101
    v_add_f32 v102, 1.0, v102
    v_add_f32 v103, 1.0, v103
    v_rcp_f32 v96, v96
    v_rcp_f32 v97, v97
    v_rcp_f32 v98, v98
    v_rcp_f32 v99, v99
    v_rcp_f32 v100, v100
    v_rcp_f32 v101, v101
    v_rcp_f32 v102, v102
    v_rcp_f32 v103, v103
    v_mul_f32 v80, v80, v96
    v_mul_f32 v81, v81, v97
    v_mul_f32 v82, v82, v98
    v_mul_f32 v83, v83, v99
    v_mul_f32 v84, v84, v100
    v_mul_f32 v85, v85, v101
    v_mul_f32 v86, v86, v102
    v_mul_f32 v87, v87, v103
    v_cvt_pk_bf16_f32 v42, v80, v81
    v_cvt_pk_bf16_f32 v43, v82, v83
    v_cvt_pk_bf16_f32 v46, v84, v85
    v_cvt_pk_bf16_f32 v47, v86, v87
    buffer_store_dwordx4 v[40:43], v3, s[12:15], s32 offen offset:1024 sc1
    buffer_store_dwordx4 v[44:47], v3, s[12:15], s33 offen offset:1024 sc1
    ds_read_b128 v[64:67], v5 offset:320
    ds_read_b128 v[68:71], v5 offset:896
    ds_read_b128 v[72:75], v5 offset:1472
    ds_read_b128 v[76:79], v5 offset:2048
    s_waitcnt lgkmcnt(4)
    v_fma_f32 v80, v48, v28, v52
    v_fma_f32 v81, v49, v28, v53
    v_fma_f32 v82, v50, v28, v54
    v_fma_f32 v83, v51, v28, v55
    v_fma_f32 v84, v48, v30, v52
    v_fma_f32 v85, v49, v30, v53
    v_fma_f32 v86, v50, v30, v54
    v_fma_f32 v87, v51, v30, v55
    v_fma_f32 v88, v56, v28, v60
    v_fma_f32 v89, v57, v28, v61
    v_fma_f32 v90, v58, v28, v62
    v_fma_f32 v91, v59, v28, v63
    v_fma_f32 v92, v56, v30, v60
    v_fma_f32 v93, v57, v30, v61
    v_fma_f32 v94, v58, v30, v62
    v_fma_f32 v95, v59, v30, v63
    v_fma_f32 v80, v128, v24, v80
    v_fma_f32 v81, v129, v24, v81
    v_fma_f32 v82, v130, v24, v82
    v_fma_f32 v83, v131, v24, v83
    v_fma_f32 v84, v200, v26, v84
    v_fma_f32 v85, v201, v26, v85
    v_fma_f32 v86, v202, v26, v86
    v_fma_f32 v87, v203, v26, v87
    v_mul_f32 v96, s40, v80
    v_mul_f32 v97, s41, v81
    v_mul_f32 v98, s40, v82
    v_mul_f32 v99, s41, v83
    v_mul_f32 v100, s40, v84
    v_mul_f32 v101, s41, v85
    v_mul_f32 v102, s40, v86
    v_mul_f32 v103, s41, v87
    v_fma_f32 v88, v164, v24, v88
    v_fma_f32 v89, v165, v24, v89
    v_fma_f32 v90, v166, v24, v90
    v_fma_f32 v91, v167, v24, v91
    v_fma_f32 v92, v236, v26, v92
    v_fma_f32 v93, v237, v26, v93
    v_fma_f32 v94, v238, v26, v94
    v_fma_f32 v95, v239, v26, v95
    v_exp_f32 v96, v96
    v_exp_f32 v97, v97
    v_exp_f32 v98, v98
    v_exp_f32 v99, v99
    v_exp_f32 v100, v100
    v_exp_f32 v101, v101
    v_exp_f32 v102, v102
    v_exp_f32 v103, v103
    v_mul_f32 v80, v80, v88
    v_mul_f32 v81, v81, v89
    v_mul_f32 v82, v82, v90
    v_mul_f32 v83, v83, v91
    v_mul_f32 v84, v84, v92
    v_mul_f32 v85, v85, v93
    v_mul_f32 v86, v86, v94
    v_mul_f32 v87, v87, v95
    v_add_f32 v96, 1.0, v96
    v_add_f32 v97, 1.0, v97
    v_add_f32 v98, 1.0, v98
    v_add_f32 v99, 1.0, v99
    v_add_f32 v100, 1.0, v100
    v_add_f32 v101, 1.0, v101
    v_add_f32 v102, 1.0, v102
    v_add_f32 v103, 1.0, v103
    v_rcp_f32 v96, v96
    v_rcp_f32 v97, v97
    v_rcp_f32 v98, v98
    v_rcp_f32 v99, v99
    v_rcp_f32 v100, v100
    v_rcp_f32 v101, v101
    v_rcp_f32 v102, v102
    v_rcp_f32 v103, v103
    v_mul_f32 v80, v80, v96
    v_mul_f32 v81, v81, v97
    v_mul_f32 v82, v82, v98
    v_mul_f32 v83, v83, v99
    v_mul_f32 v84, v84, v100
    v_mul_f32 v85, v85, v101
    v_mul_f32 v86, v86, v102
    v_mul_f32 v87, v87, v103
    v_cvt_pk_bf16_f32 v32, v80, v81
    v_cvt_pk_bf16_f32 v33, v82, v83
    v_cvt_pk_bf16_f32 v36, v84, v85
    v_cvt_pk_bf16_f32 v37, v86, v87
    ds_read_b128 v[48:51], v5 offset:384
    ds_read_b128 v[52:55], v5 offset:960
    ds_read_b128 v[56:59], v5 offset:1536
    ds_read_b128 v[60:63], v5 offset:2112
    s_waitcnt lgkmcnt(4)
    v_fma_f32 v80, v64, v28, v68
    v_fma_f32 v81, v65, v28, v69
    v_fma_f32 v82, v66, v28, v70
    v_fma_f32 v83, v67, v28, v71
    v_fma_f32 v84, v64, v30, v68
    v_fma_f32 v85, v65, v30, v69
    v_fma_f32 v86, v66, v30, v70
    v_fma_f32 v87, v67, v30, v71
    v_fma_f32 v88, v72, v28, v76
    v_fma_f32 v89, v73, v28, v77
    v_fma_f32 v90, v74, v28, v78
    v_fma_f32 v91, v75, v28, v79
    v_fma_f32 v92, v72, v30, v76
    v_fma_f32 v93, v73, v30, v77
    v_fma_f32 v94, v74, v30, v78
    v_fma_f32 v95, v75, v30, v79
    v_fma_f32 v80, v132, v24, v80
    v_fma_f32 v81, v133, v24, v81
    v_fma_f32 v82, v134, v24, v82
    v_fma_f32 v83, v135, v24, v83
    v_fma_f32 v84, v204, v26, v84
    v_fma_f32 v85, v205, v26, v85
    v_fma_f32 v86, v206, v26, v86
    v_fma_f32 v87, v207, v26, v87
    v_mul_f32 v96, s40, v80
    v_mul_f32 v97, s41, v81
    v_mul_f32 v98, s40, v82
    v_mul_f32 v99, s41, v83
    v_mul_f32 v100, s40, v84
    v_mul_f32 v101, s41, v85
    v_mul_f32 v102, s40, v86
    v_mul_f32 v103, s41, v87
    v_fma_f32 v88, v168, v24, v88
    v_fma_f32 v89, v169, v24, v89
    v_fma_f32 v90, v170, v24, v90
    v_fma_f32 v91, v171, v24, v91
    v_fma_f32 v92, v240, v26, v92
    v_fma_f32 v93, v241, v26, v93
    v_fma_f32 v94, v242, v26, v94
    v_fma_f32 v95, v243, v26, v95
    v_exp_f32 v96, v96
    v_exp_f32 v97, v97
    v_exp_f32 v98, v98
    v_exp_f32 v99, v99
    v_exp_f32 v100, v100
    v_exp_f32 v101, v101
    v_exp_f32 v102, v102
    v_exp_f32 v103, v103
    v_mul_f32 v80, v80, v88
    v_mul_f32 v81, v81, v89
    v_mul_f32 v82, v82, v90
    v_mul_f32 v83, v83, v91
    v_mul_f32 v84, v84, v92
    v_mul_f32 v85, v85, v93
    v_mul_f32 v86, v86, v94
    v_mul_f32 v87, v87, v95
    v_add_f32 v96, 1.0, v96
    v_add_f32 v97, 1.0, v97
    v_add_f32 v98, 1.0, v98
    v_add_f32 v99, 1.0, v99
    v_add_f32 v100, 1.0, v100
    v_add_f32 v101, 1.0, v101
    v_add_f32 v102, 1.0, v102
    v_add_f32 v103, 1.0, v103
    v_rcp_f32 v96, v96
    v_rcp_f32 v97, v97
    v_rcp_f32 v98, v98
    v_rcp_f32 v99, v99
    v_rcp_f32 v100, v100
    v_rcp_f32 v101, v101
    v_rcp_f32 v102, v102
    v_rcp_f32 v103, v103
    v_mul_f32 v80, v80, v96
    v_mul_f32 v81, v81, v97
    v_mul_f32 v82, v82, v98
    v_mul_f32 v83, v83, v99
    v_mul_f32 v84, v84, v100
    v_mul_f32 v85, v85, v101
    v_mul_f32 v86, v86, v102
    v_mul_f32 v87, v87, v103
    v_cvt_pk_bf16_f32 v34, v80, v81
    v_cvt_pk_bf16_f32 v35, v82, v83
    v_cvt_pk_bf16_f32 v38, v84, v85
    v_cvt_pk_bf16_f32 v39, v86, v87
    buffer_store_dwordx4 v[32:35], v3, s[12:15], s32 offen offset:2048 sc1
    buffer_store_dwordx4 v[36:39], v3, s[12:15], s33 offen offset:2048 sc1
    ds_read_b128 v[64:67], v5 offset:448
    ds_read_b128 v[68:71], v5 offset:1024
    ds_read_b128 v[72:75], v5 offset:1600
    ds_read_b128 v[76:79], v5 offset:2176
    s_waitcnt lgkmcnt(4)
    v_fma_f32 v80, v48, v28, v52
    v_fma_f32 v81, v49, v28, v53
    v_fma_f32 v82, v50, v28, v54
    v_fma_f32 v83, v51, v28, v55
    v_fma_f32 v84, v48, v30, v52
    v_fma_f32 v85, v49, v30, v53
    v_fma_f32 v86, v50, v30, v54
    v_fma_f32 v87, v51, v30, v55
    v_fma_f32 v88, v56, v28, v60
    v_fma_f32 v89, v57, v28, v61
    v_fma_f32 v90, v58, v28, v62
    v_fma_f32 v91, v59, v28, v63
    v_fma_f32 v92, v56, v30, v60
    v_fma_f32 v93, v57, v30, v61
    v_fma_f32 v94, v58, v30, v62
    v_fma_f32 v95, v59, v30, v63
    v_fma_f32 v80, v136, v24, v80
    v_fma_f32 v81, v137, v24, v81
    v_fma_f32 v82, v138, v24, v82
    v_fma_f32 v83, v139, v24, v83
    v_fma_f32 v84, v208, v26, v84
    v_fma_f32 v85, v209, v26, v85
    v_fma_f32 v86, v210, v26, v86
    v_fma_f32 v87, v211, v26, v87
    v_mul_f32 v96, s40, v80
    v_mul_f32 v97, s41, v81
    v_mul_f32 v98, s40, v82
    v_mul_f32 v99, s41, v83
    v_mul_f32 v100, s40, v84
    v_mul_f32 v101, s41, v85
    v_mul_f32 v102, s40, v86
    v_mul_f32 v103, s41, v87
    v_fma_f32 v88, v172, v24, v88
    v_fma_f32 v89, v173, v24, v89
    v_fma_f32 v90, v174, v24, v90
    v_fma_f32 v91, v175, v24, v91
    v_fma_f32 v92, v244, v26, v92
    v_fma_f32 v93, v245, v26, v93
    v_fma_f32 v94, v246, v26, v94
    v_fma_f32 v95, v247, v26, v95
    v_exp_f32 v96, v96
    v_exp_f32 v97, v97
    v_exp_f32 v98, v98
    v_exp_f32 v99, v99
    v_exp_f32 v100, v100
    v_exp_f32 v101, v101
    v_exp_f32 v102, v102
    v_exp_f32 v103, v103
    v_mul_f32 v80, v80, v88
    v_mul_f32 v81, v81, v89
    v_mul_f32 v82, v82, v90
    v_mul_f32 v83, v83, v91
    v_mul_f32 v84, v84, v92
    v_mul_f32 v85, v85, v93
    v_mul_f32 v86, v86, v94
    v_mul_f32 v87, v87, v95
    v_add_f32 v96, 1.0, v96
    v_add_f32 v97, 1.0, v97
    v_add_f32 v98, 1.0, v98
    v_add_f32 v99, 1.0, v99
    v_add_f32 v100, 1.0, v100
    v_add_f32 v101, 1.0, v101
    v_add_f32 v102, 1.0, v102
    v_add_f32 v103, 1.0, v103
    v_rcp_f32 v96, v96
    v_rcp_f32 v97, v97
    v_rcp_f32 v98, v98
    v_rcp_f32 v99, v99
    v_rcp_f32 v100, v100
    v_rcp_f32 v101, v101
    v_rcp_f32 v102, v102
    v_rcp_f32 v103, v103
    v_mul_f32 v80, v80, v96
    v_mul_f32 v81, v81, v97
    v_mul_f32 v82, v82, v98
    v_mul_f32 v83, v83, v99
    v_mul_f32 v84, v84, v100
    v_mul_f32 v85, v85, v101
    v_mul_f32 v86, v86, v102
    v_mul_f32 v87, v87, v103
    v_cvt_pk_bf16_f32 v40, v80, v81
    v_cvt_pk_bf16_f32 v41, v82, v83
    v_cvt_pk_bf16_f32 v44, v84, v85
    v_cvt_pk_bf16_f32 v45, v86, v87
    ds_read_b128 v[48:51], v5 offset:512
    ds_read_b128 v[52:55], v5 offset:1088
    ds_read_b128 v[56:59], v5 offset:1664
    ds_read_b128 v[60:63], v5 offset:2240
    s_waitcnt lgkmcnt(4)
    v_fma_f32 v80, v64, v28, v68
    v_fma_f32 v81, v65, v28, v69
    v_fma_f32 v82, v66, v28, v70
    v_fma_f32 v83, v67, v28, v71
    v_fma_f32 v84, v64, v30, v68
    v_fma_f32 v85, v65, v30, v69
    v_fma_f32 v86, v66, v30, v70
    v_fma_f32 v87, v67, v30, v71
    v_fma_f32 v88, v72, v28, v76
    v_fma_f32 v89, v73, v28, v77
    v_fma_f32 v90, v74, v28, v78
    v_fma_f32 v91, v75, v28, v79
    v_fma_f32 v92, v72, v30, v76
    v_fma_f32 v93, v73, v30, v77
    v_fma_f32 v94, v74, v30, v78
    v_fma_f32 v95, v75, v30, v79
    v_fma_f32 v80, v140, v24, v80
    v_fma_f32 v81, v141, v24, v81
    v_fma_f32 v82, v142, v24, v82
    v_fma_f32 v83, v143, v24, v83
    v_fma_f32 v84, v212, v26, v84
    v_fma_f32 v85, v213, v26, v85
    v_fma_f32 v86, v214, v26, v86
    v_fma_f32 v87, v215, v26, v87
    v_mul_f32 v96, s40, v80
    v_mul_f32 v97, s41, v81
    v_mul_f32 v98, s40, v82
    v_mul_f32 v99, s41, v83
    v_mul_f32 v100, s40, v84
    v_mul_f32 v101, s41, v85
    v_mul_f32 v102, s40, v86
    v_mul_f32 v103, s41, v87
    v_fma_f32 v88, v176, v24, v88
    v_fma_f32 v89, v177, v24, v89
    v_fma_f32 v90, v178, v24, v90
    v_fma_f32 v91, v179, v24, v91
    v_fma_f32 v92, v248, v26, v92
    v_fma_f32 v93, v249, v26, v93
    v_fma_f32 v94, v250, v26, v94
    v_fma_f32 v95, v251, v26, v95
    v_exp_f32 v96, v96
    v_exp_f32 v97, v97
    v_exp_f32 v98, v98
    v_exp_f32 v99, v99
    v_exp_f32 v100, v100
    v_exp_f32 v101, v101
    v_exp_f32 v102, v102
    v_exp_f32 v103, v103
    v_mul_f32 v80, v80, v88
    v_mul_f32 v81, v81, v89
    v_mul_f32 v82, v82, v90
    v_mul_f32 v83, v83, v91
    v_mul_f32 v84, v84, v92
    v_mul_f32 v85, v85, v93
    v_mul_f32 v86, v86, v94
    v_mul_f32 v87, v87, v95
    v_add_f32 v96, 1.0, v96
    v_add_f32 v97, 1.0, v97
    v_add_f32 v98, 1.0, v98
    v_add_f32 v99, 1.0, v99
    v_add_f32 v100, 1.0, v100
    v_add_f32 v101, 1.0, v101
    v_add_f32 v102, 1.0, v102
    v_add_f32 v103, 1.0, v103
    v_rcp_f32 v96, v96
    v_rcp_f32 v97, v97
    v_rcp_f32 v98, v98
    v_rcp_f32 v99, v99
    v_rcp_f32 v100, v100
    v_rcp_f32 v101, v101
    v_rcp_f32 v102, v102
    v_rcp_f32 v103, v103
    v_mul_f32 v80, v80, v96
    v_mul_f32 v81, v81, v97
    v_mul_f32 v82, v82, v98
    v_mul_f32 v83, v83, v99
    v_mul_f32 v84, v84, v100
    v_mul_f32 v85, v85, v101
    v_mul_f32 v86, v86, v102
    v_mul_f32 v87, v87, v103
    v_cvt_pk_bf16_f32 v42, v80, v81
    v_cvt_pk_bf16_f32 v43, v82, v83
    v_cvt_pk_bf16_f32 v46, v84, v85
    v_cvt_pk_bf16_f32 v47, v86, v87
    buffer_store_dwordx4 v[40:43], v3, s[12:15], s32 offen offset:3072 sc1
    buffer_store_dwordx4 v[44:47], v3, s[12:15], s33 offen offset:3072 sc1
    s_waitcnt lgkmcnt(0)
    v_fma_f32 v80, v48, v28, v52
    v_fma_f32 v81, v49, v28, v53
    v_fma_f32 v82, v50, v28, v54
    v_fma_f32 v83, v51, v28, v55
    v_fma_f32 v84, v48, v30, v52
    v_fma_f32 v85, v49, v30, v53
    v_fma_f32 v86, v50, v30, v54
    v_fma_f32 v87, v51, v30, v55
    v_fma_f32 v88, v56, v28, v60
    v_fma_f32 v89, v57, v28, v61
    v_fma_f32 v90, v58, v28, v62
    v_fma_f32 v91, v59, v28, v63
    v_fma_f32 v92, v56, v30, v60
    v_fma_f32 v93, v57, v30, v61
    v_fma_f32 v94, v58, v30, v62
    v_fma_f32 v95, v59, v30, v63
    v_fma_f32 v80, v144, v24, v80
    v_fma_f32 v81, v145, v24, v81
    v_fma_f32 v82, v146, v24, v82
    v_fma_f32 v83, v147, v24, v83
    v_fma_f32 v84, v216, v26, v84
    v_fma_f32 v85, v217, v26, v85
    v_fma_f32 v86, v218, v26, v86
    v_fma_f32 v87, v219, v26, v87
    v_mul_f32 v96, s40, v80
    v_mul_f32 v97, s41, v81
    v_mul_f32 v98, s40, v82
    v_mul_f32 v99, s41, v83
    v_mul_f32 v100, s40, v84
    v_mul_f32 v101, s41, v85
    v_mul_f32 v102, s40, v86
    v_mul_f32 v103, s41, v87
    v_fma_f32 v88, v180, v24, v88
    v_fma_f32 v89, v181, v24, v89
    v_fma_f32 v90, v182, v24, v90
    v_fma_f32 v91, v183, v24, v91
    v_fma_f32 v92, v252, v26, v92
    v_fma_f32 v93, v253, v26, v93
    v_fma_f32 v94, v254, v26, v94
    v_fma_f32 v95, v255, v26, v95
    v_exp_f32 v96, v96
    v_exp_f32 v97, v97
    v_exp_f32 v98, v98
    v_exp_f32 v99, v99
    v_exp_f32 v100, v100
    v_exp_f32 v101, v101
    v_exp_f32 v102, v102
    v_exp_f32 v103, v103
    v_mul_f32 v80, v80, v88
    v_mul_f32 v81, v81, v89
    v_mul_f32 v82, v82, v90
    v_mul_f32 v83, v83, v91
    v_mul_f32 v84, v84, v92
    v_mul_f32 v85, v85, v93
    v_mul_f32 v86, v86, v94
    v_mul_f32 v87, v87, v95
    v_add_f32 v96, 1.0, v96
    v_add_f32 v97, 1.0, v97
    v_add_f32 v98, 1.0, v98
    v_add_f32 v99, 1.0, v99
    v_add_f32 v100, 1.0, v100
    v_add_f32 v101, 1.0, v101
    v_add_f32 v102, 1.0, v102
    v_add_f32 v103, 1.0, v103
    v_rcp_f32 v96, v96
    v_rcp_f32 v97, v97
    v_rcp_f32 v98, v98
    v_rcp_f32 v99, v99
    v_rcp_f32 v100, v100
    v_rcp_f32 v101, v101
    v_rcp_f32 v102, v102
    v_rcp_f32 v103, v103
    v_mul_f32 v80, v80, v96
    v_mul_f32 v81, v81, v97
    v_mul_f32 v82, v82, v98
    v_mul_f32 v83, v83, v99
    v_mul_f32 v84, v84, v100
    v_mul_f32 v85, v85, v101
    v_mul_f32 v86, v86, v102
    v_mul_f32 v87, v87, v103
    v_cvt_pk_bf16_f32 v32, v80, v81
    v_cvt_pk_bf16_f32 v33, v82, v83
    v_cvt_pk_bf16_f32 v36, v84, v85
    v_cvt_pk_bf16_f32 v37, v86, v87
    buffer_store_dwordx2 v[32:33], v3, s[12:15], s42 offen sc1
    buffer_store_dwordx2 v[36:37], v3, s[12:15], s43 offen sc1
k3_done:
    s_waitcnt vmcnt(0) lgkmcnt(0)
    s_barrier
    s_lshl_b32 s33, s21, 8
    s_add_u32 s33, s33, 141312
    v_mov_b32 v9, s33
    s_cmp_lg_u32 s3, 7
    s_cbranch_scc1 k3_nosig
    v_mov_b32 v8, 1
    s_mov_b64 exec, 1
    global_atomic_add v9, v8, s[86:87]
    s_mov_b64 exec, -1
k3_nosig:
    s_cmp_ge_u32 s2, 240
    s_cbranch_scc1 k4_done
    s_and_b32 s20, s2, 7
    s_mul_i32 s20, s20, 30
    s_lshr_b32 s21, s2, 3
    s_add_u32 s22, s20, s21
    s_cmp_ge_u32 s22, 234
    s_cbranch_scc1 k4_done
    s_load_dwordx2 s[16:17], s[0:1], 48
    s_load_dwordx2 s[18:19], s[0:1], 72
    s_mul_i32 s20, s22, 0x1c72
    s_lshr_b32 s20, s20, 16
    s_mul_i32 s21, s20, 9
    s_sub_u32 s21, s22, s21
    s_waitcnt lgkmcnt(0)
    s_mov_b32 s8, s16
    s_and_b32 s9, s17, 0xffff
    s_mov_b32 s10, 5308416
    s_mov_b32 s11, 0x00020000
    s_mov_b32 s44, s18
    s_and_b32 s45, s19, 0xffff
    s_mov_b32 s46, 2359296
    s_mov_b32 s47, 0x00020000
    s_mul_i32 s22, s20, 5
    s_mul_i32 s23, s3, 18432
    s_add_u32 s29, s22, 0
    s_min_u32 s29, s29, 127
    s_mul_i32 s29, s29, 147456
    s_add_u32 s29, s29, s23
    s_add_u32 s24, s29, 17825792
    s_add_u32 s29, s22, 1
    s_min_u32 s29, s29, 127
    s_mul_i32 s29, s29, 147456
    s_add_u32 s29, s29, s23
    s_add_u32 s25, s29, 17825792
    s_add_u32 s29, s22, 2
    s_min_u32 s29, s29, 127
    s_mul_i32 s29, s29, 147456
    s_add_u32 s29, s29, s23
    s_add_u32 s26, s29, 17825792
    s_add_u32 s29, s22, 3
    s_min_u32 s29, s29, 127
    s_mul_i32 s29, s29, 147456
    s_add_u32 s29, s29, s23
    s_add_u32 s27, s29, 17825792
    s_add_u32 s29, s22, 4
    s_min_u32 s29, s29, 127
    s_mul_i32 s29, s29, 147456
    s_add_u32 s29, s29, s23
    s_add_u32 s28, s29, 17825792
    s_lshl_b32 s30, s3, 14
    s_mul_i32 s31, s3, 663552
    s_lshl_b32 s29, s21, 7
    s_add_u32 s31, s31, s29
    v_lshrrev_b32 v7, 3, v1
    v_and_b32 v8, 7, v1
    v_bfe_u32 v9, v7, 1, 2
    v_lshlrev_b32 v9, 1, v9
    v_xor_b32 v8, v8, v9
    v_mul_u32_u24 v7, 1152, v7
    v_lshl_add_u32 v7, v8, 4, v7
    v_add_u32 v10, s31, v7
    v_add_u32 v11, 9216, v10
    v_bfe_u32 v7, v1, 2, 2
    v_lshl_add_u32 v7, v4, 2, v7
    v_bfe_u32 v8, v7, 1, 2
    v_lshlrev_b32 v8, 1, v8
    v_bfe_u32 v9, v1, 1, 1
    v_lshlrev_b32 v7, 7, v7
    v_and_b32 v16, 1, v1
    v_lshl_add_u32 v7, v16, 3, v7
    v_add_u32 v7, s30, v7
    v_or_b32 v16, 0, v9
    v_xor_b32 v16, v16, v8
    v_lshl_add_u32 v12, v16, 4, v7
    v_or_b32 v16, 2, v9
    v_xor_b32 v16, v16, v8
    v_lshl_add_u32 v13, v16, 4, v7
    v_or_b32 v16, 4, v9
    v_xor_b32 v16, v16, v8
    v_lshl_add_u32 v14, v16, 4, v7
    v_or_b32 v16, 6, v9
    v_xor_b32 v16, v16, v8
    v_lshl_add_u32 v15, v16, 4, v7
    s_mov_b32 s29, 0
    s_add_u32 m0, s30, 0
    s_nop 0
    buffer_load_dwordx4 v10, s[8:11], s29 offen lds
    s_mov_b32 s29, 0
    s_add_u32 m0, s30, 1024
    s_nop 0
    buffer_load_dwordx4 v11, s[8:11], s29 offen lds
    s_mov_b32 s29, 18432
    s_add_u32 m0, s30, 2048
    s_nop 0
    buffer_load_dwordx4 v10, s[8:11], s29 offen lds
    s_mov_b32 s29, 18432
    s_add_u32 m0, s30, 3072
    s_nop 0
    buffer_load_dwordx4 v11, s[8:11], s29 offen lds
    s_mov_b32 s29, 36864
    s_add_u32 m0, s30, 4096
    s_nop 0
    buffer_load_dwordx4 v10, s[8:11], s29 offen lds
    s_mov_b32 s29, 36864
    s_add_u32 m0, s30, 5120
    s_nop 0
    buffer_load_dwordx4 v11, s[8:11], s29 offen lds
    s_mov_b32 s29, 55296
    s_add_u32 m0, s30, 6144
    s_nop 0
    buffer_load_dwordx4 v10, s[8:11], s29 offen lds
    s_mov_b32 s29, 55296
    s_add_u32 m0, s30, 7168
    s_nop 0
    buffer_load_dwordx4 v11, s[8:11], s29 offen lds
    s_lshr_b32 s33, s22, 4
    s_add_u32 s34, s22, 4
    s_min_u32 s34, s34, 127
    s_lshr_b32 s34, s34, 4
    s_lshl_b32 s33, s33, 8
    s_lshl_b32 s34, s34, 8
    s_add_u32 s33, s33, 141312
    s_add_u32 s34, s34, 141312
    v_mov_b32 v17, s33
    v_mov_b32 v18, s34
    s_mov_b32 s37, 0
    s_cmp_lg_u32 s3, 7
    s_cbranch_scc1 k4_ready
    s_mov_b64 exec, 1
k4_poll:
    global_load_dword v19, v17, s[86:87] sc1
    global_load_dword v20, v18, s[86:87] sc1
    s_waitcnt vmcnt(0)
    v_min_u32 v19, v19, v20
    s_nop 0
    v_readfirstlane_b32 s38, v19
    s_add_u32 s37, s37, 1
    s_nop 2
    s_cmp_ge_u32 s38, 32
    s_cbranch_scc1 k4_ready
    s_cmp_lt_u32 s37, 0x400000
    s_cbranch_scc0 k4_ready
    s_sleep 2
    s_branch k4_poll
k4_ready:
    s_mov_b64 exec, -1
    s_barrier
    buffer_load_dwordx4 v[32:35], v3, s[12:15], s24 offen offset:0 sc1
    buffer_load_dwordx4 v[36:39], v3, s[12:15], s25 offen offset:0 sc1
    buffer_load_dwordx4 v[40:43], v3, s[12:15], s26 offen offset:0 sc1
    buffer_load_dwordx4 v[44:47], v3, s[12:15], s27 offen offset:0 sc1
    buffer_load_dwordx4 v[48:51], v3, s[12:15], s28 offen offset:0 sc1
    buffer_load_dwordx4 v[52:55], v3, s[12:15], s24 offen offset:1024 sc1
    buffer_load_dwordx4 v[56:59], v3, s[12:15], s25 offen offset:1024 sc1
    buffer_load_dwordx4 v[60:63], v3, s[12:15], s26 offen offset:1024 sc1
    buffer_load_dwordx4 v[64:67], v3, s[12:15], s27 offen offset:1024 sc1
    buffer_load_dwordx4 v[68:71], v3, s[12:15], s28 offen offset:1024 sc1
    s_mov_b32 s29, 73728
    s_add_u32 m0, s30, 8192
    s_nop 0
    buffer_load_dwordx4 v10, s[8:11], s29 offen lds
    s_mov_b32 s29, 73728
    s_add_u32 m0, s30, 9216
    s_nop 0
    buffer_load_dwordx4 v11, s[8:11], s29 offen lds
    s_mov_b32 s29, 92160
    s_add_u32 m0, s30, 10240
    s_nop 0
    buffer_load_dwordx4 v10, s[8:11], s29 offen lds
    s_mov_b32 s29, 92160
    s_add_u32 m0, s30, 11264
    s_nop 0
    buffer_load_dwordx4 v11, s[8:11], s29 offen lds
    buffer_load_dwordx4 v[72:75], v3, s[12:15], s24 offen offset:2048 sc1
    buffer_load_dwordx4 v[76:79], v3, s[12:15], s25 offen offset:2048 sc1
    buffer_load_dwordx4 v[80:83], v3, s[12:15], s26 offen offset:2048 sc1
    buffer_load_dwordx4 v[84:87], v3, s[12:15], s27 offen offset:2048 sc1
    buffer_load_dwordx4 v[88:91], v3, s[12:15], s28 offen offset:2048 sc1
    s_waitcnt vmcnt(14)
    ds_read_b64_tr_b16 v[112:113], v12 offset:0
    ds_read_b64_tr_b16 v[114:115], v12 offset:2048
    ds_read_b64_tr_b16 v[116:117], v13 offset:0
    ds_read_b64_tr_b16 v[118:119], v13 offset:2048
    ds_read_b64_tr_b16 v[120:121], v14 offset:0
    ds_read_b64_tr_b16 v[122:123], v14 offset:2048
    ds_read_b64_tr_b16 v[124:125], v15 offset:0
    ds_read_b64_tr_b16 v[126:127], v15 offset:2048
    s_waitcnt lgkmcnt(6)
    v_mfma_f32_16x16x32_bf16 v[128:131], v[112:115], v[32:35], 0
    v_mfma_f32_16x16x32_bf16 v[144:147], v[112:115], v[36:39], 0
    v_mfma_f32_16x16x32_bf16 v[160:163], v[112:115], v[40:43], 0
    v_mfma_f32_16x16x32_bf16 v[176:179], v[112:115], v[44:47], 0
    v_mfma_f32_16x16x32_bf16 v[192:195], v[112:115], v[48:51], 0
    s_waitcnt lgkmcnt(4)
    v_mfma_f32_16x16x32_bf16 v[132:135], v[116:119], v[32:35], 0
    v_mfma_f32_16x16x32_bf16 v[148:151], v[116:119], v[36:39], 0
    v_mfma_f32_16x16x32_bf16 v[164:167], v[116:119], v[40:43], 0
    v_mfma_f32_16x16x32_bf16 v[180:183], v[116:119], v[44:47], 0
    v_mfma_f32_16x16x32_bf16 v[196:199], v[116:119], v[48:51], 0
    s_waitcnt lgkmcnt(2)
    v_mfma_f32_16x16x32_bf16 v[136:139], v[120:123], v[32:35], 0
    v_mfma_f32_16x16x32_bf16 v[152:155], v[120:123], v[36:39], 0
    v_mfma_f32_16x16x32_bf16 v[168:171], v[120:123], v[40:43], 0
    v_mfma_f32_16x16x32_bf16 v[184:187], v[120:123], v[44:47], 0
    v_mfma_f32_16x16x32_bf16 v[200:203], v[120:123], v[48:51], 0
    s_waitcnt lgkmcnt(0)
    v_mfma_f32_16x16x32_bf16 v[140:143], v[124:127], v[32:35], 0
    v_mfma_f32_16x16x32_bf16 v[156:159], v[124:127], v[36:39], 0
    v_mfma_f32_16x16x32_bf16 v[172:175], v[124:127], v[40:43], 0
    v_mfma_f32_16x16x32_bf16 v[188:191], v[124:127], v[44:47], 0
    v_mfma_f32_16x16x32_bf16 v[204:207], v[124:127], v[48:51], 0
    s_mov_b32 s29, 110592
    s_add_u32 m0, s30, 0
    s_nop 0
    buffer_load_dwordx4 v10, s[8:11], s29 offen lds
    s_mov_b32 s29, 110592
    s_add_u32 m0, s30, 1024
    s_nop 0
    buffer_load_dwordx4 v11, s[8:11], s29 offen lds
    s_mov_b32 s29, 129024
    s_add_u32 m0, s30, 2048
    s_nop 0
    buffer_load_dwordx4 v10, s[8:11], s29 offen lds
    s_mov_b32 s29, 129024
    s_add_u32 m0, s30, 3072
    s_nop 0
    buffer_load_dwordx4 v11, s[8:11], s29 offen lds
    buffer_load_dwordx4 v[32:35], v3, s[12:15], s24 offen offset:3072 sc1
    buffer_load_dwordx4 v[36:39], v3, s[12:15], s25 offen offset:3072 sc1
    buffer_load_dwordx4 v[40:43], v3, s[12:15], s26 offen offset:3072 sc1
    buffer_load_dwordx4 v[44:47], v3, s[12:15], s27 offen offset:3072 sc1
    buffer_load_dwordx4 v[48:51], v3, s[12:15], s28 offen offset:3072 sc1
    s_waitcnt vmcnt(18)
    ds_read_b64_tr_b16 v[112:113], v12 offset:4096
    ds_read_b64_tr_b16 v[114:115], v12 offset:6144
    ds_read_b64_tr_b16 v[116:117], v13 offset:4096
    ds_read_b64_tr_b16 v[118:119], v13 offset:6144
    ds_read_b64_tr_b16 v[120:121], v14 offset:4096
    ds_read_b64_tr_b16 v[122:123], v14 offset:6144
    ds_read_b64_tr_b16 v[124:125], v15 offset:4096
    ds_read_b64_tr_b16 v[126:127], v15 offset:6144
    s_waitcnt lgkmcnt(6)
    v_mfma_f32_16x16x32_bf16 v[128:131], v[112:115], v[52:55], v[128:131]
    v_mfma_f32_16x16x32_bf16 v[144:147], v[112:115], v[56:59], v[144:147]
    v_mfma_f32_16x16x32_bf16 v[160:163], v[112:115], v[60:63], v[160:163]
    v_mfma_f32_16x16x32_bf16 v[176:179], v[112:115], v[64:67], v[176:179]
    v_mfma_f32_16x16x32_bf16 v[192:195], v[112:115], v[68:71], v[192:195]
    s_waitcnt lgkmcnt(4)
    v_mfma_f32_16x16x32_bf16 v[132:135], v[116:119], v[52:55], v[132:135]
    v_mfma_f32_16x16x32_bf16 v[148:151], v[116:119], v[56:59], v[148:151]
    v_mfma_f32_16x16x32_bf16 v[164:167], v[116:119], v[60:63], v[164:167]
    v_mfma_f32_16x16x32_bf16 v[180:183], v[116:119], v[64:67], v[180:183]
    v_mfma_f32_16x16x32_bf16 v[196:199], v[116:119], v[68:71], v[196:199]
    s_waitcnt lgkmcnt(2)
    v_mfma_f32_16x16x32_bf16 v[136:139], v[120:123], v[52:55], v[136:139]
    v_mfma_f32_16x16x32_bf16 v[152:155], v[120:123], v[56:59], v[152:155]
    v_mfma_f32_16x16x32_bf16 v[168:171], v[120:123], v[60:63], v[168:171]
    v_mfma_f32_16x16x32_bf16 v[184:187], v[120:123], v[64:67], v[184:187]
    v_mfma_f32_16x16x32_bf16 v[200:203], v[120:123], v[68:71], v[200:203]
    s_waitcnt lgkmcnt(0)
    v_mfma_f32_16x16x32_bf16 v[140:143], v[124:127], v[52:55], v[140:143]
    v_mfma_f32_16x16x32_bf16 v[156:159], v[124:127], v[56:59], v[156:159]
    v_mfma_f32_16x16x32_bf16 v[172:175], v[124:127], v[60:63], v[172:175]
    v_mfma_f32_16x16x32_bf16 v[188:191], v[124:127], v[64:67], v[188:191]
    v_mfma_f32_16x16x32_bf16 v[204:207], v[124:127], v[68:71], v[204:207]
    s_mov_b32 s29, 165888
    s_add_u32 m0, s30, 4096
    s_nop 0
    buffer_load_dwordx4 v10, s[8:11], s29 offen lds
    s_mov_b32 s29, 165888
    s_add_u32 m0, s30, 5120
    s_nop 0
    buffer_load_dwordx4 v11, s[8:11], s29 offen lds
    s_mov_b32 s29, 184320
    s_add_u32 m0, s30, 6144
    s_nop 0
    buffer_load_dwordx4 v10, s[8:11], s29 offen lds
    s_mov_b32 s29, 184320
    s_add_u32 m0, s30, 7168
    s_nop 0
    buffer_load_dwordx4 v11, s[8:11], s29 offen lds
    s_add_u32 s24, s24, 4096
    s_add_u32 s25, s25, 4096
    s_add_u32 s26, s26, 4096
    s_add_u32 s27, s27, 4096
    s_add_u32 s28, s28, 4096
    buffer_load_dwordx4 v[52:55], v3, s[12:15], s24 offen offset:0 sc1
    buffer_load_dwordx4 v[56:59], v3, s[12:15], s25 offen offset:0 sc1
    buffer_load_dwordx4 v[60:63], v3, s[12:15], s26 offen offset:0 sc1
    buffer_load_dwordx4 v[64:67], v3, s[12:15], s27 offen offset:0 sc1
    buffer_load_dwordx4 v[68:71], v3, s[12:15], s28 offen offset:0 sc1
    s_waitcnt vmcnt(18)
    ds_read_b64_tr_b16 v[112:113], v12 offset:8192
    ds_read_b64_tr_b16 v[114:115], v12 offset:10240
    ds_read_b64_tr_b16 v[116:117], v13 offset:8192
    ds_read_b64_tr_b16 v[118:119], v13 offset:10240
    ds_read_b64_tr_b16 v[120:121], v14 offset:8192
    ds_read_b64_tr_b16 v[122:123], v14 offset:10240
    ds_read_b64_tr_b16 v[124:125], v15 offset:8192
    ds_read_b64_tr_b16 v[126:127], v15 offset:10240
    s_waitcnt lgkmcnt(6)
    v_mfma_f32_16x16x32_bf16 v[128:131], v[112:115], v[72:75], v[128:131]
    v_mfma_f32_16x16x32_bf16 v[144:147], v[112:115], v[76:79], v[144:147]
    v_mfma_f32_16x16x32_bf16 v[160:163], v[112:115], v[80:83], v[160:163]
    v_mfma_f32_16x16x32_bf16 v[176:179], v[112:115], v[84:87], v[176:179]
    v_mfma_f32_16x16x32_bf16 v[192:195], v[112:115], v[88:91], v[192:195]
    s_waitcnt lgkmcnt(4)
    v_mfma_f32_16x16x32_bf16 v[132:135], v[116:119], v[72:75], v[132:135]
    v_mfma_f32_16x16x32_bf16 v[148:151], v[116:119], v[76:79], v[148:151]
    v_mfma_f32_16x16x32_bf16 v[164:167], v[116:119], v[80:83], v[164:167]
    v_mfma_f32_16x16x32_bf16 v[180:183], v[116:119], v[84:87], v[180:183]
    v_mfma_f32_16x16x32_bf16 v[196:199], v[116:119], v[88:91], v[196:199]
    s_waitcnt lgkmcnt(2)
    v_mfma_f32_16x16x32_bf16 v[136:139], v[120:123], v[72:75], v[136:139]
    v_mfma_f32_16x16x32_bf16 v[152:155], v[120:123], v[76:79], v[152:155]
    v_mfma_f32_16x16x32_bf16 v[168:171], v[120:123], v[80:83], v[168:171]
    v_mfma_f32_16x16x32_bf16 v[184:187], v[120:123], v[84:87], v[184:187]
    v_mfma_f32_16x16x32_bf16 v[200:203], v[120:123], v[88:91], v[200:203]
    s_waitcnt lgkmcnt(0)
    v_mfma_f32_16x16x32_bf16 v[140:143], v[124:127], v[72:75], v[140:143]
    v_mfma_f32_16x16x32_bf16 v[156:159], v[124:127], v[76:79], v[156:159]
    v_mfma_f32_16x16x32_bf16 v[172:175], v[124:127], v[80:83], v[172:175]
    v_mfma_f32_16x16x32_bf16 v[188:191], v[124:127], v[84:87], v[188:191]
    v_mfma_f32_16x16x32_bf16 v[204:207], v[124:127], v[88:91], v[204:207]
    s_mov_b32 s29, 202752
    s_add_u32 m0, s30, 8192
    s_nop 0
    buffer_load_dwordx4 v10, s[8:11], s29 offen lds
    s_mov_b32 s29, 202752
    s_add_u32 m0, s30, 9216
    s_nop 0
    buffer_load_dwordx4 v11, s[8:11], s29 offen lds
    s_mov_b32 s29, 221184
    s_add_u32 m0, s30, 10240
    s_nop 0
    buffer_load_dwordx4 v10, s[8:11], s29 offen lds
    s_mov_b32 s29, 221184
    s_add_u32 m0, s30, 11264
    s_nop 0
    buffer_load_dwordx4 v11, s[8:11], s29 offen lds
    buffer_load_dwordx4 v[72:75], v3, s[12:15], s24 offen offset:1024 sc1
    buffer_load_dwordx4 v[76:79], v3, s[12:15], s25 offen offset:1024 sc1
    buffer_load_dwordx4 v[80:83], v3, s[12:15], s26 offen offset:1024 sc1
    buffer_load_dwordx4 v[84:87], v3, s[12:15], s27 offen offset:1024 sc1
    buffer_load_dwordx4 v[88:91], v3, s[12:15], s28 offen offset:1024 sc1
    s_waitcnt vmcnt(18)
    ds_read_b64_tr_b16 v[112:113], v12 offset:0
    ds_read_b64_tr_b16 v[114:115], v12 offset:2048
    ds_read_b64_tr_b16 v[116:117], v13 offset:0
    ds_read_b64_tr_b16 v[118:119], v13 offset:2048
    ds_read_b64_tr_b16 v[120:121], v14 offset:0
    ds_read_b64_tr_b16 v[122:123], v14 offset:2048
    ds_read_b64_tr_b16 v[124:125], v15 offset:0
    ds_read_b64_tr_b16 v[126:127], v15 offset:2048
    s_waitcnt lgkmcnt(6)
    v_mfma_f32_16x16x32_bf16 v[128:131], v[112:115], v[32:35], v[128:131]
    v_mfma_f32_16x16x32_bf16 v[144:147], v[112:115], v[36:39], v[144:147]
    v_mfma_f32_16x16x32_bf16 v[160:163], v[112:115], v[40:43], v[160:163]
    v_mfma_f32_16x16x32_bf16 v[176:179], v[112:115], v[44:47], v[176:179]
    v_mfma_f32_16x16x32_bf16 v[192:195], v[112:115], v[48:51], v[192:195]
    s_waitcnt lgkmcnt(4)
    v_mfma_f32_16x16x32_bf16 v[132:135], v[116:119], v[32:35], v[132:135]
    v_mfma_f32_16x16x32_bf16 v[148:151], v[116:119], v[36:39], v[148:151]
    v_mfma_f32_16x16x32_bf16 v[164:167], v[116:119], v[40:43], v[164:167]
    v_mfma_f32_16x16x32_bf16 v[180:183], v[116:119], v[44:47], v[180:183]
    v_mfma_f32_16x16x32_bf16 v[196:199], v[116:119], v[48:51], v[196:199]
    s_waitcnt lgkmcnt(2)
    v_mfma_f32_16x16x32_bf16 v[136:139], v[120:123], v[32:35], v[136:139]
    v_mfma_f32_16x16x32_bf16 v[152:155], v[120:123], v[36:39], v[152:155]
    v_mfma_f32_16x16x32_bf16 v[168:171], v[120:123], v[40:43], v[168:171]
    v_mfma_f32_16x16x32_bf16 v[184:187], v[120:123], v[44:47], v[184:187]
    v_mfma_f32_16x16x32_bf16 v[200:203], v[120:123], v[48:51], v[200:203]
    s_waitcnt lgkmcnt(0)
    v_mfma_f32_16x16x32_bf16 v[140:143], v[124:127], v[32:35], v[140:143]
    v_mfma_f32_16x16x32_bf16 v[156:159], v[124:127], v[36:39], v[156:159]
    v_mfma_f32_16x16x32_bf16 v[172:175], v[124:127], v[40:43], v[172:175]
    v_mfma_f32_16x16x32_bf16 v[188:191], v[124:127], v[44:47], v[188:191]
    v_mfma_f32_16x16x32_bf16 v[204:207], v[124:127], v[48:51], v[204:207]
    s_mov_b32 s29, 239616
    s_add_u32 m0, s30, 0
    s_nop 0
    buffer_load_dwordx4 v10, s[8:11], s29 offen lds
    s_mov_b32 s29, 239616
    s_add_u32 m0, s30, 1024
    s_nop 0
    buffer_load_dwordx4 v11, s[8:11], s29 offen lds
    s_mov_b32 s29, 258048
    s_add_u32 m0, s30, 2048
    s_nop 0
    buffer_load_dwordx4 v10, s[8:11], s29 offen lds
    s_mov_b32 s29, 258048
    s_add_u32 m0, s30, 3072
    s_nop 0
    buffer_load_dwordx4 v11, s[8:11], s29 offen lds
    buffer_load_dwordx4 v[32:35], v3, s[12:15], s24 offen offset:2048 sc1
    buffer_load_dwordx4 v[36:39], v3, s[12:15], s25 offen offset:2048 sc1
    buffer_load_dwordx4 v[40:43], v3, s[12:15], s26 offen offset:2048 sc1
    buffer_load_dwordx4 v[44:47], v3, s[12:15], s27 offen offset:2048 sc1
    buffer_load_dwordx4 v[48:51], v3, s[12:15], s28 offen offset:2048 sc1
    s_waitcnt vmcnt(18)
    ds_read_b64_tr_b16 v[112:113], v12 offset:4096
    ds_read_b64_tr_b16 v[114:115], v12 offset:6144
    ds_read_b64_tr_b16 v[116:117], v13 offset:4096
    ds_read_b64_tr_b16 v[118:119], v13 offset:6144
    ds_read_b64_tr_b16 v[120:121], v14 offset:4096
    ds_read_b64_tr_b16 v[122:123], v14 offset:6144
    ds_read_b64_tr_b16 v[124:125], v15 offset:4096
    ds_read_b64_tr_b16 v[126:127], v15 offset:6144
    s_waitcnt lgkmcnt(6)
    v_mfma_f32_16x16x32_bf16 v[128:131], v[112:115], v[52:55], v[128:131]
    v_mfma_f32_16x16x32_bf16 v[144:147], v[112:115], v[56:59], v[144:147]
    v_mfma_f32_16x16x32_bf16 v[160:163], v[112:115], v[60:63], v[160:163]
    v_mfma_f32_16x16x32_bf16 v[176:179], v[112:115], v[64:67], v[176:179]
    v_mfma_f32_16x16x32_bf16 v[192:195], v[112:115], v[68:71], v[192:195]
    s_waitcnt lgkmcnt(4)
    v_mfma_f32_16x16x32_bf16 v[132:135], v[116:119], v[52:55], v[132:135]
    v_mfma_f32_16x16x32_bf16 v[148:151], v[116:119], v[56:59], v[148:151]
    v_mfma_f32_16x16x32_bf16 v[164:167], v[116:119], v[60:63], v[164:167]
    v_mfma_f32_16x16x32_bf16 v[180:183], v[116:119], v[64:67], v[180:183]
    v_mfma_f32_16x16x32_bf16 v[196:199], v[116:119], v[68:71], v[196:199]
    s_waitcnt lgkmcnt(2)
    v_mfma_f32_16x16x32_bf16 v[136:139], v[120:123], v[52:55], v[136:139]
    v_mfma_f32_16x16x32_bf16 v[152:155], v[120:123], v[56:59], v[152:155]
    v_mfma_f32_16x16x32_bf16 v[168:171], v[120:123], v[60:63], v[168:171]
    v_mfma_f32_16x16x32_bf16 v[184:187], v[120:123], v[64:67], v[184:187]
    v_mfma_f32_16x16x32_bf16 v[200:203], v[120:123], v[68:71], v[200:203]
    s_waitcnt lgkmcnt(0)
    v_mfma_f32_16x16x32_bf16 v[140:143], v[124:127], v[52:55], v[140:143]
    v_mfma_f32_16x16x32_bf16 v[156:159], v[124:127], v[56:59], v[156:159]
    v_mfma_f32_16x16x32_bf16 v[172:175], v[124:127], v[60:63], v[172:175]
    v_mfma_f32_16x16x32_bf16 v[188:191], v[124:127], v[64:67], v[188:191]
    v_mfma_f32_16x16x32_bf16 v[204:207], v[124:127], v[68:71], v[204:207]
    s_mov_b32 s29, 276480
    s_add_u32 m0, s30, 4096
    s_nop 0
    buffer_load_dwordx4 v10, s[8:11], s29 offen lds
    s_mov_b32 s29, 276480
    s_add_u32 m0, s30, 5120
    s_nop 0
    buffer_load_dwordx4 v11, s[8:11], s29 offen lds
    s_mov_b32 s29, 294912
    s_add_u32 m0, s30, 6144
    s_nop 0
    buffer_load_dwordx4 v10, s[8:11], s29 offen lds
    s_mov_b32 s29, 294912
    s_add_u32 m0, s30, 7168
    s_nop 0
    buffer_load_dwordx4 v11, s[8:11], s29 offen lds
    buffer_load_dwordx4 v[52:55], v3, s[12:15], s24 offen offset:3072 sc1
    buffer_load_dwordx4 v[56:59], v3, s[12:15], s25 offen offset:3072 sc1
    buffer_load_dwordx4 v[60:63], v3, s[12:15], s26 offen offset:3072 sc1
    buffer_load_dwordx4 v[64:67], v3, s[12:15], s27 offen offset:3072 sc1
    buffer_load_dwordx4 v[68:71], v3, s[12:15], s28 offen offset:3072 sc1
    s_waitcnt vmcnt(18)
    ds_read_b64_tr_b16 v[112:113], v12 offset:8192
    ds_read_b64_tr_b16 v[114:115], v12 offset:10240
    ds_read_b64_tr_b16 v[116:117], v13 offset:8192
    ds_read_b64_tr_b16 v[118:119], v13 offset:10240
    ds_read_b64_tr_b16 v[120:121], v14 offset:8192
    ds_read_b64_tr_b16 v[122:123], v14 offset:10240
    ds_read_b64_tr_b16 v[124:125], v15 offset:8192
    ds_read_b64_tr_b16 v[126:127], v15 offset:10240
    s_waitcnt lgkmcnt(6)
    v_mfma_f32_16x16x32_bf16 v[128:131], v[112:115], v[72:75], v[128:131]
    v_mfma_f32_16x16x32_bf16 v[144:147], v[112:115], v[76:79], v[144:147]
    v_mfma_f32_16x16x32_bf16 v[160:163], v[112:115], v[80:83], v[160:163]
    v_mfma_f32_16x16x32_bf16 v[176:179], v[112:115], v[84:87], v[176:179]
    v_mfma_f32_16x16x32_bf16 v[192:195], v[112:115], v[88:91], v[192:195]
    s_waitcnt lgkmcnt(4)
    v_mfma_f32_16x16x32_bf16 v[132:135], v[116:119], v[72:75], v[132:135]
    v_mfma_f32_16x16x32_bf16 v[148:151], v[116:119], v[76:79], v[148:151]
    v_mfma_f32_16x16x32_bf16 v[164:167], v[116:119], v[80:83], v[164:167]
    v_mfma_f32_16x16x32_bf16 v[180:183], v[116:119], v[84:87], v[180:183]
    v_mfma_f32_16x16x32_bf16 v[196:199], v[116:119], v[88:91], v[196:199]
    s_waitcnt lgkmcnt(2)
    v_mfma_f32_16x16x32_bf16 v[136:139], v[120:123], v[72:75], v[136:139]
    v_mfma_f32_16x16x32_bf16 v[152:155], v[120:123], v[76:79], v[152:155]
    v_mfma_f32_16x16x32_bf16 v[168:171], v[120:123], v[80:83], v[168:171]
    v_mfma_f32_16x16x32_bf16 v[184:187], v[120:123], v[84:87], v[184:187]
    v_mfma_f32_16x16x32_bf16 v[200:203], v[120:123], v[88:91], v[200:203]
    s_waitcnt lgkmcnt(0)
    v_mfma_f32_16x16x32_bf16 v[140:143], v[124:127], v[72:75], v[140:143]
    v_mfma_f32_16x16x32_bf16 v[156:159], v[124:127], v[76:79], v[156:159]
    v_mfma_f32_16x16x32_bf16 v[172:175], v[124:127], v[80:83], v[172:175]
    v_mfma_f32_16x16x32_bf16 v[188:191], v[124:127], v[84:87], v[188:191]
    v_mfma_f32_16x16x32_bf16 v[204:207], v[124:127], v[88:91], v[204:207]
    s_mov_b32 s29, 147456
    s_add_u32 m0, s30, 8192
    s_nop 0
    buffer_load_dwordx4 v10, s[8:11], s29 offen lds
    s_mov_b32 s29, 147456
    s_add_u32 m0, s30, 9216
    s_nop 0
    buffer_load_dwordx4 v11, s[8:11], s29 offen lds
    s_mov_b32 s29, 313344
    s_add_u32 m0, s30, 10240
    s_nop 0
    buffer_load_dwordx4 v10, s[8:11], s29 offen lds
    s_mov_b32 s29, 313344
    s_add_u32 m0, s30, 11264
    s_nop 0
    buffer_load_dwordx4 v11, s[8:11], s29 offen lds
    s_add_u32 s24, s24, 4096
    s_add_u32 s25, s25, 4096
    s_add_u32 s26, s26, 4096
    s_add_u32 s27, s27, 4096
    s_add_u32 s28, s28, 4096
    buffer_load_dwordx4 v[72:75], v3, s[12:15], s24 offen offset:0 sc1
    buffer_load_dwordx4 v[76:79], v3, s[12:15], s25 offen offset:0 sc1
    buffer_load_dwordx4 v[80:83], v3, s[12:15], s26 offen offset:0 sc1
    buffer_load_dwordx4 v[84:87], v3, s[12:15], s27 offen offset:0 sc1
    buffer_load_dwordx4 v[88:91], v3, s[12:15], s28 offen offset:0 sc1
    s_waitcnt vmcnt(18)
    ds_read_b64_tr_b16 v[112:113], v12 offset:0
    ds_read_b64_tr_b16 v[114:115], v12 offset:2048
    ds_read_b64_tr_b16 v[116:117], v13 offset:0
    ds_read_b64_tr_b16 v[118:119], v13 offset:2048
    ds_read_b64_tr_b16 v[120:121], v14 offset:0
    ds_read_b64_tr_b16 v[122:123], v14 offset:2048
    ds_read_b64_tr_b16 v[124:125], v15 offset:0
    ds_read_b64_tr_b16 v[126:127], v15 offset:2048
    s_waitcnt lgkmcnt(6)
    v_mfma_f32_16x16x32_bf16 v[128:131], v[112:115], v[32:35], v[128:131]
    v_mfma_f32_16x16x32_bf16 v[144:147], v[112:115], v[36:39], v[144:147]
    v_mfma_f32_16x16x32_bf16 v[160:163], v[112:115], v[40:43], v[160:163]
    v_mfma_f32_16x16x32_bf16 v[176:179], v[112:115], v[44:47], v[176:179]
    v_mfma_f32_16x16x32_bf16 v[192:195], v[112:115], v[48:51], v[192:195]
    s_waitcnt lgkmcnt(4)
    v_mfma_f32_16x16x32_bf16 v[132:135], v[116:119], v[32:35], v[132:135]
    v_mfma_f32_16x16x32_bf16 v[148:151], v[116:119], v[36:39], v[148:151]
    v_mfma_f32_16x16x32_bf16 v[164:167], v[116:119], v[40:43], v[164:167]
    v_mfma_f32_16x16x32_bf16 v[180:183], v[116:119], v[44:47], v[180:183]
    v_mfma_f32_16x16x32_bf16 v[196:199], v[116:119], v[48:51], v[196:199]
    s_waitcnt lgkmcnt(2)
    v_mfma_f32_16x16x32_bf16 v[136:139], v[120:123], v[32:35], v[136:139]
    v_mfma_f32_16x16x32_bf16 v[152:155], v[120:123], v[36:39], v[152:155]
    v_mfma_f32_16x16x32_bf16 v[168:171], v[120:123], v[40:43], v[168:171]
    v_mfma_f32_16x16x32_bf16 v[184:187], v[120:123], v[44:47], v[184:187]
    v_mfma_f32_16x16x32_bf16 v[200:203], v[120:123], v[48:51], v[200:203]
    s_waitcnt lgkmcnt(0)
    v_mfma_f32_16x16x32_bf16 v[140:143], v[124:127], v[32:35], v[140:143]
    v_mfma_f32_16x16x32_bf16 v[156:159], v[124:127], v[36:39], v[156:159]
    v_mfma_f32_16x16x32_bf16 v[172:175], v[124:127], v[40:43], v[172:175]
    v_mfma_f32_16x16x32_bf16 v[188:191], v[124:127], v[44:47], v[188:191]
    v_mfma_f32_16x16x32_bf16 v[204:207], v[124:127], v[48:51], v[204:207]
    s_mov_b32 s29, 331776
    s_add_u32 m0, s30, 0
    s_nop 0
    buffer_load_dwordx4 v10, s[8:11], s29 offen lds
    s_mov_b32 s29, 331776
    s_add_u32 m0, s30, 1024
    s_nop 0
    buffer_load_dwordx4 v11, s[8:11], s29 offen lds
    s_mov_b32 s29, 350208
    s_add_u32 m0, s30, 2048
    s_nop 0
    buffer_load_dwordx4 v10, s[8:11], s29 offen lds
    s_mov_b32 s29, 350208
    s_add_u32 m0, s30, 3072
    s_nop 0
    buffer_load_dwordx4 v11, s[8:11], s29 offen lds
    buffer_load_dwordx4 v[32:35], v3, s[12:15], s24 offen offset:1024 sc1
    buffer_load_dwordx4 v[36:39], v3, s[12:15], s25 offen offset:1024 sc1
    buffer_load_dwordx4 v[40:43], v3, s[12:15], s26 offen offset:1024 sc1
    buffer_load_dwordx4 v[44:47], v3, s[12:15], s27 offen offset:1024 sc1
    buffer_load_dwordx4 v[48:51], v3, s[12:15], s28 offen offset:1024 sc1
    s_waitcnt vmcnt(18)
    ds_read_b64_tr_b16 v[112:113], v12 offset:4096
    ds_read_b64_tr_b16 v[114:115], v12 offset:6144
    ds_read_b64_tr_b16 v[116:117], v13 offset:4096
    ds_read_b64_tr_b16 v[118:119], v13 offset:6144
    ds_read_b64_tr_b16 v[120:121], v14 offset:4096
    ds_read_b64_tr_b16 v[122:123], v14 offset:6144
    ds_read_b64_tr_b16 v[124:125], v15 offset:4096
    ds_read_b64_tr_b16 v[126:127], v15 offset:6144
    s_waitcnt lgkmcnt(6)
    v_mfma_f32_16x16x32_bf16 v[128:131], v[112:115], v[52:55], v[128:131]
    v_mfma_f32_16x16x32_bf16 v[144:147], v[112:115], v[56:59], v[144:147]
    v_mfma_f32_16x16x32_bf16 v[160:163], v[112:115], v[60:63], v[160:163]
    v_mfma_f32_16x16x32_bf16 v[176:179], v[112:115], v[64:67], v[176:179]
    v_mfma_f32_16x16x32_bf16 v[192:195], v[112:115], v[68:71], v[192:195]
    s_waitcnt lgkmcnt(4)
    v_mfma_f32_16x16x32_bf16 v[132:135], v[116:119], v[52:55], v[132:135]
    v_mfma_f32_16x16x32_bf16 v[148:151], v[116:119], v[56:59], v[148:151]
    v_mfma_f32_16x16x32_bf16 v[164:167], v[116:119], v[60:63], v[164:167]
    v_mfma_f32_16x16x32_bf16 v[180:183], v[116:119], v[64:67], v[180:183]
    v_mfma_f32_16x16x32_bf16 v[196:199], v[116:119], v[68:71], v[196:199]
    s_waitcnt lgkmcnt(2)
    v_mfma_f32_16x16x32_bf16 v[136:139], v[120:123], v[52:55], v[136:139]
    v_mfma_f32_16x16x32_bf16 v[152:155], v[120:123], v[56:59], v[152:155]
    v_mfma_f32_16x16x32_bf16 v[168:171], v[120:123], v[60:63], v[168:171]
    v_mfma_f32_16x16x32_bf16 v[184:187], v[120:123], v[64:67], v[184:187]
    v_mfma_f32_16x16x32_bf16 v[200:203], v[120:123], v[68:71], v[200:203]
    s_waitcnt lgkmcnt(0)
    v_mfma_f32_16x16x32_bf16 v[140:143], v[124:127], v[52:55], v[140:143]
    v_mfma_f32_16x16x32_bf16 v[156:159], v[124:127], v[56:59], v[156:159]
    v_mfma_f32_16x16x32_bf16 v[172:175], v[124:127], v[60:63], v[172:175]
    v_mfma_f32_16x16x32_bf16 v[188:191], v[124:127], v[64:67], v[188:191]
    v_mfma_f32_16x16x32_bf16 v[204:207], v[124:127], v[68:71], v[204:207]
    s_mov_b32 s29, 368640
    s_add_u32 m0, s30, 4096
    s_nop 0
    buffer_load_dwordx4 v10, s[8:11], s29 offen lds
    s_mov_b32 s29, 368640
    s_add_u32 m0, s30, 5120
    s_nop 0
    buffer_load_dwordx4 v11, s[8:11], s29 offen lds
    s_mov_b32 s29, 387072
    s_add_u32 m0, s30, 6144
    s_nop 0
    buffer_load_dwordx4 v10, s[8:11], s29 offen lds
    s_mov_b32 s29, 387072
    s_add_u32 m0, s30, 7168
    s_nop 0
    buffer_load_dwordx4 v11, s[8:11], s29 offen lds
    buffer_load_dwordx4 v[52:55], v3, s[12:15], s24 offen offset:2048 sc1
    buffer_load_dwordx4 v[56:59], v3, s[12:15], s25 offen offset:2048 sc1
    buffer_load_dwordx4 v[60:63], v3, s[12:15], s26 offen offset:2048 sc1
    buffer_load_dwordx4 v[64:67], v3, s[12:15], s27 offen offset:2048 sc1
    buffer_load_dwordx4 v[68:71], v3, s[12:15], s28 offen offset:2048 sc1
    s_waitcnt vmcnt(18)
    ds_read_b64_tr_b16 v[112:113], v12 offset:8192
    ds_read_b64_tr_b16 v[114:115], v12 offset:10240
    ds_read_b64_tr_b16 v[116:117], v13 offset:8192
    ds_read_b64_tr_b16 v[118:119], v13 offset:10240
    ds_read_b64_tr_b16 v[120:121], v14 offset:8192
    ds_read_b64_tr_b16 v[122:123], v14 offset:10240
    ds_read_b64_tr_b16 v[124:125], v15 offset:8192
    ds_read_b64_tr_b16 v[126:127], v15 offset:10240
    s_waitcnt lgkmcnt(6)
    v_mfma_f32_16x16x32_bf16 v[128:131], v[112:115], v[72:75], v[128:131]
    v_mfma_f32_16x16x32_bf16 v[144:147], v[112:115], v[76:79], v[144:147]
    v_mfma_f32_16x16x32_bf16 v[160:163], v[112:115], v[80:83], v[160:163]
    v_mfma_f32_16x16x32_bf16 v[176:179], v[112:115], v[84:87], v[176:179]
    v_mfma_f32_16x16x32_bf16 v[192:195], v[112:115], v[88:91], v[192:195]
    s_waitcnt lgkmcnt(4)
    v_mfma_f32_16x16x32_bf16 v[132:135], v[116:119], v[72:75], v[132:135]
    v_mfma_f32_16x16x32_bf16 v[148:151], v[116:119], v[76:79], v[148:151]
    v_mfma_f32_16x16x32_bf16 v[164:167], v[116:119], v[80:83], v[164:167]
    v_mfma_f32_16x16x32_bf16 v[180:183], v[116:119], v[84:87], v[180:183]
    v_mfma_f32_16x16x32_bf16 v[196:199], v[116:119], v[88:91], v[196:199]
    s_waitcnt lgkmcnt(2)
    v_mfma_f32_16x16x32_bf16 v[136:139], v[120:123], v[72:75], v[136:139]
    v_mfma_f32_16x16x32_bf16 v[152:155], v[120:123], v[76:79], v[152:155]
    v_mfma_f32_16x16x32_bf16 v[168:171], v[120:123], v[80:83], v[168:171]
    v_mfma_f32_16x16x32_bf16 v[184:187], v[120:123], v[84:87], v[184:187]
    v_mfma_f32_16x16x32_bf16 v[200:203], v[120:123], v[88:91], v[200:203]
    s_waitcnt lgkmcnt(0)
    v_mfma_f32_16x16x32_bf16 v[140:143], v[124:127], v[72:75], v[140:143]
    v_mfma_f32_16x16x32_bf16 v[156:159], v[124:127], v[76:79], v[156:159]
    v_mfma_f32_16x16x32_bf16 v[172:175], v[124:127], v[80:83], v[172:175]
    v_mfma_f32_16x16x32_bf16 v[188:191], v[124:127], v[84:87], v[188:191]
    v_mfma_f32_16x16x32_bf16 v[204:207], v[124:127], v[88:91], v[204:207]
    s_mov_b32 s29, 405504
    s_add_u32 m0, s30, 8192
    s_nop 0
    buffer_load_dwordx4 v10, s[8:11], s29 offen lds
    s_mov_b32 s29, 405504
    s_add_u32 m0, s30, 9216
    s_nop 0
    buffer_load_dwordx4 v11, s[8:11], s29 offen lds
    s_mov_b32 s29, 423936
    s_add_u32 m0, s30, 10240
    s_nop 0
    buffer_load_dwordx4 v10, s[8:11], s29 offen lds
    s_mov_b32 s29, 423936
    s_add_u32 m0, s30, 11264
    s_nop 0
    buffer_load_dwordx4 v11, s[8:11], s29 offen lds
    buffer_load_dwordx4 v[72:75], v3, s[12:15], s24 offen offset:3072 sc1
    buffer_load_dwordx4 v[76:79], v3, s[12:15], s25 offen offset:3072 sc1
    buffer_load_dwordx4 v[80:83], v3, s[12:15], s26 offen offset:3072 sc1
    buffer_load_dwordx4 v[84:87], v3, s[12:15], s27 offen offset:3072 sc1
    buffer_load_dwordx4 v[88:91], v3, s[12:15], s28 offen offset:3072 sc1
    s_waitcnt vmcnt(18)
    ds_read_b64_tr_b16 v[112:113], v12 offset:0
    ds_read_b64_tr_b16 v[114:115], v12 offset:2048
    ds_read_b64_tr_b16 v[116:117], v13 offset:0
    ds_read_b64_tr_b16 v[118:119], v13 offset:2048
    ds_read_b64_tr_b16 v[120:121], v14 offset:0
    ds_read_b64_tr_b16 v[122:123], v14 offset:2048
    ds_read_b64_tr_b16 v[124:125], v15 offset:0
    ds_read_b64_tr_b16 v[126:127], v15 offset:2048
    s_waitcnt lgkmcnt(6)
    v_mfma_f32_16x16x32_bf16 v[128:131], v[112:115], v[32:35], v[128:131]
    v_mfma_f32_16x16x32_bf16 v[144:147], v[112:115], v[36:39], v[144:147]
    v_mfma_f32_16x16x32_bf16 v[160:163], v[112:115], v[40:43], v[160:163]
    v_mfma_f32_16x16x32_bf16 v[176:179], v[112:115], v[44:47], v[176:179]
    v_mfma_f32_16x16x32_bf16 v[192:195], v[112:115], v[48:51], v[192:195]
    s_waitcnt lgkmcnt(4)
    v_mfma_f32_16x16x32_bf16 v[132:135], v[116:119], v[32:35], v[132:135]
    v_mfma_f32_16x16x32_bf16 v[148:151], v[116:119], v[36:39], v[148:151]
    v_mfma_f32_16x16x32_bf16 v[164:167], v[116:119], v[40:43], v[164:167]
    v_mfma_f32_16x16x32_bf16 v[180:183], v[116:119], v[44:47], v[180:183]
    v_mfma_f32_16x16x32_bf16 v[196:199], v[116:119], v[48:51], v[196:199]
    s_waitcnt lgkmcnt(2)
    v_mfma_f32_16x16x32_bf16 v[136:139], v[120:123], v[32:35], v[136:139]
    v_mfma_f32_16x16x32_bf16 v[152:155], v[120:123], v[36:39], v[152:155]
    v_mfma_f32_16x16x32_bf16 v[168:171], v[120:123], v[40:43], v[168:171]
    v_mfma_f32_16x16x32_bf16 v[184:187], v[120:123], v[44:47], v[184:187]
    v_mfma_f32_16x16x32_bf16 v[200:203], v[120:123], v[48:51], v[200:203]
    s_waitcnt lgkmcnt(0)
    v_mfma_f32_16x16x32_bf16 v[140:143], v[124:127], v[32:35], v[140:143]
    v_mfma_f32_16x16x32_bf16 v[156:159], v[124:127], v[36:39], v[156:159]
    v_mfma_f32_16x16x32_bf16 v[172:175], v[124:127], v[40:43], v[172:175]
    v_mfma_f32_16x16x32_bf16 v[188:191], v[124:127], v[44:47], v[188:191]
    v_mfma_f32_16x16x32_bf16 v[204:207], v[124:127], v[48:51], v[204:207]
    s_mov_b32 s29, 442368
    s_add_u32 m0, s30, 0
    s_nop 0
    buffer_load_dwordx4 v10, s[8:11], s29 offen lds
    s_mov_b32 s29, 442368
    s_add_u32 m0, s30, 1024
    s_nop 0
    buffer_load_dwordx4 v11, s[8:11], s29 offen lds
    s_mov_b32 s29, 460800
    s_add_u32 m0, s30, 2048
    s_nop 0
    buffer_load_dwordx4 v10, s[8:11], s29 offen lds
    s_mov_b32 s29, 460800
    s_add_u32 m0, s30, 3072
    s_nop 0
    buffer_load_dwordx4 v11, s[8:11], s29 offen lds
    s_add_u32 s24, s24, 4096
    s_add_u32 s25, s25, 4096
    s_add_u32 s26, s26, 4096
    s_add_u32 s27, s27, 4096
    s_add_u32 s28, s28, 4096
    buffer_load_dwordx4 v[32:35], v3, s[12:15], s24 offen offset:0 sc1
    buffer_load_dwordx4 v[36:39], v3, s[12:15], s25 offen offset:0 sc1
    buffer_load_dwordx4 v[40:43], v3, s[12:15], s26 offen offset:0 sc1
    buffer_load_dwordx4 v[44:47], v3, s[12:15], s27 offen offset:0 sc1
    buffer_load_dwordx4 v[48:51], v3, s[12:15], s28 offen offset:0 sc1
    s_waitcnt vmcnt(18)
    ds_read_b64_tr_b16 v[112:113], v12 offset:4096
    ds_read_b64_tr_b16 v[114:115], v12 offset:6144
    ds_read_b64_tr_b16 v[116:117], v13 offset:4096
    ds_read_b64_tr_b16 v[118:119], v13 offset:6144
    ds_read_b64_tr_b16 v[120:121], v14 offset:4096
    ds_read_b64_tr_b16 v[122:123], v14 offset:6144
    ds_read_b64_tr_b16 v[124:125], v15 offset:4096
    ds_read_b64_tr_b16 v[126:127], v15 offset:6144
    s_waitcnt lgkmcnt(6)
    v_mfma_f32_16x16x32_bf16 v[128:131], v[112:115], v[52:55], v[128:131]
    v_mfma_f32_16x16x32_bf16 v[144:147], v[112:115], v[56:59], v[144:147]
    v_mfma_f32_16x16x32_bf16 v[160:163], v[112:115], v[60:63], v[160:163]
    v_mfma_f32_16x16x32_bf16 v[176:179], v[112:115], v[64:67], v[176:179]
    v_mfma_f32_16x16x32_bf16 v[192:195], v[112:115], v[68:71], v[192:195]
    s_waitcnt lgkmcnt(4)
    v_mfma_f32_16x16x32_bf16 v[132:135], v[116:119], v[52:55], v[132:135]
    v_mfma_f32_16x16x32_bf16 v[148:151], v[116:119], v[56:59], v[148:151]
    v_mfma_f32_16x16x32_bf16 v[164:167], v[116:119], v[60:63], v[164:167]
    v_mfma_f32_16x16x32_bf16 v[180:183], v[116:119], v[64:67], v[180:183]
    v_mfma_f32_16x16x32_bf16 v[196:199], v[116:119], v[68:71], v[196:199]
    s_waitcnt lgkmcnt(2)
    v_mfma_f32_16x16x32_bf16 v[136:139], v[120:123], v[52:55], v[136:139]
    v_mfma_f32_16x16x32_bf16 v[152:155], v[120:123], v[56:59], v[152:155]
    v_mfma_f32_16x16x32_bf16 v[168:171], v[120:123], v[60:63], v[168:171]
    v_mfma_f32_16x16x32_bf16 v[184:187], v[120:123], v[64:67], v[184:187]
    v_mfma_f32_16x16x32_bf16 v[200:203], v[120:123], v[68:71], v[200:203]
    s_waitcnt lgkmcnt(0)
    v_mfma_f32_16x16x32_bf16 v[140:143], v[124:127], v[52:55], v[140:143]
    v_mfma_f32_16x16x32_bf16 v[156:159], v[124:127], v[56:59], v[156:159]
    v_mfma_f32_16x16x32_bf16 v[172:175], v[124:127], v[60:63], v[172:175]
    v_mfma_f32_16x16x32_bf16 v[188:191], v[124:127], v[64:67], v[188:191]
    v_mfma_f32_16x16x32_bf16 v[204:207], v[124:127], v[68:71], v[204:207]
    s_mov_b32 s29, 497664
    s_add_u32 m0, s30, 4096
    s_nop 0
    buffer_load_dwordx4 v10, s[8:11], s29 offen lds
    s_mov_b32 s29, 497664
    s_add_u32 m0, s30, 5120
    s_nop 0
    buffer_load_dwordx4 v11, s[8:11], s29 offen lds
    s_mov_b32 s29, 516096
    s_add_u32 m0, s30, 6144
    s_nop 0
    buffer_load_dwordx4 v10, s[8:11], s29 offen lds
    s_mov_b32 s29, 516096
    s_add_u32 m0, s30, 7168
    s_nop 0
    buffer_load_dwordx4 v11, s[8:11], s29 offen lds
    buffer_load_dwordx4 v[52:55], v3, s[12:15], s24 offen offset:1024 sc1
    buffer_load_dwordx4 v[56:59], v3, s[12:15], s25 offen offset:1024 sc1
    buffer_load_dwordx4 v[60:63], v3, s[12:15], s26 offen offset:1024 sc1
    buffer_load_dwordx4 v[64:67], v3, s[12:15], s27 offen offset:1024 sc1
    buffer_load_dwordx4 v[68:71], v3, s[12:15], s28 offen offset:1024 sc1
    s_waitcnt vmcnt(18)
    ds_read_b64_tr_b16 v[112:113], v12 offset:8192
    ds_read_b64_tr_b16 v[114:115], v12 offset:10240
    ds_read_b64_tr_b16 v[116:117], v13 offset:8192
    ds_read_b64_tr_b16 v[118:119], v13 offset:10240
    ds_read_b64_tr_b16 v[120:121], v14 offset:8192
    ds_read_b64_tr_b16 v[122:123], v14 offset:10240
    ds_read_b64_tr_b16 v[124:125], v15 offset:8192
    ds_read_b64_tr_b16 v[126:127], v15 offset:10240
    s_waitcnt lgkmcnt(6)
    v_mfma_f32_16x16x32_bf16 v[128:131], v[112:115], v[72:75], v[128:131]
    v_mfma_f32_16x16x32_bf16 v[144:147], v[112:115], v[76:79], v[144:147]
    v_mfma_f32_16x16x32_bf16 v[160:163], v[112:115], v[80:83], v[160:163]
    v_mfma_f32_16x16x32_bf16 v[176:179], v[112:115], v[84:87], v[176:179]
    v_mfma_f32_16x16x32_bf16 v[192:195], v[112:115], v[88:91], v[192:195]
    s_waitcnt lgkmcnt(4)
    v_mfma_f32_16x16x32_bf16 v[132:135], v[116:119], v[72:75], v[132:135]
    v_mfma_f32_16x16x32_bf16 v[148:151], v[116:119], v[76:79], v[148:151]
    v_mfma_f32_16x16x32_bf16 v[164:167], v[116:119], v[80:83], v[164:167]
    v_mfma_f32_16x16x32_bf16 v[180:183], v[116:119], v[84:87], v[180:183]
    v_mfma_f32_16x16x32_bf16 v[196:199], v[116:119], v[88:91], v[196:199]
    s_waitcnt lgkmcnt(2)
    v_mfma_f32_16x16x32_bf16 v[136:139], v[120:123], v[72:75], v[136:139]
    v_mfma_f32_16x16x32_bf16 v[152:155], v[120:123], v[76:79], v[152:155]
    v_mfma_f32_16x16x32_bf16 v[168:171], v[120:123], v[80:83], v[168:171]
    v_mfma_f32_16x16x32_bf16 v[184:187], v[120:123], v[84:87], v[184:187]
    v_mfma_f32_16x16x32_bf16 v[200:203], v[120:123], v[88:91], v[200:203]
    s_waitcnt lgkmcnt(0)
    v_mfma_f32_16x16x32_bf16 v[140:143], v[124:127], v[72:75], v[140:143]
    v_mfma_f32_16x16x32_bf16 v[156:159], v[124:127], v[76:79], v[156:159]
    v_mfma_f32_16x16x32_bf16 v[172:175], v[124:127], v[80:83], v[172:175]
    v_mfma_f32_16x16x32_bf16 v[188:191], v[124:127], v[84:87], v[188:191]
    v_mfma_f32_16x16x32_bf16 v[204:207], v[124:127], v[88:91], v[204:207]
    s_mov_b32 s29, 534528
    s_add_u32 m0, s30, 8192
    s_nop 0
    buffer_load_dwordx4 v10, s[8:11], s29 offen lds
    s_mov_b32 s29, 534528
    s_add_u32 m0, s30, 9216
    s_nop 0
    buffer_load_dwordx4 v11, s[8:11], s29 offen lds
    s_mov_b32 s29, 552960
    s_add_u32 m0, s30, 10240
    s_nop 0
    buffer_load_dwordx4 v10, s[8:11], s29 offen lds
    s_mov_b32 s29, 552960
    s_add_u32 m0, s30, 11264
    s_nop 0
    buffer_load_dwordx4 v11, s[8:11], s29 offen lds
    buffer_load_dwordx4 v[72:75], v3, s[12:15], s24 offen offset:2048 sc1
    buffer_load_dwordx4 v[76:79], v3, s[12:15], s25 offen offset:2048 sc1
    buffer_load_dwordx4 v[80:83], v3, s[12:15], s26 offen offset:2048 sc1
    buffer_load_dwordx4 v[84:87], v3, s[12:15], s27 offen offset:2048 sc1
    buffer_load_dwordx4 v[88:91], v3, s[12:15], s28 offen offset:2048 sc1
    s_waitcnt vmcnt(18)
    ds_read_b64_tr_b16 v[112:113], v12 offset:0
    ds_read_b64_tr_b16 v[114:115], v12 offset:2048
    ds_read_b64_tr_b16 v[116:117], v13 offset:0
    ds_read_b64_tr_b16 v[118:119], v13 offset:2048
    ds_read_b64_tr_b16 v[120:121], v14 offset:0
    ds_read_b64_tr_b16 v[122:123], v14 offset:2048
    ds_read_b64_tr_b16 v[124:125], v15 offset:0
    ds_read_b64_tr_b16 v[126:127], v15 offset:2048
    s_waitcnt lgkmcnt(6)
    v_mfma_f32_16x16x32_bf16 v[128:131], v[112:115], v[32:35], v[128:131]
    v_mfma_f32_16x16x32_bf16 v[144:147], v[112:115], v[36:39], v[144:147]
    v_mfma_f32_16x16x32_bf16 v[160:163], v[112:115], v[40:43], v[160:163]
    v_mfma_f32_16x16x32_bf16 v[176:179], v[112:115], v[44:47], v[176:179]
    v_mfma_f32_16x16x32_bf16 v[192:195], v[112:115], v[48:51], v[192:195]
    s_waitcnt lgkmcnt(4)
    v_mfma_f32_16x16x32_bf16 v[132:135], v[116:119], v[32:35], v[132:135]
    v_mfma_f32_16x16x32_bf16 v[148:151], v[116:119], v[36:39], v[148:151]
    v_mfma_f32_16x16x32_bf16 v[164:167], v[116:119], v[40:43], v[164:167]
    v_mfma_f32_16x16x32_bf16 v[180:183], v[116:119], v[44:47], v[180:183]
    v_mfma_f32_16x16x32_bf16 v[196:199], v[116:119], v[48:51], v[196:199]
    s_waitcnt lgkmcnt(2)
    v_mfma_f32_16x16x32_bf16 v[136:139], v[120:123], v[32:35], v[136:139]
    v_mfma_f32_16x16x32_bf16 v[152:155], v[120:123], v[36:39], v[152:155]
    v_mfma_f32_16x16x32_bf16 v[168:171], v[120:123], v[40:43], v[168:171]
    v_mfma_f32_16x16x32_bf16 v[184:187], v[120:123], v[44:47], v[184:187]
    v_mfma_f32_16x16x32_bf16 v[200:203], v[120:123], v[48:51], v[200:203]
    s_waitcnt lgkmcnt(0)
    v_mfma_f32_16x16x32_bf16 v[140:143], v[124:127], v[32:35], v[140:143]
    v_mfma_f32_16x16x32_bf16 v[156:159], v[124:127], v[36:39], v[156:159]
    v_mfma_f32_16x16x32_bf16 v[172:175], v[124:127], v[40:43], v[172:175]
    v_mfma_f32_16x16x32_bf16 v[188:191], v[124:127], v[44:47], v[188:191]
    v_mfma_f32_16x16x32_bf16 v[204:207], v[124:127], v[48:51], v[204:207]
    s_mov_b32 s29, 571392
    s_add_u32 m0, s30, 0
    s_nop 0
    buffer_load_dwordx4 v10, s[8:11], s29 offen lds
    s_mov_b32 s29, 571392
    s_add_u32 m0, s30, 1024
    s_nop 0
    buffer_load_dwordx4 v11, s[8:11], s29 offen lds
    s_mov_b32 s29, 589824
    s_add_u32 m0, s30, 2048
    s_nop 0
    buffer_load_dwordx4 v10, s[8:11], s29 offen lds
    s_mov_b32 s29, 589824
    s_add_u32 m0, s30, 3072
    s_nop 0
    buffer_load_dwordx4 v11, s[8:11], s29 offen lds
    buffer_load_dwordx4 v[32:35], v3, s[12:15], s24 offen offset:3072 sc1
    buffer_load_dwordx4 v[36:39], v3, s[12:15], s25 offen offset:3072 sc1
    buffer_load_dwordx4 v[40:43], v3, s[12:15], s26 offen offset:3072 sc1
    buffer_load_dwordx4 v[44:47], v3, s[12:15], s27 offen offset:3072 sc1
    buffer_load_dwordx4 v[48:51], v3, s[12:15], s28 offen offset:3072 sc1
    s_waitcnt vmcnt(18)
    ds_read_b64_tr_b16 v[112:113], v12 offset:4096
    ds_read_b64_tr_b16 v[114:115], v12 offset:6144
    ds_read_b64_tr_b16 v[116:117], v13 offset:4096
    ds_read_b64_tr_b16 v[118:119], v13 offset:6144
    ds_read_b64_tr_b16 v[120:121], v14 offset:4096
    ds_read_b64_tr_b16 v[122:123], v14 offset:6144
    ds_read_b64_tr_b16 v[124:125], v15 offset:4096
    ds_read_b64_tr_b16 v[126:127], v15 offset:6144
    s_waitcnt lgkmcnt(6)
    v_mfma_f32_16x16x32_bf16 v[128:131], v[112:115], v[52:55], v[128:131]
    v_mfma_f32_16x16x32_bf16 v[144:147], v[112:115], v[56:59], v[144:147]
    v_mfma_f32_16x16x32_bf16 v[160:163], v[112:115], v[60:63], v[160:163]
    v_mfma_f32_16x16x32_bf16 v[176:179], v[112:115], v[64:67], v[176:179]
    v_mfma_f32_16x16x32_bf16 v[192:195], v[112:115], v[68:71], v[192:195]
    s_waitcnt lgkmcnt(4)
    v_mfma_f32_16x16x32_bf16 v[132:135], v[116:119], v[52:55], v[132:135]
    v_mfma_f32_16x16x32_bf16 v[148:151], v[116:119], v[56:59], v[148:151]
    v_mfma_f32_16x16x32_bf16 v[164:167], v[116:119], v[60:63], v[164:167]
    v_mfma_f32_16x16x32_bf16 v[180:183], v[116:119], v[64:67], v[180:183]
    v_mfma_f32_16x16x32_bf16 v[196:199], v[116:119], v[68:71], v[196:199]
    s_waitcnt lgkmcnt(2)
    v_mfma_f32_16x16x32_bf16 v[136:139], v[120:123], v[52:55], v[136:139]
    v_mfma_f32_16x16x32_bf16 v[152:155], v[120:123], v[56:59], v[152:155]
    v_mfma_f32_16x16x32_bf16 v[168:171], v[120:123], v[60:63], v[168:171]
    v_mfma_f32_16x16x32_bf16 v[184:187], v[120:123], v[64:67], v[184:187]
    v_mfma_f32_16x16x32_bf16 v[200:203], v[120:123], v[68:71], v[200:203]
    s_waitcnt lgkmcnt(0)
    v_mfma_f32_16x16x32_bf16 v[140:143], v[124:127], v[52:55], v[140:143]
    v_mfma_f32_16x16x32_bf16 v[156:159], v[124:127], v[56:59], v[156:159]
    v_mfma_f32_16x16x32_bf16 v[172:175], v[124:127], v[60:63], v[172:175]
    v_mfma_f32_16x16x32_bf16 v[188:191], v[124:127], v[64:67], v[188:191]
    v_mfma_f32_16x16x32_bf16 v[204:207], v[124:127], v[68:71], v[204:207]
    s_mov_b32 s29, 608256
    s_add_u32 m0, s30, 4096
    s_nop 0
    buffer_load_dwordx4 v10, s[8:11], s29 offen lds
    s_mov_b32 s29, 608256
    s_add_u32 m0, s30, 5120
    s_nop 0
    buffer_load_dwordx4 v11, s[8:11], s29 offen lds
    s_mov_b32 s29, 626688
    s_add_u32 m0, s30, 6144
    s_nop 0
    buffer_load_dwordx4 v10, s[8:11], s29 offen lds
    s_mov_b32 s29, 626688
    s_add_u32 m0, s30, 7168
    s_nop 0
    buffer_load_dwordx4 v11, s[8:11], s29 offen lds
    s_add_u32 s24, s24, 4096
    s_add_u32 s25, s25, 4096
    s_add_u32 s26, s26, 4096
    s_add_u32 s27, s27, 4096
    s_add_u32 s28, s28, 4096
    buffer_load_dwordx4 v[52:55], v3, s[12:15], s24 offen offset:0 sc1
    buffer_load_dwordx4 v[56:59], v3, s[12:15], s25 offen offset:0 sc1
    buffer_load_dwordx4 v[60:63], v3, s[12:15], s26 offen offset:0 sc1
    buffer_load_dwordx4 v[64:67], v3, s[12:15], s27 offen offset:0 sc1
    buffer_load_dwordx4 v[68:71], v3, s[12:15], s28 offen offset:0 sc1
    s_waitcnt vmcnt(18)
    ds_read_b64_tr_b16 v[112:113], v12 offset:8192
    ds_read_b64_tr_b16 v[114:115], v12 offset:10240
    ds_read_b64_tr_b16 v[116:117], v13 offset:8192
    ds_read_b64_tr_b16 v[118:119], v13 offset:10240
    ds_read_b64_tr_b16 v[120:121], v14 offset:8192
    ds_read_b64_tr_b16 v[122:123], v14 offset:10240
    ds_read_b64_tr_b16 v[124:125], v15 offset:8192
    ds_read_b64_tr_b16 v[126:127], v15 offset:10240
    s_waitcnt lgkmcnt(6)
    v_mfma_f32_16x16x32_bf16 v[128:131], v[112:115], v[72:75], v[128:131]
    v_mfma_f32_16x16x32_bf16 v[144:147], v[112:115], v[76:79], v[144:147]
    v_mfma_f32_16x16x32_bf16 v[160:163], v[112:115], v[80:83], v[160:163]
    v_mfma_f32_16x16x32_bf16 v[176:179], v[112:115], v[84:87], v[176:179]
    v_mfma_f32_16x16x32_bf16 v[192:195], v[112:115], v[88:91], v[192:195]
    s_waitcnt lgkmcnt(4)
    v_mfma_f32_16x16x32_bf16 v[132:135], v[116:119], v[72:75], v[132:135]
    v_mfma_f32_16x16x32_bf16 v[148:151], v[116:119], v[76:79], v[148:151]
    v_mfma_f32_16x16x32_bf16 v[164:167], v[116:119], v[80:83], v[164:167]
    v_mfma_f32_16x16x32_bf16 v[180:183], v[116:119], v[84:87], v[180:183]
    v_mfma_f32_16x16x32_bf16 v[196:199], v[116:119], v[88:91], v[196:199]
    s_waitcnt lgkmcnt(2)
    v_mfma_f32_16x16x32_bf16 v[136:139], v[120:123], v[72:75], v[136:139]
    v_mfma_f32_16x16x32_bf16 v[152:155], v[120:123], v[76:79], v[152:155]
    v_mfma_f32_16x16x32_bf16 v[168:171], v[120:123], v[80:83], v[168:171]
    v_mfma_f32_16x16x32_bf16 v[184:187], v[120:123], v[84:87], v[184:187]
    v_mfma_f32_16x16x32_bf16 v[200:203], v[120:123], v[88:91], v[200:203]
    s_waitcnt lgkmcnt(0)
    v_mfma_f32_16x16x32_bf16 v[140:143], v[124:127], v[72:75], v[140:143]
    v_mfma_f32_16x16x32_bf16 v[156:159], v[124:127], v[76:79], v[156:159]
    v_mfma_f32_16x16x32_bf16 v[172:175], v[124:127], v[80:83], v[172:175]
    v_mfma_f32_16x16x32_bf16 v[188:191], v[124:127], v[84:87], v[188:191]
    v_mfma_f32_16x16x32_bf16 v[204:207], v[124:127], v[88:91], v[204:207]
    s_mov_b32 s29, 479232
    s_add_u32 m0, s30, 8192
    s_nop 0
    buffer_load_dwordx4 v10, s[8:11], s29 offen lds
    s_mov_b32 s29, 479232
    s_add_u32 m0, s30, 9216
    s_nop 0
    buffer_load_dwordx4 v11, s[8:11], s29 offen lds
    s_mov_b32 s29, 645120
    s_add_u32 m0, s30, 10240
    s_nop 0
    buffer_load_dwordx4 v10, s[8:11], s29 offen lds
    s_mov_b32 s29, 645120
    s_add_u32 m0, s30, 11264
    s_nop 0
    buffer_load_dwordx4 v11, s[8:11], s29 offen lds
    buffer_load_dwordx4 v[72:75], v3, s[12:15], s24 offen offset:1024 sc1
    buffer_load_dwordx4 v[76:79], v3, s[12:15], s25 offen offset:1024 sc1
    buffer_load_dwordx4 v[80:83], v3, s[12:15], s26 offen offset:1024 sc1
    buffer_load_dwordx4 v[84:87], v3, s[12:15], s27 offen offset:1024 sc1
    buffer_load_dwordx4 v[88:91], v3, s[12:15], s28 offen offset:1024 sc1
    s_waitcnt vmcnt(18)
    ds_read_b64_tr_b16 v[112:113], v12 offset:0
    ds_read_b64_tr_b16 v[114:115], v12 offset:2048
    ds_read_b64_tr_b16 v[116:117], v13 offset:0
    ds_read_b64_tr_b16 v[118:119], v13 offset:2048
    ds_read_b64_tr_b16 v[120:121], v14 offset:0
    ds_read_b64_tr_b16 v[122:123], v14 offset:2048
    ds_read_b64_tr_b16 v[124:125], v15 offset:0
    ds_read_b64_tr_b16 v[126:127], v15 offset:2048
    s_waitcnt lgkmcnt(6)
    v_mfma_f32_16x16x32_bf16 v[128:131], v[112:115], v[32:35], v[128:131]
    v_mfma_f32_16x16x32_bf16 v[144:147], v[112:115], v[36:39], v[144:147]
    v_mfma_f32_16x16x32_bf16 v[160:163], v[112:115], v[40:43], v[160:163]
    v_mfma_f32_16x16x32_bf16 v[176:179], v[112:115], v[44:47], v[176:179]
    v_mfma_f32_16x16x32_bf16 v[192:195], v[112:115], v[48:51], v[192:195]
    s_waitcnt lgkmcnt(4)
    v_mfma_f32_16x16x32_bf16 v[132:135], v[116:119], v[32:35], v[132:135]
    v_mfma_f32_16x16x32_bf16 v[148:151], v[116:119], v[36:39], v[148:151]
    v_mfma_f32_16x16x32_bf16 v[164:167], v[116:119], v[40:43], v[164:167]
    v_mfma_f32_16x16x32_bf16 v[180:183], v[116:119], v[44:47], v[180:183]
    v_mfma_f32_16x16x32_bf16 v[196:199], v[116:119], v[48:51], v[196:199]
    s_waitcnt lgkmcnt(2)
    v_mfma_f32_16x16x32_bf16 v[136:139], v[120:123], v[32:35], v[136:139]
    v_mfma_f32_16x16x32_bf16 v[152:155], v[120:123], v[36:39], v[152:155]
    v_mfma_f32_16x16x32_bf16 v[168:171], v[120:123], v[40:43], v[168:171]
    v_mfma_f32_16x16x32_bf16 v[184:187], v[120:123], v[44:47], v[184:187]
    v_mfma_f32_16x16x32_bf16 v[200:203], v[120:123], v[48:51], v[200:203]
    s_waitcnt lgkmcnt(0)
    v_mfma_f32_16x16x32_bf16 v[140:143], v[124:127], v[32:35], v[140:143]
    v_mfma_f32_16x16x32_bf16 v[156:159], v[124:127], v[36:39], v[156:159]
    v_mfma_f32_16x16x32_bf16 v[172:175], v[124:127], v[40:43], v[172:175]
    v_mfma_f32_16x16x32_bf16 v[188:191], v[124:127], v[44:47], v[188:191]
    v_mfma_f32_16x16x32_bf16 v[204:207], v[124:127], v[48:51], v[204:207]
    s_waitcnt vmcnt(9)
    ds_read_b64_tr_b16 v[112:113], v12 offset:4096
    ds_read_b64_tr_b16 v[114:115], v12 offset:6144
    ds_read_b64_tr_b16 v[116:117], v13 offset:4096
    ds_read_b64_tr_b16 v[118:119], v13 offset:6144
    ds_read_b64_tr_b16 v[120:121], v14 offset:4096
    ds_read_b64_tr_b16 v[122:123], v14 offset:6144
    ds_read_b64_tr_b16 v[124:125], v15 offset:4096
    ds_read_b64_tr_b16 v[126:127], v15 offset:6144
    s_waitcnt lgkmcnt(6)
    v_mfma_f32_16x16x32_bf16 v[128:131], v[112:115], v[52:55], v[128:131]
    v_mfma_f32_16x16x32_bf16 v[144:147], v[112:115], v[56:59], v[144:147]
    v_mfma_f32_16x16x32_bf16 v[160:163], v[112:115], v[60:63], v[160:163]
    v_mfma_f32_16x16x32_bf16 v[176:179], v[112:115], v[64:67], v[176:179]
    v_mfma_f32_16x16x32_bf16 v[192:195], v[112:115], v[68:71], v[192:195]
    s_waitcnt lgkmcnt(4)
    v_mfma_f32_16x16x32_bf16 v[132:135], v[116:119], v[52:55], v[132:135]
    v_mfma_f32_16x16x32_bf16 v[148:151], v[116:119], v[56:59], v[148:151]
    v_mfma_f32_16x16x32_bf16 v[164:167], v[116:119], v[60:63], v[164:167]
    v_mfma_f32_16x16x32_bf16 v[180:183], v[116:119], v[64:67], v[180:183]
    v_mfma_f32_16x16x32_bf16 v[196:199], v[116:119], v[68:71], v[196:199]
    s_waitcnt lgkmcnt(2)
    v_mfma_f32_16x16x32_bf16 v[136:139], v[120:123], v[52:55], v[136:139]
    v_mfma_f32_16x16x32_bf16 v[152:155], v[120:123], v[56:59], v[152:155]
    v_mfma_f32_16x16x32_bf16 v[168:171], v[120:123], v[60:63], v[168:171]
    v_mfma_f32_16x16x32_bf16 v[184:187], v[120:123], v[64:67], v[184:187]
    v_mfma_f32_16x16x32_bf16 v[200:203], v[120:123], v[68:71], v[200:203]
    s_waitcnt lgkmcnt(0)
    v_mfma_f32_16x16x32_bf16 v[140:143], v[124:127], v[52:55], v[140:143]
    v_mfma_f32_16x16x32_bf16 v[156:159], v[124:127], v[56:59], v[156:159]
    v_mfma_f32_16x16x32_bf16 v[172:175], v[124:127], v[60:63], v[172:175]
    v_mfma_f32_16x16x32_bf16 v[188:191], v[124:127], v[64:67], v[188:191]
    v_mfma_f32_16x16x32_bf16 v[204:207], v[124:127], v[68:71], v[204:207]
    s_waitcnt vmcnt(0)
    ds_read_b64_tr_b16 v[112:113], v12 offset:8192
    ds_read_b64_tr_b16 v[114:115], v12 offset:10240
    ds_read_b64_tr_b16 v[116:117], v13 offset:8192
    ds_read_b64_tr_b16 v[118:119], v13 offset:10240
    ds_read_b64_tr_b16 v[120:121], v14 offset:8192
    ds_read_b64_tr_b16 v[122:123], v14 offset:10240
    ds_read_b64_tr_b16 v[124:125], v15 offset:8192
    ds_read_b64_tr_b16 v[126:127], v15 offset:10240
    s_waitcnt lgkmcnt(6)
    v_mfma_f32_16x16x32_bf16 v[128:131], v[112:115], v[72:75], v[128:131]
    v_mfma_f32_16x16x32_bf16 v[144:147], v[112:115], v[76:79], v[144:147]
    v_mfma_f32_16x16x32_bf16 v[160:163], v[112:115], v[80:83], v[160:163]
    v_mfma_f32_16x16x32_bf16 v[176:179], v[112:115], v[84:87], v[176:179]
    v_mfma_f32_16x16x32_bf16 v[192:195], v[112:115], v[88:91], v[192:195]
    s_waitcnt lgkmcnt(4)
    v_mfma_f32_16x16x32_bf16 v[132:135], v[116:119], v[72:75], v[132:135]
    v_mfma_f32_16x16x32_bf16 v[148:151], v[116:119], v[76:79], v[148:151]
    v_mfma_f32_16x16x32_bf16 v[164:167], v[116:119], v[80:83], v[164:167]
    v_mfma_f32_16x16x32_bf16 v[180:183], v[116:119], v[84:87], v[180:183]
    v_mfma_f32_16x16x32_bf16 v[196:199], v[116:119], v[88:91], v[196:199]
    s_waitcnt lgkmcnt(2)
    v_mfma_f32_16x16x32_bf16 v[136:139], v[120:123], v[72:75], v[136:139]
    v_mfma_f32_16x16x32_bf16 v[152:155], v[120:123], v[76:79], v[152:155]
    v_mfma_f32_16x16x32_bf16 v[168:171], v[120:123], v[80:83], v[168:171]
    v_mfma_f32_16x16x32_bf16 v[184:187], v[120:123], v[84:87], v[184:187]
    v_mfma_f32_16x16x32_bf16 v[200:203], v[120:123], v[88:91], v[200:203]
    s_waitcnt lgkmcnt(0)
    v_mfma_f32_16x16x32_bf16 v[140:143], v[124:127], v[72:75], v[140:143]
    v_mfma_f32_16x16x32_bf16 v[156:159], v[124:127], v[76:79], v[156:159]
    v_mfma_f32_16x16x32_bf16 v[172:175], v[124:127], v[80:83], v[172:175]
    v_mfma_f32_16x16x32_bf16 v[188:191], v[124:127], v[84:87], v[188:191]
    v_mfma_f32_16x16x32_bf16 v[204:207], v[124:127], v[88:91], v[204:207]
    v_add_u32 v5, s30, v3
    s_lshl_b32 s33, s3, 12
    s_add_u32 s33, s33, 131072
    v_add_u32 v6, s33, v3
    ds_write_b128 v5, v[128:131] offset:0
    ds_write_b128 v5, v[132:135] offset:1024
    ds_write_b128 v5, v[136:139] offset:2048
    ds_write_b128 v5, v[140:143] offset:3072
    ds_write_b128 v5, v[144:147] offset:4096
    ds_write_b128 v5, v[148:151] offset:5120
    ds_write_b128 v5, v[152:155] offset:6144
    ds_write_b128 v5, v[156:159] offset:7168
    ds_write_b128 v5, v[160:163] offset:8192
    ds_write_b128 v5, v[164:167] offset:9216
    ds_write_b128 v5, v[168:171] offset:10240
    ds_write_b128 v5, v[172:175] offset:11264
    ds_write_b128 v5, v[176:179] offset:12288
    ds_write_b128 v5, v[180:183] offset:13312
    ds_write_b128 v5, v[184:187] offset:14336
    ds_write_b128 v5, v[188:191] offset:15360
    ds_write_b128 v6, v[192:195] offset:0
    ds_write_b128 v6, v[196:199] offset:1024
    ds_write_b128 v6, v[200:203] offset:2048
    ds_write_b128 v6, v[204:207] offset:3072
    s_mov_b32 s34, s3
    s_add_u32 s35, s3, 8
    s_and_b32 s36, s3, 3
    s_add_u32 s36, s36, 16
    v_lshlrev_b32 v9, 3, v1
    v_lshlrev_b32 v11, 4, v4
    v_and_b32 v12, 15, v1
    v_mul_u32_u24 v12, 1152, v12
    v_lshl_add_u32 v12, v4, 3, v12
    s_lshr_b32 s37, s34, 2
    s_and_b32 s38, s34, 3
    s_add_u32 s37, s37, s22
    s_min_u32 s39, s37, 127
    s_mul_i32 s40, s39, 18432
    s_lshl_b32 s41, s21, 11
    s_add_u32 s40, s40, s41
    s_lshl_b32 s41, s38, 9
    s_add_u32 s40, s40, s41
    s_add_u32 s40, s40, 11534336
    buffer_load_dwordx2 v[120:121], v9, s[12:15], s40 offen sc1
    s_lshl_b32 s40, s21, 8
    s_lshl_b32 s41, s38, 6
    s_add_u32 s40, s40, s41
    s_add_u32 s40, s40, 11520
    buffer_load_dwordx4 v[208:211], v11, s[12:15], s40 offen
    s_mul_i32 s40, s37, 18432
    s_lshl_b32 s41, s21, 7
    s_add_u32 s40, s40, s41
    s_lshl_b32 s41, s38, 5
    s_add_u32 s50, s40, s41
    s_lshr_b32 s37, s35, 2
    s_and_b32 s38, s35, 3
    s_add_u32 s37, s37, s22
    s_min_u32 s39, s37, 127
    s_mul_i32 s40, s39, 18432
    s_lshl_b32 s41, s21, 11
    s_add_u32 s40, s40, s41
    s_lshl_b32 s41, s38, 9
    s_add_u32 s40, s40, s41
    s_add_u32 s40, s40, 11534336
    buffer_load_dwordx2 v[122:123], v9, s[12:15], s40 offen sc1
    s_lshl_b32 s40, s21, 8
    s_lshl_b32 s41, s38, 6
    s_add_u32 s40, s40, s41
    s_add_u32 s40, s40, 11520
    buffer_load_dwordx4 v[212:215], v11, s[12:15], s40 offen
    s_mul_i32 s40, s37, 18432
    s_lshl_b32 s41, s21, 7
    s_add_u32 s40, s40, s41
    s_lshl_b32 s41, s38, 5
    s_add_u32 s51, s40, s41
    s_lshr_b32 s37, s36, 2
    s_and_b32 s38, s36, 3
    s_add_u32 s37, s37, s22
    s_min_u32 s39, s37, 127
    s_mul_i32 s40, s39, 18432
    s_lshl_b32 s41, s21, 11
    s_add_u32 s40, s40, s41
    s_lshl_b32 s41, s38, 9
    s_add_u32 s40, s40, s41
    s_add_u32 s40, s40, 11534336
    buffer_load_dwordx2 v[124:125], v9, s[12:15], s40 offen sc1
    s_lshl_b32 s40, s21, 8
    s_lshl_b32 s41, s38, 6
    s_add_u32 s40, s40, s41
    s_add_u32 s40, s40, 11520
    buffer_load_dwordx4 v[216:219], v11, s[12:15], s40 offen
    s_mul_i32 s40, s37, 18432
    s_lshl_b32 s41, s21, 7
    s_add_u32 s40, s40, s41
    s_lshl_b32 s41, s38, 5
    s_add_u32 s52, s40, s41
    s_lshl_b32 s40, s3, 10
    v_add_u32 v6, s40, v3
    v_add_u32 v13, 65536, v6
    s_and_b32 s40, s3, 3
    s_lshl_b32 s40, s40, 10
    s_add_u32 s40, s40, 131072
    v_add_u32 v8, s40, v3
    s_waitcnt lgkmcnt(0)
    s_barrier
    ds_read_b128 v[16:19], v6 offset:0
    ds_read_b128 v[28:31], v6 offset:16384
    ds_read_b128 v[32:35], v6 offset:32768
    ds_read_b128 v[36:39], v6 offset:49152
    ds_read_b128 v[40:43], v13 offset:0
    ds_read_b128 v[44:47], v13 offset:16384
    ds_read_b128 v[48:51], v13 offset:32768
    ds_read_b128 v[52:55], v13 offset:49152
    ds_read_b128 v[20:23], v6 offset:8192
    ds_read_b128 v[56:59], v6 offset:24576
    ds_read_b128 v[60:63], v6 offset:40960
    ds_read_b128 v[64:67], v6 offset:57344
    ds_read_b128 v[68:71], v13 offset:8192
    ds_read_b128 v[72:75], v13 offset:24576
    ds_read_b128 v[76:79], v13 offset:40960
    ds_read_b128 v[80:83], v13 offset:57344
    ds_read_b128 v[24:27], v8 offset:0
    ds_read_b128 v[84:87], v8 offset:4096
    ds_read_b128 v[88:91], v8 offset:8192
    ds_read_b128 v[92:95], v8 offset:12288
    ds_read_b128 v[96:99], v8 offset:16384
    ds_read_b128 v[100:103], v8 offset:20480
    ds_read_b128 v[104:107], v8 offset:24576
    ds_read_b128 v[108:111], v8 offset:28672
    s_waitcnt lgkmcnt(15)
    v_add_f32 v16, v16, v28
    v_add_f32 v17, v17, v29
    v_add_f32 v18, v18, v30
    v_add_f32 v19, v19, v31
    v_add_f32 v16, v16, v32
    v_add_f32 v17, v17, v33
    v_add_f32 v18, v18, v34
    v_add_f32 v19, v19, v35
    v_add_f32 v16, v16, v36
    v_add_f32 v17, v17, v37
    v_add_f32 v18, v18, v38
    v_add_f32 v19, v19, v39
    v_add_f32 v16, v16, v40
    v_add_f32 v17, v17, v41
    v_add_f32 v18, v18, v42
    v_add_f32 v19, v19, v43
    v_add_f32 v16, v16, v44
    v_add_f32 v17, v17, v45
    v_add_f32 v18, v18, v46
    v_add_f32 v19, v19, v47
    v_add_f32 v16, v16, v48
    v_add_f32 v17, v17, v49
    v_add_f32 v18, v18, v50
    v_add_f32 v19, v19, v51
    v_add_f32 v16, v16, v52
    v_add_f32 v17, v17, v53
    v_add_f32 v18, v18, v54
    v_add_f32 v19, v19, v55
    s_waitcnt lgkmcnt(8)
    v_add_f32 v20, v20, v56
    v_add_f32 v21, v21, v57
    v_add_f32 v22, v22, v58
    v_add_f32 v23, v23, v59
    v_add_f32 v20, v20, v60
    v_add_f32 v21, v21, v61
    v_add_f32 v22, v22, v62
    v_add_f32 v23, v23, v63
    v_add_f32 v20, v20, v64
    v_add_f32 v21, v21, v65
    v_add_f32 v22, v22, v66
    v_add_f32 v23, v23, v67
    v_add_f32 v20, v20, v68
    v_add_f32 v21, v21, v69
    v_add_f32 v22, v22, v70
    v_add_f32 v23, v23, v71
    v_add_f32 v20, v20, v72
    v_add_f32 v21, v21, v73
    v_add_f32 v22, v22, v74
    v_add_f32 v23, v23, v75
    v_add_f32 v20, v20, v76
    v_add_f32 v21, v21, v77
    v_add_f32 v22, v22, v78
    v_add_f32 v23, v23, v79
    v_add_f32 v20, v20, v80
    v_add_f32 v21, v21, v81
    v_add_f32 v22, v22, v82
    v_add_f32 v23, v23, v83
    s_waitcnt lgkmcnt(0)
    v_add_f32 v24, v24, v84
    v_add_f32 v25, v25, v85
    v_add_f32 v26, v26, v86
    v_add_f32 v27, v27, v87
    v_add_f32 v24, v24, v88
    v_add_f32 v25, v25, v89
    v_add_f32 v26, v26, v90
    v_add_f32 v27, v27, v91
    v_add_f32 v24, v24, v92
    v_add_f32 v25, v25, v93
    v_add_f32 v26, v26, v94
    v_add_f32 v27, v27, v95
    v_add_f32 v24, v24, v96
    v_add_f32 v25, v25, v97
    v_add_f32 v26, v26, v98
    v_add_f32 v27, v27, v99
    v_add_f32 v24, v24, v100
    v_add_f32 v25, v25, v101
    v_add_f32 v26, v26, v102
    v_add_f32 v27, v27, v103
    v_add_f32 v24, v24, v104
    v_add_f32 v25, v25, v105
    v_add_f32 v26, v26, v106
    v_add_f32 v27, v27, v107
    v_add_f32 v24, v24, v108
    v_add_f32 v25, v25, v109
    v_add_f32 v26, v26, v110
    v_add_f32 v27, v27, v111
    s_waitcnt vmcnt(0)
    v_cvt_pk_bf16_f32 v32, v16, v17
    v_cvt_pk_bf16_f32 v33, v18, v19
    v_lshlrev_b32 v16, 16, v32
    v_and_b32 v17, 0xffff0000, v32
    v_lshlrev_b32 v18, 16, v33
    v_and_b32 v19, 0xffff0000, v33
    v_mul_f32 v16, v16, v208
    v_mul_f32 v17, v17, v209
    v_mul_f32 v18, v18, v210
    v_mul_f32 v19, v19, v211
    v_cvt_pk_bf16_f32 v32, v16, v17
    v_cvt_pk_bf16_f32 v33, v18, v19
    v_lshlrev_b32 v16, 16, v32
    v_and_b32 v17, 0xffff0000, v32
    v_lshlrev_b32 v18, 16, v33
    v_and_b32 v19, 0xffff0000, v33
    v_lshlrev_b32 v34, 16, v120
    v_and_b32 v35, 0xffff0000, v120
    v_lshlrev_b32 v36, 16, v121
    v_and_b32 v37, 0xffff0000, v121
    v_add_f32 v16, v16, v34
    v_add_f32 v17, v17, v35
    v_add_f32 v18, v18, v36
    v_add_f32 v19, v19, v37
    v_cvt_pk_bf16_f32 v38, v16, v17
    v_cvt_pk_bf16_f32 v39, v18, v19
    buffer_store_dwordx2 v[38:39], v12, s[44:47], s50 offen
    v_cvt_pk_bf16_f32 v40, v20, v21
    v_cvt_pk_bf16_f32 v41, v22, v23
    v_lshlrev_b32 v20, 16, v40
    v_and_b32 v21, 0xffff0000, v40
    v_lshlrev_b32 v22, 16, v41
    v_and_b32 v23, 0xffff0000, v41
    v_mul_f32 v20, v20, v212
    v_mul_f32 v21, v21, v213
    v_mul_f32 v22, v22, v214
    v_mul_f32 v23, v23, v215
    v_cvt_pk_bf16_f32 v40, v20, v21
    v_cvt_pk_bf16_f32 v41, v22, v23
    v_lshlrev_b32 v20, 16, v40
    v_and_b32 v21, 0xffff0000, v40
    v_lshlrev_b32 v22, 16, v41
    v_and_b32 v23, 0xffff0000, v41
    v_lshlrev_b32 v42, 16, v122
    v_and_b32 v43, 0xffff0000, v122
    v_lshlrev_b32 v44, 16, v123
    v_and_b32 v45, 0xffff0000, v123
    v_add_f32 v20, v20, v42
    v_add_f32 v21, v21, v43
    v_add_f32 v22, v22, v44
    v_add_f32 v23, v23, v45
    v_cvt_pk_bf16_f32 v46, v20, v21
    v_cvt_pk_bf16_f32 v47, v22, v23
    buffer_store_dwordx2 v[46:47], v12, s[44:47], s51 offen
    v_cvt_pk_bf16_f32 v48, v24, v25
    v_cvt_pk_bf16_f32 v49, v26, v27
    v_lshlrev_b32 v24, 16, v48
    v_and_b32 v25, 0xffff0000, v48
    v_lshlrev_b32 v26, 16, v49
    v_and_b32 v27, 0xffff0000, v49
    v_mul_f32 v24, v24, v216
    v_mul_f32 v25, v25, v217
    v_mul_f32 v26, v26, v218
    v_mul_f32 v27, v27, v219
    v_cvt_pk_bf16_f32 v48, v24, v25
    v_cvt_pk_bf16_f32 v49, v26, v27
    v_lshlrev_b32 v24, 16, v48
    v_and_b32 v25, 0xffff0000, v48
    v_lshlrev_b32 v26, 16, v49
    v_and_b32 v27, 0xffff0000, v49
    v_lshlrev_b32 v50, 16, v124
    v_and_b32 v51, 0xffff0000, v124
    v_lshlrev_b32 v52, 16, v125
    v_and_b32 v53, 0xffff0000, v125
    v_add_f32 v24, v24, v50
    v_add_f32 v25, v25, v51
    v_add_f32 v26, v26, v52
    v_add_f32 v27, v27, v53
    v_cvt_pk_bf16_f32 v54, v24, v25
    v_cvt_pk_bf16_f32 v55, v26, v27
    buffer_store_dwordx2 v[54:55], v12, s[44:47], s52 offen
k4_done:
    s_endpgm
qkv_attn_kernel_end:

.section .rodata,"a"
.p2align 6
.amdhsa_kernel prep_kernel
  .amdhsa_next_free_vgpr 136
  .amdhsa_next_free_sgpr 100
  .amdhsa_accum_offset 136
  .amdhsa_group_segment_fixed_size 0
  .amdhsa_kernarg_size 96
  .amdhsa_user_sgpr_count 2
  .amdhsa_user_sgpr_kernarg_segment_ptr 1
  .amdhsa_system_sgpr_workgroup_id_x 1
.end_amdhsa_kernel
.p2align 6
.amdhsa_kernel qkv_attn_kernel
  .amdhsa_next_free_vgpr 256
  .amdhsa_next_free_sgpr 100
  .amdhsa_accum_offset 256
  .amdhsa_group_segment_fixed_size 0
  .amdhsa_kernarg_size 96
  .amdhsa_user_sgpr_count 2
  .amdhsa_user_sgpr_kernarg_segment_ptr 1
  .amdhsa_system_sgpr_workgroup_id_x 1
.end_amdhsa_kernel
```
